```python
import torch

def _softmax(x, axis=-1):
    return torch.softmax(x, dim=axis)

def _gelu(x):
    return torch.nn.functional.gelu(x, approximate='tanh')

def _silu(x):
    return torch.nn.functional.silu(x)

def _sigmoid(x):
    return torch.sigmoid(x)

def _layernorm(x, axis=-1, eps=1e-05):
    m = x.mean(dim=axis, keepdim=True)
    v = x.var(dim=axis, keepdim=True, unbiased=False)
    return (x - m) / torch.sqrt(v + eps)

def _scatter_add(tgt, idx, src, axis=0):
    return tgt.clone().index_add_(axis, idx, src)

def _segment_sum(src, seg, n):
    out = torch.zeros((n,) + src.shape[1:], dtype=src.dtype)
    return out.index_add_(0, seg, src)

def _pad(x, pw):
    flat = tuple((v for pair in reversed(pw) for v in pair))
    return torch.nn.functional.pad(x, flat)
kernel_name = 'sequential_preLN__memory_aug_recurrent_mem_tr__swiglu_ffn__prompt'

def setup_inputs():

    _w = lambda a: (lambda t: t.to(torch.bfloat16) if t.is_floating_point() else t)(torch.as_tensor(a))

    def _A_setup():
        B, S, Dm = (1, 2048, 448)
        H, Dh = (16, 256)
        M, seg = (8, 32)
        seg = min(seg, S)
        S = S // seg * seg
        return {'x': _w((lambda *s: torch.randn(*s, dtype=torch.bfloat16) * 0.05)(B, S, Dm)), 'mem0': _w((lambda *s: torch.randn(*s, dtype=torch.bfloat16) * 0.2)(B, M, Dm)), 'Wq': _w((lambda *s: torch.randn(*s, dtype=torch.bfloat16) * 1.6)(Dm, H, Dh) * Dm ** (-0.5)), 'Wk': _w((lambda *s: torch.randn(*s, dtype=torch.bfloat16) * 1.6)(Dm, H, Dh) * Dm ** (-0.5)), 'Wv': _w((lambda *s: torch.randn(*s, dtype=torch.bfloat16) * 0.2)(Dm, H, Dh) * Dm ** (-0.5)), 'Wo': _w((lambda *s: torch.randn(*s, dtype=torch.bfloat16) * 0.2)(H, Dh, Dm) * (H * Dh) ** (-0.5)), 'seg_len': seg}
    _A_in = _A_setup()

    def _B_setup():
        B, S, D, F = (1, 2048, 448, 1792)
        return {'x': _w((lambda *s: torch.randn(*s, dtype=torch.bfloat16) * 0.05)(B, S, D)), 'w_gate': _w((lambda *s: torch.randn(*s, dtype=torch.bfloat16) * 0.05)(D, F)), 'w_up': _w((lambda *s: torch.randn(*s, dtype=torch.bfloat16) * 0.05)(D, F)), 'w_down': _w((lambda *s: torch.randn(*s, dtype=torch.bfloat16) * 0.05)(F, D))}
    _B_in = _B_setup()
    return {'A_x': _A_in['x'], 'A_mem0': _A_in['mem0'], 'A_Wq': _A_in['Wq'], 'A_Wk': _A_in['Wk'], 'A_Wv': _A_in['Wv'], 'A_Wo': _A_in['Wo'], 'A_seg_len': _A_in['seg_len'], 'B_x': _B_in['x'], 'B_w_gate': _B_in['w_gate'], 'B_w_up': _B_in['w_up'], 'B_w_down': _B_in['w_down']}

def reference(A_x, A_mem0, A_Wq, A_Wk, A_Wv, A_Wo, A_seg_len, B_x, B_w_gate, B_w_up, B_w_down):

    def _A_ref(x, mem0, Wq, Wk, Wv, Wo, seg_len):
        B, S, Dm = x.shape
        H, Dh = (Wq.shape[1], Wq.shape[2])
        M = mem0.shape[1]
        scale = Dh ** (-0.5)
        n_seg = S // seg_len
        L = M + seg_len
        idx = torch.arange(L)
        mask = (idx[:, None] < M) | (idx[:, None] >= idx[None, :])
        mem = mem0
        outs = []
        for s in range(n_seg):
            xs = x[:, s * seg_len:(s + 1) * seg_len, :].clone()
            h = torch.concatenate([mem, xs], axis=1)
            q = torch.einsum('btd,dhe->bhte', h, Wq)
            k = torch.einsum('btd,dhe->bhte', h, Wk)
            v = torch.einsum('btd,dhe->bhte', h, Wv)
            scores = torch.einsum('bhqe,bhke->bhqk', q, k) * scale
            scores = torch.where(mask[None, None], scores, -1000000000.0)
            p = _softmax(scores, axis=-1)
            o = torch.einsum('bhqk,bhke->bhqe', p, v)
            o = torch.einsum('bhte,hed->btd', o, Wo)
            mem = o[:, :M, :].clone()
            outs.append(o[:, M:, :])
        return torch.concatenate(outs, axis=1)

    def _B_ref(x, w_gate, w_up, w_down):
        g = _silu(x @ w_gate)
        u = x @ w_up
        return g * u @ w_down
    x = A_x
    h = x + _A_ref(_layernorm(x, axis=-1), A_mem0, A_Wq, A_Wk, A_Wv, A_Wo, A_seg_len)
    h2 = h + _B_ref(_layernorm(h, axis=-1), B_w_gate, B_w_up, B_w_down)
    return h2
```

```asm
; @launch grid=(256,1,1) block=(256,1,1) lds=122880
.amdgcn_target "amdgcn-amd-amdhsa--gfx950"
.text
.globl sequential_preLN__memory_aug_recurrent_mem_tr__swiglu_ffn__prompt_kernel
.p2align 8
.type sequential_preLN__memory_aug_recurrent_mem_tr__swiglu_ffn__prompt_kernel,@function
sequential_preLN__memory_aug_recurrent_mem_tr__swiglu_ffn__prompt_kernel:
s_cmp_ge_u32 s2, 256
s_cbranch_scc1 L_exit0
s_load_dwordx2 s[4:5], s[0:1], 104
s_load_dwordx2 s[92:93], s[0:1], 96
s_getreg_b32 s20, hwreg(HW_REG_XCC_ID)
s_and_b32 s20, s20, 15
v_lshrrev_b32 v1, 6, v0
s_nop 0
v_readfirstlane_b32 s14, v1
s_waitcnt lgkmcnt(0)
s_and_b32 s5, s5, 0xffff
s_mov_b32 s6, 268435456
s_mov_b32 s7, 0x20000
s_and_b32 s93, s93, 0xffff
s_mov_b32 s94, 256
s_mov_b32 s95, 0x20000
s_cmp_lg_u32 s14, 0
s_cbranch_scc1 Lel_wait
s_lshl_b32 s21, s20, 5
v_mov_b32 v2, s21
v_mov_b32 v3, 1
s_mov_b64 exec, 1
buffer_atomic_add v3, v2, s[92:95], 0 offen sc0
s_waitcnt vmcnt(0)
v_readfirstlane_b32 s22, v3
s_mov_b64 exec, -1
s_nop 3
s_cmp_ge_u32 s22, 32
s_cbranch_scc1 Lel_none
s_cmp_ge_u32 s20, 8
s_cbranch_scc1 Lel_none
s_cmp_eq_u32 s20, 0
s_cbranch_scc1 Lel_pub
s_lshl_b32 s21, s20, 5
s_add_u32 s22, s22, s21
s_add_u32 s22, s22, 32
s_branch Lel_pub
Lel_none:
s_mov_b32 s22, 1000
Lel_pub:
v_mov_b32 v3, s22
v_mov_b32 v2, 0
ds_write_b32 v2, v3
s_waitcnt lgkmcnt(0)
Lel_wait:
s_barrier
v_mov_b32 v2, 0
ds_read_b32 v3, v2
s_waitcnt lgkmcnt(0)
v_readfirstlane_b32 s13, v3
s_nop 3
s_barrier
s_cmp_ge_u32 s13, 1000
s_cbranch_scc1 L_exit0
s_mov_b32 s91, s13
s_mov_b32 s88, 0
s_mov_b32 s89, 0
s_mov_b32 s84, 0
s_mov_b32 s24, s14
v_and_b32 v1, 63, v0
s_cmp_ge_u32 s13, 64
s_cbranch_scc1 L_worker
s_cmp_lg_u32 s13, 31
s_cbranch_scc1 L_nozero
v_lshlrev_b32 v4, 4, v0
v_mov_b32 v8, 0
v_mov_b32 v9, 0
v_mov_b32 v10, 0
v_mov_b32 v11, 0
s_mov_b32 s30, 74973184
buffer_store_dwordx4 v[8:11], v4, s[4:7], s30 offen sc1
s_add_u32 s30, s30, 4096
buffer_store_dwordx4 v[8:11], v4, s[4:7], s30 offen sc1
s_add_u32 s30, s30, 4096
buffer_store_dwordx4 v[8:11], v4, s[4:7], s30 offen sc1
s_add_u32 s30, s30, 4096
buffer_store_dwordx4 v[8:11], v4, s[4:7], s30 offen sc1
s_add_u32 s30, s30, 4096
buffer_store_dwordx4 v[8:11], v4, s[4:7], s30 offen sc1
s_add_u32 s30, s30, 4096
buffer_store_dwordx4 v[8:11], v4, s[4:7], s30 offen sc1
s_add_u32 s30, s30, 4096
buffer_store_dwordx4 v[8:11], v4, s[4:7], s30 offen sc1
s_add_u32 s30, s30, 4096
buffer_store_dwordx4 v[8:11], v4, s[4:7], s30 offen sc1
s_add_u32 s30, s30, 4096
buffer_store_dwordx4 v[8:11], v4, s[4:7], s30 offen sc1
s_add_u32 s30, s30, 4096
buffer_store_dwordx4 v[8:11], v4, s[4:7], s30 offen sc1
s_add_u32 s30, s30, 4096
buffer_store_dwordx4 v[8:11], v4, s[4:7], s30 offen sc1
s_add_u32 s30, s30, 4096
buffer_store_dwordx4 v[8:11], v4, s[4:7], s30 offen sc1
s_add_u32 s30, s30, 4096
buffer_store_dwordx4 v[8:11], v4, s[4:7], s30 offen sc1
s_add_u32 s30, s30, 4096
buffer_store_dwordx4 v[8:11], v4, s[4:7], s30 offen sc1
s_add_u32 s30, s30, 4096
buffer_store_dwordx4 v[8:11], v4, s[4:7], s30 offen sc1
s_add_u32 s30, s30, 4096
buffer_store_dwordx4 v[8:11], v4, s[4:7], s30 offen sc1
s_add_u32 s30, s30, 4096
s_waitcnt vmcnt(0)
s_barrier
s_cmp_lg_u32 s24, 0
s_cbranch_scc1 L_nozero
v_mov_b32 v4, 16
v_mov_b32 v5, 1
s_mov_b64 exec, 1
buffer_store_dword v5, v4, s[92:95], 0 offen sc1
s_mov_b64 exec, -1
L_nozero:
s_mov_b32 s26, s13
s_load_dwordx2 s[16:17], s[0:1], 0
s_load_dwordx2 s[20:21], s[0:1], 8
s_waitcnt lgkmcnt(0)
s_and_b32 s17, s17, 0xffff
s_mov_b32 s18, 1835008
s_mov_b32 s19, 0x20000
s_and_b32 s21, s21, 0xffff
s_mov_b32 s22, 7168
s_mov_b32 s23, 0x20000
s_lshr_b32 s27, s24, 1
s_lshl_b32 s28, s26, 1
s_add_u32 s27, s27, s28
s_and_b32 s25, s24, 1
v_and_b32 v184, 15, v1
v_lshrrev_b32 v185, 3, v184
v_lshlrev_b32 v2, 4, v185
v_bfe_u32 v185, v184, 2, 1
v_lshl_add_u32 v2, v185, 2, v2
v_and_b32 v185, 1, v184
v_add_u32 v2, v2, v185
v_bfe_u32 v185, v184, 1, 1
v_lshl_add_u32 v2, v185, 3, v2
s_lshl_b32 s28, s25, 1
v_add_u32 v2, s28, v2
v_lshrrev_b32 v3, 4, v1
v_mul_u32_u24 v4, 896, v2
v_lshrrev_b32 v184, 1, v3
v_lshl_add_u32 v4, v184, 5, v4
v_and_b32 v185, 1, v3
v_lshl_add_u32 v4, v185, 3, v4
v_lshlrev_b32 v188, 4, v1
s_mul_i32 s28, s26, 57344
s_mul_i32 s29, s24, 14336
s_add_u32 s28, s28, s29
buffer_load_dwordx4 v[72:75], v188, s[16:19], s28 offen offset:0
buffer_load_dwordx4 v[76:79], v188, s[16:19], s28 offen offset:1024
buffer_load_dwordx4 v[80:83], v188, s[16:19], s28 offen offset:2048
buffer_load_dwordx4 v[84:87], v188, s[16:19], s28 offen offset:3072
s_add_u32 s28, s28, 4096
buffer_load_dwordx4 v[88:91], v188, s[16:19], s28 offen offset:0
buffer_load_dwordx4 v[92:95], v188, s[16:19], s28 offen offset:1024
buffer_load_dwordx4 v[96:99], v188, s[16:19], s28 offen offset:2048
buffer_load_dwordx4 v[100:103], v188, s[16:19], s28 offen offset:3072
s_add_u32 s28, s28, 4096
buffer_load_dwordx4 v[104:107], v188, s[16:19], s28 offen offset:0
buffer_load_dwordx4 v[108:111], v188, s[16:19], s28 offen offset:1024
buffer_load_dwordx4 v[112:115], v188, s[16:19], s28 offen offset:2048
buffer_load_dwordx4 v[116:119], v188, s[16:19], s28 offen offset:3072
s_add_u32 s28, s28, 4096
buffer_load_dwordx4 v[120:123], v188, s[16:19], s28 offen offset:0
buffer_load_dwordx4 v[124:127], v188, s[16:19], s28 offen offset:1024
v_add_u32 v188, s29, v188
s_waitcnt vmcnt(0)
ds_write_b128 v188, v[72:75] offset:0
ds_write_b128 v188, v[76:79] offset:1024
ds_write_b128 v188, v[80:83] offset:2048
ds_write_b128 v188, v[84:87] offset:3072
ds_write_b128 v188, v[88:91] offset:4096
ds_write_b128 v188, v[92:95] offset:5120
ds_write_b128 v188, v[96:99] offset:6144
ds_write_b128 v188, v[100:103] offset:7168
ds_write_b128 v188, v[104:107] offset:8192
ds_write_b128 v188, v[108:111] offset:9216
ds_write_b128 v188, v[112:115] offset:10240
ds_write_b128 v188, v[116:119] offset:11264
ds_write_b128 v188, v[120:123] offset:12288
ds_write_b128 v188, v[124:127] offset:13312
s_waitcnt lgkmcnt(0)
s_barrier
s_lshr_b32 s28, s24, 1
s_mul_i32 s28, s28, 28672
v_add_u32 v4, s28, v4
ds_read_b64 v[16:17], v4 offset:0
ds_read_b64 v[18:19], v4 offset:16
ds_read_b64 v[20:21], v4 offset:64
ds_read_b64 v[22:23], v4 offset:80
ds_read_b64 v[24:25], v4 offset:128
ds_read_b64 v[26:27], v4 offset:144
ds_read_b64 v[28:29], v4 offset:192
ds_read_b64 v[30:31], v4 offset:208
ds_read_b64 v[32:33], v4 offset:256
ds_read_b64 v[34:35], v4 offset:272
ds_read_b64 v[36:37], v4 offset:320
ds_read_b64 v[38:39], v4 offset:336
ds_read_b64 v[40:41], v4 offset:384
ds_read_b64 v[42:43], v4 offset:400
ds_read_b64 v[44:45], v4 offset:448
ds_read_b64 v[46:47], v4 offset:464
ds_read_b64 v[48:49], v4 offset:512
ds_read_b64 v[50:51], v4 offset:528
ds_read_b64 v[52:53], v4 offset:576
ds_read_b64 v[54:55], v4 offset:592
ds_read_b64 v[56:57], v4 offset:640
ds_read_b64 v[58:59], v4 offset:656
ds_read_b64 v[60:61], v4 offset:704
ds_read_b64 v[62:63], v4 offset:720
ds_read_b64 v[64:65], v4 offset:768
ds_read_b64 v[66:67], v4 offset:784
ds_read_b64 v[68:69], v4 offset:832
ds_read_b64 v[70:71], v4 offset:848
v_lshlrev_b32 v6, 10, v184
v_lshl_add_u32 v6, v2, 4, v6
v_lshl_add_u32 v6, v185, 3, v6
v_lshlrev_b32 v5, 4, v1
s_waitcnt lgkmcnt(0)
v_lshlrev_b32 v72, 16, v16
v_and_b32 v73, 0xffff0000, v16
v_lshlrev_b32 v74, 16, v17
v_and_b32 v75, 0xffff0000, v17
v_lshlrev_b32 v76, 16, v18
v_and_b32 v77, 0xffff0000, v18
v_lshlrev_b32 v78, 16, v19
v_and_b32 v79, 0xffff0000, v19
v_lshlrev_b32 v80, 16, v20
v_and_b32 v81, 0xffff0000, v20
v_lshlrev_b32 v82, 16, v21
v_and_b32 v83, 0xffff0000, v21
v_lshlrev_b32 v84, 16, v22
v_and_b32 v85, 0xffff0000, v22
v_lshlrev_b32 v86, 16, v23
v_and_b32 v87, 0xffff0000, v23
v_lshlrev_b32 v88, 16, v24
v_and_b32 v89, 0xffff0000, v24
v_lshlrev_b32 v90, 16, v25
v_and_b32 v91, 0xffff0000, v25
v_lshlrev_b32 v92, 16, v26
v_and_b32 v93, 0xffff0000, v26
v_lshlrev_b32 v94, 16, v27
v_and_b32 v95, 0xffff0000, v27
v_lshlrev_b32 v96, 16, v28
v_and_b32 v97, 0xffff0000, v28
v_lshlrev_b32 v98, 16, v29
v_and_b32 v99, 0xffff0000, v29
v_lshlrev_b32 v100, 16, v30
v_and_b32 v101, 0xffff0000, v30
v_lshlrev_b32 v102, 16, v31
v_and_b32 v103, 0xffff0000, v31
v_lshlrev_b32 v104, 16, v32
v_and_b32 v105, 0xffff0000, v32
v_lshlrev_b32 v106, 16, v33
v_and_b32 v107, 0xffff0000, v33
v_lshlrev_b32 v108, 16, v34
v_and_b32 v109, 0xffff0000, v34
v_lshlrev_b32 v110, 16, v35
v_and_b32 v111, 0xffff0000, v35
v_lshlrev_b32 v112, 16, v36
v_and_b32 v113, 0xffff0000, v36
v_lshlrev_b32 v114, 16, v37
v_and_b32 v115, 0xffff0000, v37
v_lshlrev_b32 v116, 16, v38
v_and_b32 v117, 0xffff0000, v38
v_lshlrev_b32 v118, 16, v39
v_and_b32 v119, 0xffff0000, v39
v_lshlrev_b32 v120, 16, v40
v_and_b32 v121, 0xffff0000, v40
v_lshlrev_b32 v122, 16, v41
v_and_b32 v123, 0xffff0000, v41
v_lshlrev_b32 v124, 16, v42
v_and_b32 v125, 0xffff0000, v42
v_lshlrev_b32 v126, 16, v43
v_and_b32 v127, 0xffff0000, v43
v_lshlrev_b32 v128, 16, v44
v_and_b32 v129, 0xffff0000, v44
v_lshlrev_b32 v130, 16, v45
v_and_b32 v131, 0xffff0000, v45
v_lshlrev_b32 v132, 16, v46
v_and_b32 v133, 0xffff0000, v46
v_lshlrev_b32 v134, 16, v47
v_and_b32 v135, 0xffff0000, v47
v_lshlrev_b32 v136, 16, v48
v_and_b32 v137, 0xffff0000, v48
v_lshlrev_b32 v138, 16, v49
v_and_b32 v139, 0xffff0000, v49
v_lshlrev_b32 v140, 16, v50
v_and_b32 v141, 0xffff0000, v50
v_lshlrev_b32 v142, 16, v51
v_and_b32 v143, 0xffff0000, v51
v_lshlrev_b32 v144, 16, v52
v_and_b32 v145, 0xffff0000, v52
v_lshlrev_b32 v146, 16, v53
v_and_b32 v147, 0xffff0000, v53
v_lshlrev_b32 v148, 16, v54
v_and_b32 v149, 0xffff0000, v54
v_lshlrev_b32 v150, 16, v55
v_and_b32 v151, 0xffff0000, v55
v_lshlrev_b32 v152, 16, v56
v_and_b32 v153, 0xffff0000, v56
v_lshlrev_b32 v154, 16, v57
v_and_b32 v155, 0xffff0000, v57
v_lshlrev_b32 v156, 16, v58
v_and_b32 v157, 0xffff0000, v58
v_lshlrev_b32 v158, 16, v59
v_and_b32 v159, 0xffff0000, v59
v_lshlrev_b32 v160, 16, v60
v_and_b32 v161, 0xffff0000, v60
v_lshlrev_b32 v162, 16, v61
v_and_b32 v163, 0xffff0000, v61
v_lshlrev_b32 v164, 16, v62
v_and_b32 v165, 0xffff0000, v62
v_lshlrev_b32 v166, 16, v63
v_and_b32 v167, 0xffff0000, v63
v_lshlrev_b32 v168, 16, v64
v_and_b32 v169, 0xffff0000, v64
v_lshlrev_b32 v170, 16, v65
v_and_b32 v171, 0xffff0000, v65
v_lshlrev_b32 v172, 16, v66
v_and_b32 v173, 0xffff0000, v66
v_lshlrev_b32 v174, 16, v67
v_and_b32 v175, 0xffff0000, v67
v_lshlrev_b32 v176, 16, v68
v_and_b32 v177, 0xffff0000, v68
v_lshlrev_b32 v178, 16, v69
v_and_b32 v179, 0xffff0000, v69
v_lshlrev_b32 v180, 16, v70
v_and_b32 v181, 0xffff0000, v70
v_lshlrev_b32 v182, 16, v71
v_and_b32 v183, 0xffff0000, v71
v_mov_b64 v[192:193], 0
v_pk_add_f32 v[192:193], v[192:193], v[72:73]
v_pk_add_f32 v[192:193], v[192:193], v[74:75]
v_pk_add_f32 v[192:193], v[192:193], v[76:77]
v_pk_add_f32 v[192:193], v[192:193], v[78:79]
v_pk_add_f32 v[192:193], v[192:193], v[80:81]
v_pk_add_f32 v[192:193], v[192:193], v[82:83]
v_pk_add_f32 v[192:193], v[192:193], v[84:85]
v_pk_add_f32 v[192:193], v[192:193], v[86:87]
v_pk_add_f32 v[192:193], v[192:193], v[88:89]
v_pk_add_f32 v[192:193], v[192:193], v[90:91]
v_pk_add_f32 v[192:193], v[192:193], v[92:93]
v_pk_add_f32 v[192:193], v[192:193], v[94:95]
v_pk_add_f32 v[192:193], v[192:193], v[96:97]
v_pk_add_f32 v[192:193], v[192:193], v[98:99]
v_pk_add_f32 v[192:193], v[192:193], v[100:101]
v_pk_add_f32 v[192:193], v[192:193], v[102:103]
v_pk_add_f32 v[192:193], v[192:193], v[104:105]
v_pk_add_f32 v[192:193], v[192:193], v[106:107]
v_pk_add_f32 v[192:193], v[192:193], v[108:109]
v_pk_add_f32 v[192:193], v[192:193], v[110:111]
v_pk_add_f32 v[192:193], v[192:193], v[112:113]
v_pk_add_f32 v[192:193], v[192:193], v[114:115]
v_pk_add_f32 v[192:193], v[192:193], v[116:117]
v_pk_add_f32 v[192:193], v[192:193], v[118:119]
v_pk_add_f32 v[192:193], v[192:193], v[120:121]
v_pk_add_f32 v[192:193], v[192:193], v[122:123]
v_pk_add_f32 v[192:193], v[192:193], v[124:125]
v_pk_add_f32 v[192:193], v[192:193], v[126:127]
v_pk_add_f32 v[192:193], v[192:193], v[128:129]
v_pk_add_f32 v[192:193], v[192:193], v[130:131]
v_pk_add_f32 v[192:193], v[192:193], v[132:133]
v_pk_add_f32 v[192:193], v[192:193], v[134:135]
v_pk_add_f32 v[192:193], v[192:193], v[136:137]
v_pk_add_f32 v[192:193], v[192:193], v[138:139]
v_pk_add_f32 v[192:193], v[192:193], v[140:141]
v_pk_add_f32 v[192:193], v[192:193], v[142:143]
v_pk_add_f32 v[192:193], v[192:193], v[144:145]
v_pk_add_f32 v[192:193], v[192:193], v[146:147]
v_pk_add_f32 v[192:193], v[192:193], v[148:149]
v_pk_add_f32 v[192:193], v[192:193], v[150:151]
v_pk_add_f32 v[192:193], v[192:193], v[152:153]
v_pk_add_f32 v[192:193], v[192:193], v[154:155]
v_pk_add_f32 v[192:193], v[192:193], v[156:157]
v_pk_add_f32 v[192:193], v[192:193], v[158:159]
v_pk_add_f32 v[192:193], v[192:193], v[160:161]
v_pk_add_f32 v[192:193], v[192:193], v[162:163]
v_pk_add_f32 v[192:193], v[192:193], v[164:165]
v_pk_add_f32 v[192:193], v[192:193], v[166:167]
v_pk_add_f32 v[192:193], v[192:193], v[168:169]
v_pk_add_f32 v[192:193], v[192:193], v[170:171]
v_pk_add_f32 v[192:193], v[192:193], v[172:173]
v_pk_add_f32 v[192:193], v[192:193], v[174:175]
v_pk_add_f32 v[192:193], v[192:193], v[176:177]
v_pk_add_f32 v[192:193], v[192:193], v[178:179]
v_pk_add_f32 v[192:193], v[192:193], v[180:181]
v_pk_add_f32 v[192:193], v[192:193], v[182:183]
v_add_f32 v7, v192, v193
v_mov_b32 v184, v7
s_nop 1
v_permlane16_swap_b32 v7, v184
v_add_f32 v7, v7, v184
v_mov_b32 v184, v7
s_nop 1
v_permlane32_swap_b32 v7, v184
v_add_f32 v7, v7, v184
v_mul_f32 v194, 0x3b124925, v7
v_mov_b64 v[192:193], 0
v_pk_add_f32 v[72:73], v[72:73], v[194:195] op_sel_hi:[1,0] neg_lo:[0,1] neg_hi:[0,1]
v_pk_fma_f32 v[192:193], v[72:73], v[72:73], v[192:193]
v_pk_add_f32 v[74:75], v[74:75], v[194:195] op_sel_hi:[1,0] neg_lo:[0,1] neg_hi:[0,1]
v_pk_fma_f32 v[192:193], v[74:75], v[74:75], v[192:193]
v_pk_add_f32 v[76:77], v[76:77], v[194:195] op_sel_hi:[1,0] neg_lo:[0,1] neg_hi:[0,1]
v_pk_fma_f32 v[192:193], v[76:77], v[76:77], v[192:193]
v_pk_add_f32 v[78:79], v[78:79], v[194:195] op_sel_hi:[1,0] neg_lo:[0,1] neg_hi:[0,1]
v_pk_fma_f32 v[192:193], v[78:79], v[78:79], v[192:193]
v_pk_add_f32 v[80:81], v[80:81], v[194:195] op_sel_hi:[1,0] neg_lo:[0,1] neg_hi:[0,1]
v_pk_fma_f32 v[192:193], v[80:81], v[80:81], v[192:193]
v_pk_add_f32 v[82:83], v[82:83], v[194:195] op_sel_hi:[1,0] neg_lo:[0,1] neg_hi:[0,1]
v_pk_fma_f32 v[192:193], v[82:83], v[82:83], v[192:193]
v_pk_add_f32 v[84:85], v[84:85], v[194:195] op_sel_hi:[1,0] neg_lo:[0,1] neg_hi:[0,1]
v_pk_fma_f32 v[192:193], v[84:85], v[84:85], v[192:193]
v_pk_add_f32 v[86:87], v[86:87], v[194:195] op_sel_hi:[1,0] neg_lo:[0,1] neg_hi:[0,1]
v_pk_fma_f32 v[192:193], v[86:87], v[86:87], v[192:193]
v_pk_add_f32 v[88:89], v[88:89], v[194:195] op_sel_hi:[1,0] neg_lo:[0,1] neg_hi:[0,1]
v_pk_fma_f32 v[192:193], v[88:89], v[88:89], v[192:193]
v_pk_add_f32 v[90:91], v[90:91], v[194:195] op_sel_hi:[1,0] neg_lo:[0,1] neg_hi:[0,1]
v_pk_fma_f32 v[192:193], v[90:91], v[90:91], v[192:193]
v_pk_add_f32 v[92:93], v[92:93], v[194:195] op_sel_hi:[1,0] neg_lo:[0,1] neg_hi:[0,1]
v_pk_fma_f32 v[192:193], v[92:93], v[92:93], v[192:193]
v_pk_add_f32 v[94:95], v[94:95], v[194:195] op_sel_hi:[1,0] neg_lo:[0,1] neg_hi:[0,1]
v_pk_fma_f32 v[192:193], v[94:95], v[94:95], v[192:193]
v_pk_add_f32 v[96:97], v[96:97], v[194:195] op_sel_hi:[1,0] neg_lo:[0,1] neg_hi:[0,1]
v_pk_fma_f32 v[192:193], v[96:97], v[96:97], v[192:193]
v_pk_add_f32 v[98:99], v[98:99], v[194:195] op_sel_hi:[1,0] neg_lo:[0,1] neg_hi:[0,1]
v_pk_fma_f32 v[192:193], v[98:99], v[98:99], v[192:193]
v_pk_add_f32 v[100:101], v[100:101], v[194:195] op_sel_hi:[1,0] neg_lo:[0,1] neg_hi:[0,1]
v_pk_fma_f32 v[192:193], v[100:101], v[100:101], v[192:193]
v_pk_add_f32 v[102:103], v[102:103], v[194:195] op_sel_hi:[1,0] neg_lo:[0,1] neg_hi:[0,1]
v_pk_fma_f32 v[192:193], v[102:103], v[102:103], v[192:193]
v_pk_add_f32 v[104:105], v[104:105], v[194:195] op_sel_hi:[1,0] neg_lo:[0,1] neg_hi:[0,1]
v_pk_fma_f32 v[192:193], v[104:105], v[104:105], v[192:193]
v_pk_add_f32 v[106:107], v[106:107], v[194:195] op_sel_hi:[1,0] neg_lo:[0,1] neg_hi:[0,1]
v_pk_fma_f32 v[192:193], v[106:107], v[106:107], v[192:193]
v_pk_add_f32 v[108:109], v[108:109], v[194:195] op_sel_hi:[1,0] neg_lo:[0,1] neg_hi:[0,1]
v_pk_fma_f32 v[192:193], v[108:109], v[108:109], v[192:193]
v_pk_add_f32 v[110:111], v[110:111], v[194:195] op_sel_hi:[1,0] neg_lo:[0,1] neg_hi:[0,1]
v_pk_fma_f32 v[192:193], v[110:111], v[110:111], v[192:193]
v_pk_add_f32 v[112:113], v[112:113], v[194:195] op_sel_hi:[1,0] neg_lo:[0,1] neg_hi:[0,1]
v_pk_fma_f32 v[192:193], v[112:113], v[112:113], v[192:193]
v_pk_add_f32 v[114:115], v[114:115], v[194:195] op_sel_hi:[1,0] neg_lo:[0,1] neg_hi:[0,1]
v_pk_fma_f32 v[192:193], v[114:115], v[114:115], v[192:193]
v_pk_add_f32 v[116:117], v[116:117], v[194:195] op_sel_hi:[1,0] neg_lo:[0,1] neg_hi:[0,1]
v_pk_fma_f32 v[192:193], v[116:117], v[116:117], v[192:193]
v_pk_add_f32 v[118:119], v[118:119], v[194:195] op_sel_hi:[1,0] neg_lo:[0,1] neg_hi:[0,1]
v_pk_fma_f32 v[192:193], v[118:119], v[118:119], v[192:193]
v_pk_add_f32 v[120:121], v[120:121], v[194:195] op_sel_hi:[1,0] neg_lo:[0,1] neg_hi:[0,1]
v_pk_fma_f32 v[192:193], v[120:121], v[120:121], v[192:193]
v_pk_add_f32 v[122:123], v[122:123], v[194:195] op_sel_hi:[1,0] neg_lo:[0,1] neg_hi:[0,1]
v_pk_fma_f32 v[192:193], v[122:123], v[122:123], v[192:193]
v_pk_add_f32 v[124:125], v[124:125], v[194:195] op_sel_hi:[1,0] neg_lo:[0,1] neg_hi:[0,1]
v_pk_fma_f32 v[192:193], v[124:125], v[124:125], v[192:193]
v_pk_add_f32 v[126:127], v[126:127], v[194:195] op_sel_hi:[1,0] neg_lo:[0,1] neg_hi:[0,1]
v_pk_fma_f32 v[192:193], v[126:127], v[126:127], v[192:193]
v_pk_add_f32 v[128:129], v[128:129], v[194:195] op_sel_hi:[1,0] neg_lo:[0,1] neg_hi:[0,1]
v_pk_fma_f32 v[192:193], v[128:129], v[128:129], v[192:193]
v_pk_add_f32 v[130:131], v[130:131], v[194:195] op_sel_hi:[1,0] neg_lo:[0,1] neg_hi:[0,1]
v_pk_fma_f32 v[192:193], v[130:131], v[130:131], v[192:193]
v_pk_add_f32 v[132:133], v[132:133], v[194:195] op_sel_hi:[1,0] neg_lo:[0,1] neg_hi:[0,1]
v_pk_fma_f32 v[192:193], v[132:133], v[132:133], v[192:193]
v_pk_add_f32 v[134:135], v[134:135], v[194:195] op_sel_hi:[1,0] neg_lo:[0,1] neg_hi:[0,1]
v_pk_fma_f32 v[192:193], v[134:135], v[134:135], v[192:193]
v_pk_add_f32 v[136:137], v[136:137], v[194:195] op_sel_hi:[1,0] neg_lo:[0,1] neg_hi:[0,1]
v_pk_fma_f32 v[192:193], v[136:137], v[136:137], v[192:193]
v_pk_add_f32 v[138:139], v[138:139], v[194:195] op_sel_hi:[1,0] neg_lo:[0,1] neg_hi:[0,1]
v_pk_fma_f32 v[192:193], v[138:139], v[138:139], v[192:193]
v_pk_add_f32 v[140:141], v[140:141], v[194:195] op_sel_hi:[1,0] neg_lo:[0,1] neg_hi:[0,1]
v_pk_fma_f32 v[192:193], v[140:141], v[140:141], v[192:193]
v_pk_add_f32 v[142:143], v[142:143], v[194:195] op_sel_hi:[1,0] neg_lo:[0,1] neg_hi:[0,1]
v_pk_fma_f32 v[192:193], v[142:143], v[142:143], v[192:193]
v_pk_add_f32 v[144:145], v[144:145], v[194:195] op_sel_hi:[1,0] neg_lo:[0,1] neg_hi:[0,1]
v_pk_fma_f32 v[192:193], v[144:145], v[144:145], v[192:193]
v_pk_add_f32 v[146:147], v[146:147], v[194:195] op_sel_hi:[1,0] neg_lo:[0,1] neg_hi:[0,1]
v_pk_fma_f32 v[192:193], v[146:147], v[146:147], v[192:193]
v_pk_add_f32 v[148:149], v[148:149], v[194:195] op_sel_hi:[1,0] neg_lo:[0,1] neg_hi:[0,1]
v_pk_fma_f32 v[192:193], v[148:149], v[148:149], v[192:193]
v_pk_add_f32 v[150:151], v[150:151], v[194:195] op_sel_hi:[1,0] neg_lo:[0,1] neg_hi:[0,1]
v_pk_fma_f32 v[192:193], v[150:151], v[150:151], v[192:193]
v_pk_add_f32 v[152:153], v[152:153], v[194:195] op_sel_hi:[1,0] neg_lo:[0,1] neg_hi:[0,1]
v_pk_fma_f32 v[192:193], v[152:153], v[152:153], v[192:193]
v_pk_add_f32 v[154:155], v[154:155], v[194:195] op_sel_hi:[1,0] neg_lo:[0,1] neg_hi:[0,1]
v_pk_fma_f32 v[192:193], v[154:155], v[154:155], v[192:193]
v_pk_add_f32 v[156:157], v[156:157], v[194:195] op_sel_hi:[1,0] neg_lo:[0,1] neg_hi:[0,1]
v_pk_fma_f32 v[192:193], v[156:157], v[156:157], v[192:193]
v_pk_add_f32 v[158:159], v[158:159], v[194:195] op_sel_hi:[1,0] neg_lo:[0,1] neg_hi:[0,1]
v_pk_fma_f32 v[192:193], v[158:159], v[158:159], v[192:193]
v_pk_add_f32 v[160:161], v[160:161], v[194:195] op_sel_hi:[1,0] neg_lo:[0,1] neg_hi:[0,1]
v_pk_fma_f32 v[192:193], v[160:161], v[160:161], v[192:193]
v_pk_add_f32 v[162:163], v[162:163], v[194:195] op_sel_hi:[1,0] neg_lo:[0,1] neg_hi:[0,1]
v_pk_fma_f32 v[192:193], v[162:163], v[162:163], v[192:193]
v_pk_add_f32 v[164:165], v[164:165], v[194:195] op_sel_hi:[1,0] neg_lo:[0,1] neg_hi:[0,1]
v_pk_fma_f32 v[192:193], v[164:165], v[164:165], v[192:193]
v_pk_add_f32 v[166:167], v[166:167], v[194:195] op_sel_hi:[1,0] neg_lo:[0,1] neg_hi:[0,1]
v_pk_fma_f32 v[192:193], v[166:167], v[166:167], v[192:193]
v_pk_add_f32 v[168:169], v[168:169], v[194:195] op_sel_hi:[1,0] neg_lo:[0,1] neg_hi:[0,1]
v_pk_fma_f32 v[192:193], v[168:169], v[168:169], v[192:193]
v_pk_add_f32 v[170:171], v[170:171], v[194:195] op_sel_hi:[1,0] neg_lo:[0,1] neg_hi:[0,1]
v_pk_fma_f32 v[192:193], v[170:171], v[170:171], v[192:193]
v_pk_add_f32 v[172:173], v[172:173], v[194:195] op_sel_hi:[1,0] neg_lo:[0,1] neg_hi:[0,1]
v_pk_fma_f32 v[192:193], v[172:173], v[172:173], v[192:193]
v_pk_add_f32 v[174:175], v[174:175], v[194:195] op_sel_hi:[1,0] neg_lo:[0,1] neg_hi:[0,1]
v_pk_fma_f32 v[192:193], v[174:175], v[174:175], v[192:193]
v_pk_add_f32 v[176:177], v[176:177], v[194:195] op_sel_hi:[1,0] neg_lo:[0,1] neg_hi:[0,1]
v_pk_fma_f32 v[192:193], v[176:177], v[176:177], v[192:193]
v_pk_add_f32 v[178:179], v[178:179], v[194:195] op_sel_hi:[1,0] neg_lo:[0,1] neg_hi:[0,1]
v_pk_fma_f32 v[192:193], v[178:179], v[178:179], v[192:193]
v_pk_add_f32 v[180:181], v[180:181], v[194:195] op_sel_hi:[1,0] neg_lo:[0,1] neg_hi:[0,1]
v_pk_fma_f32 v[192:193], v[180:181], v[180:181], v[192:193]
v_pk_add_f32 v[182:183], v[182:183], v[194:195] op_sel_hi:[1,0] neg_lo:[0,1] neg_hi:[0,1]
v_pk_fma_f32 v[192:193], v[182:183], v[182:183], v[192:193]
v_add_f32 v7, v192, v193
v_mov_b32 v184, v7
s_nop 1
v_permlane16_swap_b32 v7, v184
v_add_f32 v7, v7, v184
v_mov_b32 v184, v7
s_nop 1
v_permlane32_swap_b32 v7, v184
v_add_f32 v7, v7, v184
v_mov_b32 v184, 0x3727c5ac
v_fmac_f32 v184, 0x3b124925, v7
v_rsq_f32 v194, v184
s_nop 0
v_pk_mul_f32 v[72:73], v[72:73], v[194:195] op_sel_hi:[1,0]
v_pk_mul_f32 v[74:75], v[74:75], v[194:195] op_sel_hi:[1,0]
v_pk_mul_f32 v[76:77], v[76:77], v[194:195] op_sel_hi:[1,0]
v_pk_mul_f32 v[78:79], v[78:79], v[194:195] op_sel_hi:[1,0]
v_pk_mul_f32 v[80:81], v[80:81], v[194:195] op_sel_hi:[1,0]
v_pk_mul_f32 v[82:83], v[82:83], v[194:195] op_sel_hi:[1,0]
v_pk_mul_f32 v[84:85], v[84:85], v[194:195] op_sel_hi:[1,0]
v_pk_mul_f32 v[86:87], v[86:87], v[194:195] op_sel_hi:[1,0]
v_pk_mul_f32 v[88:89], v[88:89], v[194:195] op_sel_hi:[1,0]
v_pk_mul_f32 v[90:91], v[90:91], v[194:195] op_sel_hi:[1,0]
v_pk_mul_f32 v[92:93], v[92:93], v[194:195] op_sel_hi:[1,0]
v_pk_mul_f32 v[94:95], v[94:95], v[194:195] op_sel_hi:[1,0]
v_pk_mul_f32 v[96:97], v[96:97], v[194:195] op_sel_hi:[1,0]
v_pk_mul_f32 v[98:99], v[98:99], v[194:195] op_sel_hi:[1,0]
v_pk_mul_f32 v[100:101], v[100:101], v[194:195] op_sel_hi:[1,0]
v_pk_mul_f32 v[102:103], v[102:103], v[194:195] op_sel_hi:[1,0]
v_pk_mul_f32 v[104:105], v[104:105], v[194:195] op_sel_hi:[1,0]
v_pk_mul_f32 v[106:107], v[106:107], v[194:195] op_sel_hi:[1,0]
v_pk_mul_f32 v[108:109], v[108:109], v[194:195] op_sel_hi:[1,0]
v_pk_mul_f32 v[110:111], v[110:111], v[194:195] op_sel_hi:[1,0]
v_pk_mul_f32 v[112:113], v[112:113], v[194:195] op_sel_hi:[1,0]
v_pk_mul_f32 v[114:115], v[114:115], v[194:195] op_sel_hi:[1,0]
v_pk_mul_f32 v[116:117], v[116:117], v[194:195] op_sel_hi:[1,0]
v_pk_mul_f32 v[118:119], v[118:119], v[194:195] op_sel_hi:[1,0]
v_pk_mul_f32 v[120:121], v[120:121], v[194:195] op_sel_hi:[1,0]
v_pk_mul_f32 v[122:123], v[122:123], v[194:195] op_sel_hi:[1,0]
v_pk_mul_f32 v[124:125], v[124:125], v[194:195] op_sel_hi:[1,0]
v_pk_mul_f32 v[126:127], v[126:127], v[194:195] op_sel_hi:[1,0]
v_pk_mul_f32 v[128:129], v[128:129], v[194:195] op_sel_hi:[1,0]
v_pk_mul_f32 v[130:131], v[130:131], v[194:195] op_sel_hi:[1,0]
v_pk_mul_f32 v[132:133], v[132:133], v[194:195] op_sel_hi:[1,0]
v_pk_mul_f32 v[134:135], v[134:135], v[194:195] op_sel_hi:[1,0]
v_pk_mul_f32 v[136:137], v[136:137], v[194:195] op_sel_hi:[1,0]
v_pk_mul_f32 v[138:139], v[138:139], v[194:195] op_sel_hi:[1,0]
v_pk_mul_f32 v[140:141], v[140:141], v[194:195] op_sel_hi:[1,0]
v_pk_mul_f32 v[142:143], v[142:143], v[194:195] op_sel_hi:[1,0]
v_pk_mul_f32 v[144:145], v[144:145], v[194:195] op_sel_hi:[1,0]
v_pk_mul_f32 v[146:147], v[146:147], v[194:195] op_sel_hi:[1,0]
v_pk_mul_f32 v[148:149], v[148:149], v[194:195] op_sel_hi:[1,0]
v_pk_mul_f32 v[150:151], v[150:151], v[194:195] op_sel_hi:[1,0]
v_pk_mul_f32 v[152:153], v[152:153], v[194:195] op_sel_hi:[1,0]
v_pk_mul_f32 v[154:155], v[154:155], v[194:195] op_sel_hi:[1,0]
v_pk_mul_f32 v[156:157], v[156:157], v[194:195] op_sel_hi:[1,0]
v_pk_mul_f32 v[158:159], v[158:159], v[194:195] op_sel_hi:[1,0]
v_pk_mul_f32 v[160:161], v[160:161], v[194:195] op_sel_hi:[1,0]
v_pk_mul_f32 v[162:163], v[162:163], v[194:195] op_sel_hi:[1,0]
v_pk_mul_f32 v[164:165], v[164:165], v[194:195] op_sel_hi:[1,0]
v_pk_mul_f32 v[166:167], v[166:167], v[194:195] op_sel_hi:[1,0]
v_pk_mul_f32 v[168:169], v[168:169], v[194:195] op_sel_hi:[1,0]
v_pk_mul_f32 v[170:171], v[170:171], v[194:195] op_sel_hi:[1,0]
v_pk_mul_f32 v[172:173], v[172:173], v[194:195] op_sel_hi:[1,0]
v_pk_mul_f32 v[174:175], v[174:175], v[194:195] op_sel_hi:[1,0]
v_pk_mul_f32 v[176:177], v[176:177], v[194:195] op_sel_hi:[1,0]
v_pk_mul_f32 v[178:179], v[178:179], v[194:195] op_sel_hi:[1,0]
v_pk_mul_f32 v[180:181], v[180:181], v[194:195] op_sel_hi:[1,0]
v_pk_mul_f32 v[182:183], v[182:183], v[194:195] op_sel_hi:[1,0]
s_lshl_b32 s28, s27, 1
s_add_u32 s28, s28, s25
s_mul_i32 s28, s28, 14336
s_add_u32 s28, s28, 59834368
s_mul_i32 s29, s27, 28672
s_add_u32 s29, s29, 42205184
v_cvt_pk_bf16_f32 v16, v72, v73
v_cvt_pk_bf16_f32 v17, v76, v77
v_cvt_pk_bf16_f32 v18, v74, v75
v_cvt_pk_bf16_f32 v19, v78, v79
v_mov_b32 v72, v16
v_mov_b32 v73, v18
v_mov_b32 v74, v17
v_mov_b32 v75, v19
buffer_store_dwordx4 v[16:19], v5, s[4:7], s28 offen offset:0 sc1
s_add_u32 s30, s29, 0
buffer_store_dwordx2 v[72:73], v6, s[4:7], s30 offen
buffer_store_dwordx2 v[74:75], v6, s[4:7], s30 offen offset:512
v_cvt_pk_bf16_f32 v20, v80, v81
v_cvt_pk_bf16_f32 v21, v84, v85
v_cvt_pk_bf16_f32 v22, v82, v83
v_cvt_pk_bf16_f32 v23, v86, v87
v_mov_b32 v80, v20
v_mov_b32 v81, v22
v_mov_b32 v82, v21
v_mov_b32 v83, v23
buffer_store_dwordx4 v[20:23], v5, s[4:7], s28 offen offset:1024 sc1
s_add_u32 s30, s29, 2048
buffer_store_dwordx2 v[80:81], v6, s[4:7], s30 offen
buffer_store_dwordx2 v[82:83], v6, s[4:7], s30 offen offset:512
v_cvt_pk_bf16_f32 v24, v88, v89
v_cvt_pk_bf16_f32 v25, v92, v93
v_cvt_pk_bf16_f32 v26, v90, v91
v_cvt_pk_bf16_f32 v27, v94, v95
v_mov_b32 v88, v24
v_mov_b32 v89, v26
v_mov_b32 v90, v25
v_mov_b32 v91, v27
buffer_store_dwordx4 v[24:27], v5, s[4:7], s28 offen offset:2048 sc1
s_add_u32 s30, s29, 4096
buffer_store_dwordx2 v[88:89], v6, s[4:7], s30 offen
buffer_store_dwordx2 v[90:91], v6, s[4:7], s30 offen offset:512
v_cvt_pk_bf16_f32 v28, v96, v97
v_cvt_pk_bf16_f32 v29, v100, v101
v_cvt_pk_bf16_f32 v30, v98, v99
v_cvt_pk_bf16_f32 v31, v102, v103
v_mov_b32 v96, v28
v_mov_b32 v97, v30
v_mov_b32 v98, v29
v_mov_b32 v99, v31
buffer_store_dwordx4 v[28:31], v5, s[4:7], s28 offen offset:3072 sc1
s_add_u32 s30, s29, 6144
buffer_store_dwordx2 v[96:97], v6, s[4:7], s30 offen
buffer_store_dwordx2 v[98:99], v6, s[4:7], s30 offen offset:512
v_cvt_pk_bf16_f32 v32, v104, v105
v_cvt_pk_bf16_f32 v33, v108, v109
v_cvt_pk_bf16_f32 v34, v106, v107
v_cvt_pk_bf16_f32 v35, v110, v111
v_mov_b32 v104, v32
v_mov_b32 v105, v34
v_mov_b32 v106, v33
v_mov_b32 v107, v35
s_add_u32 s28, s28, 4096
buffer_store_dwordx4 v[32:35], v5, s[4:7], s28 offen offset:0 sc1
s_add_u32 s30, s29, 8192
buffer_store_dwordx2 v[104:105], v6, s[4:7], s30 offen
buffer_store_dwordx2 v[106:107], v6, s[4:7], s30 offen offset:512
v_cvt_pk_bf16_f32 v36, v112, v113
v_cvt_pk_bf16_f32 v37, v116, v117
v_cvt_pk_bf16_f32 v38, v114, v115
v_cvt_pk_bf16_f32 v39, v118, v119
v_mov_b32 v112, v36
v_mov_b32 v113, v38
v_mov_b32 v114, v37
v_mov_b32 v115, v39
buffer_store_dwordx4 v[36:39], v5, s[4:7], s28 offen offset:1024 sc1
s_add_u32 s30, s29, 10240
buffer_store_dwordx2 v[112:113], v6, s[4:7], s30 offen
buffer_store_dwordx2 v[114:115], v6, s[4:7], s30 offen offset:512
v_cvt_pk_bf16_f32 v40, v120, v121
v_cvt_pk_bf16_f32 v41, v124, v125
v_cvt_pk_bf16_f32 v42, v122, v123
v_cvt_pk_bf16_f32 v43, v126, v127
v_mov_b32 v120, v40
v_mov_b32 v121, v42
v_mov_b32 v122, v41
v_mov_b32 v123, v43
buffer_store_dwordx4 v[40:43], v5, s[4:7], s28 offen offset:2048 sc1
s_add_u32 s30, s29, 12288
buffer_store_dwordx2 v[120:121], v6, s[4:7], s30 offen
buffer_store_dwordx2 v[122:123], v6, s[4:7], s30 offen offset:512
v_cvt_pk_bf16_f32 v44, v128, v129
v_cvt_pk_bf16_f32 v45, v132, v133
v_cvt_pk_bf16_f32 v46, v130, v131
v_cvt_pk_bf16_f32 v47, v134, v135
v_mov_b32 v128, v44
v_mov_b32 v129, v46
v_mov_b32 v130, v45
v_mov_b32 v131, v47
buffer_store_dwordx4 v[44:47], v5, s[4:7], s28 offen offset:3072 sc1
s_add_u32 s30, s29, 14336
buffer_store_dwordx2 v[128:129], v6, s[4:7], s30 offen
buffer_store_dwordx2 v[130:131], v6, s[4:7], s30 offen offset:512
v_cvt_pk_bf16_f32 v48, v136, v137
v_cvt_pk_bf16_f32 v49, v140, v141
v_cvt_pk_bf16_f32 v50, v138, v139
v_cvt_pk_bf16_f32 v51, v142, v143
v_mov_b32 v136, v48
v_mov_b32 v137, v50
v_mov_b32 v138, v49
v_mov_b32 v139, v51
s_add_u32 s28, s28, 4096
buffer_store_dwordx4 v[48:51], v5, s[4:7], s28 offen offset:0 sc1
s_add_u32 s30, s29, 16384
buffer_store_dwordx2 v[136:137], v6, s[4:7], s30 offen
buffer_store_dwordx2 v[138:139], v6, s[4:7], s30 offen offset:512
v_cvt_pk_bf16_f32 v52, v144, v145
v_cvt_pk_bf16_f32 v53, v148, v149
v_cvt_pk_bf16_f32 v54, v146, v147
v_cvt_pk_bf16_f32 v55, v150, v151
v_mov_b32 v144, v52
v_mov_b32 v145, v54
v_mov_b32 v146, v53
v_mov_b32 v147, v55
buffer_store_dwordx4 v[52:55], v5, s[4:7], s28 offen offset:1024 sc1
s_add_u32 s30, s29, 18432
buffer_store_dwordx2 v[144:145], v6, s[4:7], s30 offen
buffer_store_dwordx2 v[146:147], v6, s[4:7], s30 offen offset:512
v_cvt_pk_bf16_f32 v56, v152, v153
v_cvt_pk_bf16_f32 v57, v156, v157
v_cvt_pk_bf16_f32 v58, v154, v155
v_cvt_pk_bf16_f32 v59, v158, v159
v_mov_b32 v152, v56
v_mov_b32 v153, v58
v_mov_b32 v154, v57
v_mov_b32 v155, v59
buffer_store_dwordx4 v[56:59], v5, s[4:7], s28 offen offset:2048 sc1
s_add_u32 s30, s29, 20480
buffer_store_dwordx2 v[152:153], v6, s[4:7], s30 offen
buffer_store_dwordx2 v[154:155], v6, s[4:7], s30 offen offset:512
v_cvt_pk_bf16_f32 v60, v160, v161
v_cvt_pk_bf16_f32 v61, v164, v165
v_cvt_pk_bf16_f32 v62, v162, v163
v_cvt_pk_bf16_f32 v63, v166, v167
v_mov_b32 v160, v60
v_mov_b32 v161, v62
v_mov_b32 v162, v61
v_mov_b32 v163, v63
buffer_store_dwordx4 v[60:63], v5, s[4:7], s28 offen offset:3072 sc1
s_add_u32 s30, s29, 22528
buffer_store_dwordx2 v[160:161], v6, s[4:7], s30 offen
buffer_store_dwordx2 v[162:163], v6, s[4:7], s30 offen offset:512
v_cvt_pk_bf16_f32 v64, v168, v169
v_cvt_pk_bf16_f32 v65, v172, v173
v_cvt_pk_bf16_f32 v66, v170, v171
v_cvt_pk_bf16_f32 v67, v174, v175
v_mov_b32 v168, v64
v_mov_b32 v169, v66
v_mov_b32 v170, v65
v_mov_b32 v171, v67
s_add_u32 s28, s28, 4096
buffer_store_dwordx4 v[64:67], v5, s[4:7], s28 offen offset:0 sc1
s_add_u32 s30, s29, 24576
buffer_store_dwordx2 v[168:169], v6, s[4:7], s30 offen
buffer_store_dwordx2 v[170:171], v6, s[4:7], s30 offen offset:512
v_cvt_pk_bf16_f32 v68, v176, v177
v_cvt_pk_bf16_f32 v69, v180, v181
v_cvt_pk_bf16_f32 v70, v178, v179
v_cvt_pk_bf16_f32 v71, v182, v183
v_mov_b32 v176, v68
v_mov_b32 v177, v70
v_mov_b32 v178, v69
v_mov_b32 v179, v71
buffer_store_dwordx4 v[68:71], v5, s[4:7], s28 offen offset:1024 sc1
s_add_u32 s30, s29, 26624
buffer_store_dwordx2 v[176:177], v6, s[4:7], s30 offen
buffer_store_dwordx2 v[178:179], v6, s[4:7], s30 offen offset:512
s_waitcnt vmcnt(0)
s_barrier
s_cmp_lg_u32 s24, 0
s_cbranch_scc1 Q1s_s
v_mov_b32 v4, 16
s_mov_b32 s47, 0
Q1s_r_p:
buffer_load_dword v5, v4, s[92:95], 0 offen sc1
s_waitcnt vmcnt(0)
v_readfirstlane_b32 s46, v5
s_add_u32 s47, s47, 1
s_nop 1
s_cmp_lg_u32 s46, 0
s_cbranch_scc1 Q1s_r_o
s_cmp_lt_u32 s47, 20000
s_cbranch_scc1 Q1s_r_p
Q1s_r_o:
v_mov_b32 v4, 75019392
v_mov_b32 v5, 1
s_mov_b64 exec, 1
buffer_atomic_add v5, v4, s[4:7], 0 offen
s_mov_b64 exec, -1
Q1s_s:
s_cmp_ge_u32 s13, 30
s_cbranch_scc1 L_warm
v_and_b32 v1, 63, v0
v_lshlrev_b32 v2, 4, v1
s_cmp_ge_u32 s13, 16
s_cbranch_scc1 LB_pre
s_cmp_lg_u32 s24, 0
s_cbranch_scc1 LA_af_w
s_lshl_b32 s46, s13, 7
s_add_u32 s46, s46, 75015296
v_mov_b32 v4, s46
s_mov_b32 s47, 0
LA_af_p:
buffer_load_dword v5, v4, s[4:7], 0 offen sc1
s_waitcnt vmcnt(0)
v_readfirstlane_b32 s46, v5
s_add_u32 s47, s47, 1
s_nop 1
s_cmp_ge_u32 s46, 7
s_cbranch_scc1 LA_af_w
s_cmp_gt_u32 s47, 20000
s_cbranch_scc1 LA_af_w
s_sleep 1
s_branch LA_af_p
LA_af_w:
s_barrier
v_and_b32 v43, 63, v0
v_lshlrev_b32 v1, 4, v43
v_and_b32 v2, 8, v43
v_cmp_ne_u32 vcc, 0, v2
v_mov_b32 v2, 0x4444
v_mov_b32 v3, 0xeeee
v_cndmask_b32 v2, v2, v3, vcc
s_mul_i32 s20, s13, 28
s_mul_i32 s21, s14, 7
s_add_u32 s20, s20, s21
s_mul_i32 s20, s20, 14336
s_add_u32 s20, s20, 0
s_add_u32 s21, s20, 0
buffer_load_dwordx4 a[0:3], v1, s[4:7], s21 offen offset:0 sc1
buffer_load_dwordx4 a[4:7], v1, s[4:7], s21 offen offset:1024 sc1
s_add_u32 s21, s20, 2048
buffer_load_dwordx4 a[8:11], v1, s[4:7], s21 offen offset:0 sc1
buffer_load_dwordx4 a[12:15], v1, s[4:7], s21 offen offset:1024 sc1
s_add_u32 s21, s20, 4096
buffer_load_dwordx4 a[16:19], v1, s[4:7], s21 offen offset:0 sc1
buffer_load_dwordx4 a[20:23], v1, s[4:7], s21 offen offset:1024 sc1
s_add_u32 s21, s20, 14336
buffer_load_dwordx4 a[56:59], v1, s[4:7], s21 offen offset:0 sc1
buffer_load_dwordx4 a[60:63], v1, s[4:7], s21 offen offset:1024 sc1
s_add_u32 s21, s20, 16384
buffer_load_dwordx4 a[64:67], v1, s[4:7], s21 offen offset:0 sc1
buffer_load_dwordx4 a[68:71], v1, s[4:7], s21 offen offset:1024 sc1
s_add_u32 s21, s20, 18432
buffer_load_dwordx4 a[72:75], v1, s[4:7], s21 offen offset:0 sc1
buffer_load_dwordx4 a[76:79], v1, s[4:7], s21 offen offset:1024 sc1
s_add_u32 s21, s20, 28672
buffer_load_dwordx4 a[112:115], v1, s[4:7], s21 offen offset:0 sc1
buffer_load_dwordx4 a[116:119], v1, s[4:7], s21 offen offset:1024 sc1
s_add_u32 s21, s20, 30720
buffer_load_dwordx4 a[120:123], v1, s[4:7], s21 offen offset:0 sc1
buffer_load_dwordx4 a[124:127], v1, s[4:7], s21 offen offset:1024 sc1
s_add_u32 s21, s20, 32768
buffer_load_dwordx4 a[128:131], v1, s[4:7], s21 offen offset:0 sc1
buffer_load_dwordx4 a[132:135], v1, s[4:7], s21 offen offset:1024 sc1
s_add_u32 s21, s20, 43008
buffer_load_dwordx4 a[168:171], v1, s[4:7], s21 offen offset:0 sc1
buffer_load_dwordx4 a[172:175], v1, s[4:7], s21 offen offset:1024 sc1
s_add_u32 s21, s20, 45056
buffer_load_dwordx4 a[176:179], v1, s[4:7], s21 offen offset:0 sc1
buffer_load_dwordx4 a[180:183], v1, s[4:7], s21 offen offset:1024 sc1
s_add_u32 s21, s20, 47104
buffer_load_dwordx4 a[184:187], v1, s[4:7], s21 offen offset:0 sc1
buffer_load_dwordx4 a[188:191], v1, s[4:7], s21 offen offset:1024 sc1
s_add_u32 s21, s20, 57344
buffer_load_dwordx4 a[224:227], v1, s[4:7], s21 offen offset:0 sc1
buffer_load_dwordx4 a[228:231], v1, s[4:7], s21 offen offset:1024 sc1
s_add_u32 s21, s20, 59392
buffer_load_dwordx4 a[232:235], v1, s[4:7], s21 offen offset:0 sc1
buffer_load_dwordx4 a[236:239], v1, s[4:7], s21 offen offset:1024 sc1
s_add_u32 s21, s20, 61440
buffer_load_dwordx4 a[240:243], v1, s[4:7], s21 offen offset:0 sc1
buffer_load_dwordx4 a[244:247], v1, s[4:7], s21 offen offset:1024 sc1
s_add_u32 s21, s20, 71680
buffer_load_dwordx4 v[144:147], v1, s[4:7], s21 offen offset:0 sc1
buffer_load_dwordx4 v[148:151], v1, s[4:7], s21 offen offset:1024 sc1
s_waitcnt vmcnt(30)
s_add_u32 s21, s20, 73728
buffer_load_dwordx4 v[152:155], v1, s[4:7], s21 offen offset:0 sc1
buffer_load_dwordx4 v[156:159], v1, s[4:7], s21 offen offset:1024 sc1
s_add_u32 s21, s20, 75776
buffer_load_dwordx4 v[160:163], v1, s[4:7], s21 offen offset:0 sc1
buffer_load_dwordx4 v[164:167], v1, s[4:7], s21 offen offset:1024 sc1
s_add_u32 s21, s20, 86016
buffer_load_dwordx4 v[200:203], v1, s[4:7], s21 offen offset:0 sc1
buffer_load_dwordx4 v[204:207], v1, s[4:7], s21 offen offset:1024 sc1
s_add_u32 s21, s20, 88064
buffer_load_dwordx4 v[208:211], v1, s[4:7], s21 offen offset:0 sc1
buffer_load_dwordx4 v[212:215], v1, s[4:7], s21 offen offset:1024 sc1
s_add_u32 s21, s20, 90112
buffer_load_dwordx4 v[216:219], v1, s[4:7], s21 offen offset:0 sc1
buffer_load_dwordx4 v[220:223], v1, s[4:7], s21 offen offset:1024 sc1
s_lshl_b32 s22, s13, 7
s_add_u32 s22, s22, 75019648
v_mov_b32 v44, s22
s_mov_b32 s28, 0
LA_af2_p:
buffer_load_dword v45, v44, s[4:7], 0 offen sc1
s_waitcnt vmcnt(0)
v_cmp_gt_u32 vcc, 7, v45
s_cbranch_vccz LA_af2_w
s_add_u32 s28, s28, 1
s_cmp_lt_u32 s28, 20000
s_cbranch_scc1 LA_af2_p
LA_af2_w:
s_add_u32 s21, s20, 6144
buffer_load_dwordx4 a[24:27], v1, s[4:7], s21 offen offset:0 sc1
buffer_load_dwordx4 a[28:31], v1, s[4:7], s21 offen offset:1024 sc1
s_add_u32 s21, s20, 8192
buffer_load_dwordx4 a[32:35], v1, s[4:7], s21 offen offset:0 sc1
buffer_load_dwordx4 a[36:39], v1, s[4:7], s21 offen offset:1024 sc1
s_add_u32 s21, s20, 10240
buffer_load_dwordx4 a[40:43], v1, s[4:7], s21 offen offset:0 sc1
buffer_load_dwordx4 a[44:47], v1, s[4:7], s21 offen offset:1024 sc1
s_add_u32 s21, s20, 12288
buffer_load_dwordx4 a[48:51], v1, s[4:7], s21 offen offset:0 sc1
buffer_load_dwordx4 a[52:55], v1, s[4:7], s21 offen offset:1024 sc1
s_add_u32 s21, s20, 20480
buffer_load_dwordx4 a[80:83], v1, s[4:7], s21 offen offset:0 sc1
buffer_load_dwordx4 a[84:87], v1, s[4:7], s21 offen offset:1024 sc1
s_add_u32 s21, s20, 22528
buffer_load_dwordx4 a[88:91], v1, s[4:7], s21 offen offset:0 sc1
buffer_load_dwordx4 a[92:95], v1, s[4:7], s21 offen offset:1024 sc1
s_add_u32 s21, s20, 24576
buffer_load_dwordx4 a[96:99], v1, s[4:7], s21 offen offset:0 sc1
buffer_load_dwordx4 a[100:103], v1, s[4:7], s21 offen offset:1024 sc1
s_add_u32 s21, s20, 26624
buffer_load_dwordx4 a[104:107], v1, s[4:7], s21 offen offset:0 sc1
buffer_load_dwordx4 a[108:111], v1, s[4:7], s21 offen offset:1024 sc1
s_add_u32 s21, s20, 34816
buffer_load_dwordx4 a[136:139], v1, s[4:7], s21 offen offset:0 sc1
buffer_load_dwordx4 a[140:143], v1, s[4:7], s21 offen offset:1024 sc1
s_add_u32 s21, s20, 36864
buffer_load_dwordx4 a[144:147], v1, s[4:7], s21 offen offset:0 sc1
buffer_load_dwordx4 a[148:151], v1, s[4:7], s21 offen offset:1024 sc1
s_add_u32 s21, s20, 38912
buffer_load_dwordx4 a[152:155], v1, s[4:7], s21 offen offset:0 sc1
buffer_load_dwordx4 a[156:159], v1, s[4:7], s21 offen offset:1024 sc1
s_waitcnt vmcnt(30)
s_add_u32 s21, s20, 40960
buffer_load_dwordx4 a[160:163], v1, s[4:7], s21 offen offset:0 sc1
buffer_load_dwordx4 a[164:167], v1, s[4:7], s21 offen offset:1024 sc1
s_add_u32 s21, s20, 49152
buffer_load_dwordx4 a[192:195], v1, s[4:7], s21 offen offset:0 sc1
buffer_load_dwordx4 a[196:199], v1, s[4:7], s21 offen offset:1024 sc1
s_add_u32 s21, s20, 51200
buffer_load_dwordx4 a[200:203], v1, s[4:7], s21 offen offset:0 sc1
buffer_load_dwordx4 a[204:207], v1, s[4:7], s21 offen offset:1024 sc1
s_add_u32 s21, s20, 53248
buffer_load_dwordx4 a[208:211], v1, s[4:7], s21 offen offset:0 sc1
buffer_load_dwordx4 a[212:215], v1, s[4:7], s21 offen offset:1024 sc1
s_add_u32 s21, s20, 55296
buffer_load_dwordx4 a[216:219], v1, s[4:7], s21 offen offset:0 sc1
buffer_load_dwordx4 a[220:223], v1, s[4:7], s21 offen offset:1024 sc1
s_add_u32 s21, s20, 63488
buffer_load_dwordx4 a[248:251], v1, s[4:7], s21 offen offset:0 sc1
buffer_load_dwordx4 a[252:255], v1, s[4:7], s21 offen offset:1024 sc1
s_add_u32 s21, s20, 65536
buffer_load_dwordx4 v[120:123], v1, s[4:7], s21 offen offset:0 sc1
buffer_load_dwordx4 v[124:127], v1, s[4:7], s21 offen offset:1024 sc1
s_add_u32 s21, s20, 67584
buffer_load_dwordx4 v[128:131], v1, s[4:7], s21 offen offset:0 sc1
buffer_load_dwordx4 v[132:135], v1, s[4:7], s21 offen offset:1024 sc1
s_add_u32 s21, s20, 69632
buffer_load_dwordx4 v[136:139], v1, s[4:7], s21 offen offset:0 sc1
buffer_load_dwordx4 v[140:143], v1, s[4:7], s21 offen offset:1024 sc1
s_add_u32 s21, s20, 77824
buffer_load_dwordx4 v[168:171], v1, s[4:7], s21 offen offset:0 sc1
buffer_load_dwordx4 v[172:175], v1, s[4:7], s21 offen offset:1024 sc1
s_add_u32 s21, s20, 79872
buffer_load_dwordx4 v[176:179], v1, s[4:7], s21 offen offset:0 sc1
buffer_load_dwordx4 v[180:183], v1, s[4:7], s21 offen offset:1024 sc1
s_add_u32 s21, s20, 81920
buffer_load_dwordx4 v[184:187], v1, s[4:7], s21 offen offset:0 sc1
buffer_load_dwordx4 v[188:191], v1, s[4:7], s21 offen offset:1024 sc1
s_add_u32 s21, s20, 83968
buffer_load_dwordx4 v[192:195], v1, s[4:7], s21 offen offset:0 sc1
buffer_load_dwordx4 v[196:199], v1, s[4:7], s21 offen offset:1024 sc1
s_add_u32 s21, s20, 92160
buffer_load_dwordx4 v[224:227], v1, s[4:7], s21 offen offset:0 sc1
buffer_load_dwordx4 v[228:231], v1, s[4:7], s21 offen offset:1024 sc1
s_add_u32 s21, s20, 94208
buffer_load_dwordx4 v[232:235], v1, s[4:7], s21 offen offset:0 sc1
buffer_load_dwordx4 v[236:239], v1, s[4:7], s21 offen offset:1024 sc1
s_add_u32 s21, s20, 96256
buffer_load_dwordx4 v[240:243], v1, s[4:7], s21 offen offset:0 sc1
buffer_load_dwordx4 v[244:247], v1, s[4:7], s21 offen offset:1024 sc1
s_waitcnt vmcnt(30)
s_add_u32 s21, s20, 98304
buffer_load_dwordx4 v[248:251], v1, s[4:7], s21 offen offset:0 sc1
buffer_load_dwordx4 v[252:255], v1, s[4:7], s21 offen offset:1024 sc1
v_and_b32 v44, 15, v43
v_lshrrev_b32 v45, 4, v43
s_mul_i32 s20, s14, 1792
v_and_b32 v46, 7, v44
v_lshlrev_b32 v46, 4, v46
v_lshlrev_b32 v47, 7, v45
v_add3_u32 v3, v46, v47, s20
v_lshrrev_b32 v47, 1, v45
v_lshlrev_b32 v47, 7, v47
v_add3_u32 v4, v46, v47, s20
v_and_b32 v47, 1, v45
v_lshlrev_b32 v47, 3, v47
v_add_u32 v4, v4, v47
v_add_u32 v4, 1536, v4
s_mul_i32 s20, s14, 7168
v_lshlrev_b32 v46, 4, v44
v_lshlrev_b32 v47, 9, v45
v_add3_u32 v5, v46, v47, s20
v_lshrrev_b32 v47, 1, v45
v_lshlrev_b32 v47, 9, v47
v_add3_u32 v6, v46, v47, s20
v_and_b32 v47, 1, v45
v_lshlrev_b32 v47, 3, v47
v_add_u32 v6, v6, v47
v_add_u32 v6, 6144, v6
s_mul_i32 s20, s14, 3584
s_add_u32 s20, s20, 14336
v_lshrrev_b32 v46, 1, v45
v_lshlrev_b32 v46, 5, v46
v_lshl_add_u32 v46, v44, 3, v46
v_and_b32 v46, 127, v46
v_lshlrev_b32 v47, 7, v45
v_add3_u32 v7, v46, v47, s20
v_and_b32 v48, 3, v43
v_bfe_u32 v49, v43, 2, 2
v_and_b32 v46, 1, v45
v_lshlrev_b32 v46, 3, v46
v_add_u32 v46, v46, v49
v_lshlrev_b32 v46, 3, v46
v_lshrrev_b32 v47, 1, v48
v_lshl_add_u32 v46, v47, 5, v46
v_and_b32 v46, 127, v46
v_lshl_add_u32 v46, v48, 7, v46
v_lshrrev_b32 v47, 1, v45
v_lshl_add_u32 v46, v47, 9, v46
v_add_u32 v8, s20, v46
v_and_b32 v46, 1, v45
v_lshlrev_b32 v46, 3, v46
v_add_u32 v46, v46, v49
v_add_u32 v46, 4, v46
v_lshlrev_b32 v46, 3, v46
v_lshrrev_b32 v47, 1, v48
v_lshl_add_u32 v46, v47, 5, v46
v_and_b32 v46, 127, v46
v_lshl_add_u32 v46, v48, 7, v46
v_lshrrev_b32 v47, 1, v45
v_lshl_add_u32 v46, v47, 9, v46
v_add_u32 v9, s20, v46
v_lshlrev_b32 v46, 2, v45
v_sub_u32 v46, v44, v46
v_cmp_eq_u32 vcc, 0, v46
v_mov_b32 v47, 0x3f80
v_mov_b32 v48, 0
v_cndmask_b32 v14, v48, v47, vcc
v_cmp_eq_u32 vcc, 1, v46
v_mov_b32 v47, 0x3f800000
s_nop 0
v_cndmask_b32 v48, v48, v47, vcc
v_or_b32 v14, v14, v48
v_cmp_eq_u32 vcc, 2, v46
v_mov_b32 v47, 0x3f80
v_mov_b32 v48, 0
v_cndmask_b32 v15, v48, v47, vcc
v_cmp_eq_u32 vcc, 3, v46
v_mov_b32 v47, 0x3f800000
s_nop 0
v_cndmask_b32 v48, v48, v47, vcc
v_or_b32 v15, v15, v48
s_lshl_b32 s20, s14, 11
s_add_u32 s20, s20, 28672
v_and_b32 v46, 1, v45
v_lshlrev_b32 v46, 10, v46
v_lshrrev_b32 v47, 5, v43
v_lshl_add_u32 v48, v47, 4, v44
v_lshrrev_b32 v49, 2, v48
v_lshl_add_u32 v46, v49, 5, v46
v_and_b32 v49, 3, v48
v_lshl_add_u32 v49, v49, 2, v46
v_add_u32 v10, s20, v49
v_and_b32 v46, 1, v45
v_lshlrev_b32 v46, 2, v46
v_add_u32 v46, v46, v47
v_lshlrev_b32 v46, 8, v46
v_and_b32 v49, 7, v44
v_lshl_add_u32 v46, v49, 5, v46
v_lshrrev_b32 v49, 3, v44
v_lshl_add_u32 v46, v49, 2, v46
v_add_u32 v46, 16, v46
v_add_u32 v11, s20, v46
v_lshrrev_b32 v46, 3, v43
v_and_b32 v47, 7, v43
v_lshrrev_b32 v48, 1, v47
v_lshlrev_b32 v49, 7, v48
v_lshl_add_u32 v49, v46, 4, v49
v_and_b32 v44, 1, v47
v_lshl_add_u32 v0, v44, 3, v49
v_lshlrev_b32 v118, 1, v1
v_lshrrev_b32 v119, 3, v1
s_mov_b32 s66, 0x3db8aa3b
s_mov_b32 s12, 0
s_mov_b32 s16, 44040192
s_lshl_b32 s20, s13, 9
s_add_u32 s17, s20, 44498944
s_lshl_b32 s20, s13, 7
s_add_u32 s15, s20, 44507136
s_mov_b32 s18, 42205184
s_lshl_b32 s20, s13, 2
s_add_u32 s20, s20, s14
s_mul_i32 s20, s20, 7168
s_add_u32 s19, s20, 13303808
s_lshl_b32 s20, s13, 2
s_add_u32 s20, s20, s14
s_lshl_b32 s20, s20, 9
s_add_u32 s71, s20, 28672
s_waitcnt vmcnt(0)
s_cmp_lg_u32 s14, 0
s_cbranch_scc1 LA_ln_w
v_mov_b32 v44, 75019392
s_mov_b32 s28, 0
LA_ln_p:
buffer_load_dword v45, v44, s[4:7], 0 offen sc1
s_waitcnt vmcnt(0)
v_readfirstlane_b32 s20, v45
s_add_u32 s28, s28, 1
s_nop 1
s_cmp_ge_u32 s20, 256
s_cbranch_scc1 LA_ln_w
s_cmp_gt_u32 s28, 20000
s_cbranch_scc1 LA_ln_w
s_sleep 2
s_branch LA_ln_p
LA_ln_w:
s_barrier
buffer_load_dwordx4 v[84:87], v5, s[4:7], s18 offen offset:0 sc1
buffer_load_dwordx4 v[98:101], v5, s[4:7], s18 offen offset:256 sc1
buffer_load_dwordx4 v[88:91], v5, s[4:7], s18 offen offset:2048 sc1
buffer_load_dwordx4 v[102:105], v5, s[4:7], s18 offen offset:2304 sc1
s_add_u32 s20, s18, 4096
buffer_load_dwordx4 v[92:95], v5, s[4:7], s20 offen offset:0 sc1
buffer_load_dwordx4 v[106:109], v5, s[4:7], s20 offen offset:256 sc1
buffer_load_dwordx2 v[96:97], v6, s[4:7], s18 offen offset:0 sc1
buffer_load_dwordx2 v[110:111], v6, s[4:7], s18 offen offset:256 sc1
s_add_u32 s18, s18, 28672
s_cmp_eq_u32 s14, 1
s_cbranch_scc1 LA1_entry
s_cmp_eq_u32 s14, 2
s_cbranch_scc1 LA2_entry
s_cmp_eq_u32 s14, 3
s_cbranch_scc1 LA3_entry
LA0_entry:
s_mov_b32 s64, 44040192
s_mov_b32 s65, 44041216
LA0_loop:
v_mov_b64 v[16:17], 0
v_mov_b64 v[18:19], 0
v_mov_b64 v[20:21], 0
v_mov_b64 v[22:23], 0
v_mov_b64 v[24:25], 0
v_mov_b64 v[26:27], 0
v_mov_b64 v[28:29], 0
v_mov_b64 v[30:31], 0
v_mov_b64 v[32:33], 0
v_mov_b64 v[34:35], 0
v_mov_b64 v[36:37], 0
v_mov_b64 v[38:39], 0
v_mov_b64 v[40:41], 0
v_mov_b64 v[42:43], 0
s_mov_b32 s28, 0
buffer_load_dwordx4 v[64:67], v1, s[4:7], s64 offen sc1
buffer_load_dwordx4 v[68:71], v1, s[4:7], s65 offen sc1
LA0_pl:
buffer_load_dwordx4 v[72:75], v1, s[4:7], s64 offen sc1
buffer_load_dwordx4 v[76:79], v1, s[4:7], s65 offen sc1
s_waitcnt vmcnt(2)
ds_write_b128 v1, v[64:67] offset:0
ds_write_b128 v1, v[68:71] offset:1024
v_max3_u32 v80, v64, v65, v66
v_max3_u32 v81, v67, v68, v69
v_max3_u32 v80, v80, v70, v71
v_max_u32 v80, v80, v81
v_cmp_eq_u32 vcc, -1, v80
s_cbranch_vccz LA0_ok0
buffer_load_dwordx4 v[64:67], v1, s[4:7], s64 offen sc1
buffer_load_dwordx4 v[68:71], v1, s[4:7], s65 offen sc1
s_waitcnt vmcnt(2)
ds_write_b128 v1, v[72:75] offset:0
ds_write_b128 v1, v[76:79] offset:1024
v_max3_u32 v80, v72, v73, v74
v_max3_u32 v81, v75, v76, v77
v_max3_u32 v80, v80, v78, v79
v_max_u32 v80, v80, v81
v_cmp_eq_u32 vcc, -1, v80
s_cbranch_vccz LA0_ok1
s_add_u32 s28, s28, 1
s_cmp_lt_u32 s28, 20000
s_cbranch_scc1 LA0_pl
s_waitcnt vmcnt(0)
s_branch LA0_ok1
LA0_ok0:
v_smfmac_f32_16x16x64_bf16 v[16:19], v[64:67], a[0:7], v2
v_smfmac_f32_16x16x64_bf16 v[20:23], v[64:67], a[56:63], v2
v_smfmac_f32_16x16x64_bf16 v[24:27], v[64:67], a[112:119], v2
v_smfmac_f32_16x16x64_bf16 v[28:31], v[64:67], a[168:175], v2
s_waitcnt lgkmcnt(0)
s_barrier
ds_read_b128 v[44:47], v1 offset:2048
v_smfmac_f32_16x16x64_bf16 v[32:35], v[64:67], a[224:231], v2
ds_read_b128 v[48:51], v1 offset:3072
v_smfmac_f32_16x16x64_bf16 v[36:39], v[64:67], v[144:151], v2
ds_read_b128 v[52:55], v1 offset:4096
v_smfmac_f32_16x16x64_bf16 v[40:43], v[64:67], v[200:207], v2
ds_read_b128 v[56:59], v1 offset:5120
v_smfmac_f32_16x16x64_bf16 v[16:19], v[68:71], a[8:15], v2
ds_read_b128 v[60:63], v1 offset:6144
v_smfmac_f32_16x16x64_bf16 v[20:23], v[68:71], a[64:71], v2
v_smfmac_f32_16x16x64_bf16 v[24:27], v[68:71], a[120:127], v2
v_smfmac_f32_16x16x64_bf16 v[28:31], v[68:71], a[176:183], v2
v_smfmac_f32_16x16x64_bf16 v[32:35], v[68:71], a[232:239], v2
v_smfmac_f32_16x16x64_bf16 v[36:39], v[68:71], v[152:159], v2
v_smfmac_f32_16x16x64_bf16 v[40:43], v[68:71], v[208:215], v2
s_branch LA0_ph2
LA0_ok1:
v_smfmac_f32_16x16x64_bf16 v[16:19], v[72:75], a[0:7], v2
v_smfmac_f32_16x16x64_bf16 v[20:23], v[72:75], a[56:63], v2
v_smfmac_f32_16x16x64_bf16 v[24:27], v[72:75], a[112:119], v2
v_smfmac_f32_16x16x64_bf16 v[28:31], v[72:75], a[168:175], v2
s_waitcnt lgkmcnt(0)
s_barrier
ds_read_b128 v[44:47], v1 offset:2048
v_smfmac_f32_16x16x64_bf16 v[32:35], v[72:75], a[224:231], v2
ds_read_b128 v[48:51], v1 offset:3072
v_smfmac_f32_16x16x64_bf16 v[36:39], v[72:75], v[144:151], v2
ds_read_b128 v[52:55], v1 offset:4096
v_smfmac_f32_16x16x64_bf16 v[40:43], v[72:75], v[200:207], v2
ds_read_b128 v[56:59], v1 offset:5120
v_smfmac_f32_16x16x64_bf16 v[16:19], v[76:79], a[8:15], v2
ds_read_b128 v[60:63], v1 offset:6144
v_smfmac_f32_16x16x64_bf16 v[20:23], v[76:79], a[64:71], v2
v_smfmac_f32_16x16x64_bf16 v[24:27], v[76:79], a[120:127], v2
v_smfmac_f32_16x16x64_bf16 v[28:31], v[76:79], a[176:183], v2
v_smfmac_f32_16x16x64_bf16 v[32:35], v[76:79], a[232:239], v2
v_smfmac_f32_16x16x64_bf16 v[36:39], v[76:79], v[152:159], v2
v_smfmac_f32_16x16x64_bf16 v[40:43], v[76:79], v[208:215], v2
LA0_ph2:
s_waitcnt lgkmcnt(4)
v_smfmac_f32_16x16x64_bf16 v[16:19], v[44:47], a[16:23], v2
s_waitcnt lgkmcnt(3)
v_smfmac_f32_16x16x64_bf16 v[16:19], v[48:51], a[24:31], v2
s_waitcnt lgkmcnt(2)
v_smfmac_f32_16x16x64_bf16 v[16:19], v[52:55], a[32:39], v2
s_waitcnt lgkmcnt(1)
v_smfmac_f32_16x16x64_bf16 v[16:19], v[56:59], a[40:47], v2
ds_read_b128 v[112:115], v3 offset:0
s_waitcnt lgkmcnt(1)
v_smfmac_f32_16x16x64_bf16 v[16:19], v[60:63], a[48:55], v2
ds_read_b64 v[116:117], v4 offset:0
v_smfmac_f32_16x16x64_bf16 v[20:23], v[44:47], a[72:79], v2
v_smfmac_f32_16x16x64_bf16 v[20:23], v[48:51], a[80:87], v2
v_smfmac_f32_16x16x64_bf16 v[20:23], v[52:55], a[88:95], v2
v_cvt_pk_bf16_f32 v80, v16, v17
v_cvt_pk_bf16_f32 v81, v18, v19
v_smfmac_f32_16x16x64_bf16 v[20:23], v[56:59], a[96:103], v2
ds_write_b64 v7, v[80:81] offset:0
v_smfmac_f32_16x16x64_bf16 v[20:23], v[60:63], a[104:111], v2
v_smfmac_f32_16x16x64_bf16 v[24:27], v[44:47], a[128:135], v2
v_smfmac_f32_16x16x64_bf16 v[24:27], v[48:51], a[136:143], v2
v_smfmac_f32_16x16x64_bf16 v[24:27], v[52:55], a[144:151], v2
v_cvt_pk_bf16_f32 v82, v20, v21
v_cvt_pk_bf16_f32 v83, v22, v23
v_smfmac_f32_16x16x64_bf16 v[24:27], v[56:59], a[152:159], v2
ds_write_b64 v7, v[82:83] offset:512
s_waitcnt vmcnt(0)
v_smfmac_f32_16x16x64_bf16 v[24:27], v[60:63], a[160:167], v2
ds_read_b64_tr_b16 v[76:77], v8 offset:0
v_smfmac_f32_16x16x64_bf16 v[28:31], v[44:47], a[184:191], v2
ds_read_b64_tr_b16 v[78:79], v9 offset:0
v_smfmac_f32_16x16x64_bf16 v[28:31], v[48:51], a[192:199], v2
v_smfmac_f32_16x16x64_bf16 v[28:31], v[52:55], a[200:207], v2
v_cvt_pk_bf16_f32 v80, v24, v25
v_cvt_pk_bf16_f32 v81, v26, v27
v_smfmac_f32_16x16x64_bf16 v[28:31], v[56:59], a[208:215], v2
ds_write_b64 v7, v[80:81] offset:1024
v_smfmac_f32_16x16x64_bf16 v[28:31], v[60:63], a[216:223], v2
v_smfmac_f32_16x16x64_bf16 v[32:35], v[44:47], a[240:247], v2
s_waitcnt lgkmcnt(1)
v_mfma_f32_16x16x32_bf16 v[64:67], v[76:79], v[112:115], 0
ds_read_b128 v[112:115], v3 offset:512
v_smfmac_f32_16x16x64_bf16 v[32:35], v[48:51], a[248:255], v2
v_mfma_f32_16x16x32_bf16 v[68:71], v[76:79], v[84:87], 0
v_smfmac_f32_16x16x64_bf16 v[32:35], v[52:55], v[120:127], v2
v_cvt_pk_bf16_f32 v82, v28, v29
v_cvt_pk_bf16_f32 v83, v30, v31
v_smfmac_f32_16x16x64_bf16 v[32:35], v[56:59], v[128:135], v2
ds_write_b64 v7, v[82:83] offset:1536
v_mfma_f32_16x16x32_bf16 v[72:75], v[76:79], v[98:101], 0
buffer_load_dwordx4 v[84:87], v5, s[4:7], s18 offen offset:0 sc1
buffer_load_dwordx4 v[98:101], v5, s[4:7], s18 offen offset:256 sc1
v_smfmac_f32_16x16x64_bf16 v[32:35], v[60:63], v[136:143], v2
ds_read_b64_tr_b16 v[76:77], v8 offset:1024
v_smfmac_f32_16x16x64_bf16 v[36:39], v[44:47], v[160:167], v2
ds_read_b64_tr_b16 v[78:79], v9 offset:1024
v_smfmac_f32_16x16x64_bf16 v[36:39], v[48:51], v[168:175], v2
v_smfmac_f32_16x16x64_bf16 v[36:39], v[52:55], v[176:183], v2
v_cvt_pk_bf16_f32 v80, v32, v33
v_cvt_pk_bf16_f32 v81, v34, v35
v_smfmac_f32_16x16x64_bf16 v[36:39], v[56:59], v[184:191], v2
ds_write_b64 v7, v[80:81] offset:2048
v_smfmac_f32_16x16x64_bf16 v[36:39], v[60:63], v[192:199], v2
v_smfmac_f32_16x16x64_bf16 v[40:43], v[44:47], v[216:223], v2
s_waitcnt lgkmcnt(1)
v_mfma_f32_16x16x32_bf16 v[64:67], v[76:79], v[112:115], v[64:67]
ds_read_b128 v[112:115], v3 offset:1024
v_smfmac_f32_16x16x64_bf16 v[40:43], v[48:51], v[224:231], v2
v_mfma_f32_16x16x32_bf16 v[68:71], v[76:79], v[88:91], v[68:71]
v_smfmac_f32_16x16x64_bf16 v[40:43], v[52:55], v[232:239], v2
v_cvt_pk_bf16_f32 v82, v36, v37
v_cvt_pk_bf16_f32 v83, v38, v39
v_smfmac_f32_16x16x64_bf16 v[40:43], v[56:59], v[240:247], v2
ds_write_b64 v7, v[82:83] offset:2560
v_mfma_f32_16x16x32_bf16 v[72:75], v[76:79], v[102:105], v[72:75]
buffer_load_dwordx4 v[88:91], v5, s[4:7], s18 offen offset:2048 sc1
buffer_load_dwordx4 v[102:105], v5, s[4:7], s18 offen offset:2304 sc1
v_smfmac_f32_16x16x64_bf16 v[40:43], v[60:63], v[248:255], v2
ds_read_b64_tr_b16 v[76:77], v8 offset:2048
ds_read_b64_tr_b16 v[78:79], v9 offset:2048
s_nop 5
v_cvt_pk_bf16_f32 v80, v40, v41
v_cvt_pk_bf16_f32 v81, v42, v43
s_nop 1
v_mfma_f32_16x16x16_bf16 v[36:39], v[80:81], v[14:15], 0
s_waitcnt lgkmcnt(0)
v_mfma_f32_16x16x32_bf16 v[64:67], v[76:79], v[112:115], v[64:67]
v_mfma_f32_16x16x32_bf16 v[68:71], v[76:79], v[92:95], v[68:71]
v_mfma_f32_16x16x32_bf16 v[72:75], v[76:79], v[106:109], v[72:75]
v_cvt_pk_bf16_f32 v82, v36, v37
v_cvt_pk_bf16_f32 v83, v38, v39
s_nop 1
v_mfma_f32_16x16x16_bf16 v[64:67], v[82:83], v[116:117], v[64:67]
v_mfma_f32_16x16x16_bf16 v[68:71], v[82:83], v[96:97], v[68:71]
v_mfma_f32_16x16x16_bf16 v[72:75], v[82:83], v[110:111], v[72:75]
s_nop 5
v_permlane32_swap_b32 v64, v65
v_permlane32_swap_b32 v66, v67
v_add_f32 v64, v64, v65
v_add_f32 v66, v66, v67
ds_write_b32 v11, v64
ds_write_b32 v11, v66 offset:512
v_permlane32_swap_b32 v68, v72
v_permlane32_swap_b32 v69, v73
v_permlane32_swap_b32 v70, v74
v_permlane32_swap_b32 v71, v75
v_add_f32 v68, v68, v72
ds_write_b32 v10, v68 offset:0
v_add_f32 v69, v69, v73
ds_write_b32 v10, v69 offset:256
v_add_f32 v70, v70, v74
ds_write_b32 v10, v70 offset:512
v_add_f32 v71, v71, v75
ds_write_b32 v10, v71 offset:768
s_waitcnt lgkmcnt(0)
s_barrier
ds_read_b128 v[44:47], v118 offset:28672
ds_read_b32 v60, v118 offset:28688
ds_read_b128 v[48:51], v118 offset:30720
ds_read_b32 v61, v118 offset:30736
ds_read_b128 v[52:55], v118 offset:32768
ds_read_b32 v62, v118 offset:32784
ds_read_b128 v[56:59], v118 offset:34816
ds_read_b32 v63, v118 offset:34832
s_waitcnt lgkmcnt(4)
v_pk_add_f32 v[44:45], v[44:45], v[48:49]
v_pk_add_f32 v[46:47], v[46:47], v[50:51]
v_add_f32 v60, v60, v61
s_waitcnt lgkmcnt(0)
v_pk_add_f32 v[52:53], v[52:53], v[56:57]
v_pk_add_f32 v[54:55], v[54:55], v[58:59]
v_add_f32 v62, v62, v63
v_pk_add_f32 v[44:45], v[44:45], v[52:53]
v_pk_add_f32 v[46:47], v[46:47], v[54:55]
v_add_f32 v60, v60, v62
v_max3_f32 v20, v44, v45, v46
v_max3_f32 v20, v20, v47, v60
s_nop 1
v_max_f32_dpp v20, v20, v20 quad_perm:[1,0,3,2] row_mask:0xf bank_mask:0xf
s_nop 1
v_max_f32_dpp v20, v20, v20 quad_perm:[2,3,0,1] row_mask:0xf bank_mask:0xf
s_nop 1
v_max_f32_dpp v20, v20, v20 row_half_mirror row_mask:0xf bank_mask:0xf
v_pk_add_f32 v[44:45], v[44:45], v[20:21] op_sel_hi:[1,0] neg_lo:[0,1] neg_hi:[0,1]
v_pk_add_f32 v[46:47], v[46:47], v[20:21] op_sel_hi:[1,0] neg_lo:[0,1] neg_hi:[0,1]
v_sub_f32 v60, v60, v20
v_exp_f32 v44, v44
v_exp_f32 v45, v45
v_exp_f32 v46, v46
v_exp_f32 v47, v47
v_exp_f32 v60, v60
v_add_f32 v20, v44, v45
v_add_f32 v21, v46, v47
v_add_f32 v20, v20, v60
v_add_f32 v20, v20, v21
s_nop 1
v_add_f32_dpp v20, v20, v20 quad_perm:[1,0,3,2] row_mask:0xf bank_mask:0xf
s_nop 1
v_add_f32_dpp v20, v20, v20 quad_perm:[2,3,0,1] row_mask:0xf bank_mask:0xf
s_nop 1
v_add_f32_dpp v20, v20, v20 row_half_mirror row_mask:0xf bank_mask:0xf
v_rcp_f32 v20, v20
s_nop 0
v_pk_mul_f32 v[44:45], v[44:45], v[20:21] op_sel_hi:[1,0]
v_pk_mul_f32 v[46:47], v[46:47], v[20:21] op_sel_hi:[1,0]
v_cvt_pk_bf16_f32 v48, |v44|, |v45|
v_cvt_pk_bf16_f32 v49, |v46|, |v47|
v_mul_f32 v60, v60, v20
buffer_store_dwordx2 v[48:49], v0, s[4:7], s17 offen
v_cvt_pk_bf16_f32 v50, |v60|, |v60|
buffer_store_short v50, v119, s[4:7], s15 offen
s_add_u32 s20, s18, 4096
buffer_load_dwordx4 v[92:95], v5, s[4:7], s20 offen offset:0 sc1
buffer_load_dwordx4 v[106:109], v5, s[4:7], s20 offen offset:256 sc1
buffer_load_dwordx2 v[96:97], v6, s[4:7], s18 offen offset:0 sc1
buffer_load_dwordx2 v[110:111], v6, s[4:7], s18 offen offset:256 sc1
s_sleep 8
s_add_u32 s18, s18, 28672
s_add_u32 s12, s12, 1
s_add_u32 s64, s64, 7168
s_add_u32 s65, s65, 7168
s_add_u32 s17, s17, 10240
s_add_u32 s15, s15, 10240
s_cmp_lt_u32 s12, 63
s_cbranch_scc1 LA0_loop
s_branch LA_fin
LA1_entry:
s_mov_b32 s64, 44042240
s_mov_b32 s65, 44043264
LA1_loop:
v_mov_b64 v[16:17], 0
v_mov_b64 v[18:19], 0
v_mov_b64 v[20:21], 0
v_mov_b64 v[22:23], 0
v_mov_b64 v[24:25], 0
v_mov_b64 v[26:27], 0
v_mov_b64 v[28:29], 0
v_mov_b64 v[30:31], 0
v_mov_b64 v[32:33], 0
v_mov_b64 v[34:35], 0
v_mov_b64 v[36:37], 0
v_mov_b64 v[38:39], 0
v_mov_b64 v[40:41], 0
v_mov_b64 v[42:43], 0
s_mov_b32 s28, 0
buffer_load_dwordx4 v[64:67], v1, s[4:7], s64 offen sc1
buffer_load_dwordx4 v[68:71], v1, s[4:7], s65 offen sc1
LA1_pl:
buffer_load_dwordx4 v[72:75], v1, s[4:7], s64 offen sc1
buffer_load_dwordx4 v[76:79], v1, s[4:7], s65 offen sc1
s_waitcnt vmcnt(2)
ds_write_b128 v1, v[64:67] offset:2048
ds_write_b128 v1, v[68:71] offset:3072
v_max3_u32 v80, v64, v65, v66
v_max3_u32 v81, v67, v68, v69
v_max3_u32 v80, v80, v70, v71
v_max_u32 v80, v80, v81
v_cmp_eq_u32 vcc, -1, v80
s_cbranch_vccz LA1_ok0
buffer_load_dwordx4 v[64:67], v1, s[4:7], s64 offen sc1
buffer_load_dwordx4 v[68:71], v1, s[4:7], s65 offen sc1
s_waitcnt vmcnt(2)
ds_write_b128 v1, v[72:75] offset:2048
ds_write_b128 v1, v[76:79] offset:3072
v_max3_u32 v80, v72, v73, v74
v_max3_u32 v81, v75, v76, v77
v_max3_u32 v80, v80, v78, v79
v_max_u32 v80, v80, v81
v_cmp_eq_u32 vcc, -1, v80
s_cbranch_vccz LA1_ok1
s_add_u32 s28, s28, 1
s_cmp_lt_u32 s28, 20000
s_cbranch_scc1 LA1_pl
s_waitcnt vmcnt(0)
s_branch LA1_ok1
LA1_ok0:
v_smfmac_f32_16x16x64_bf16 v[16:19], v[64:67], a[16:23], v2
v_smfmac_f32_16x16x64_bf16 v[20:23], v[64:67], a[72:79], v2
v_smfmac_f32_16x16x64_bf16 v[24:27], v[64:67], a[128:135], v2
v_smfmac_f32_16x16x64_bf16 v[28:31], v[64:67], a[184:191], v2
s_waitcnt lgkmcnt(0)
s_barrier
ds_read_b128 v[44:47], v1 offset:0
v_smfmac_f32_16x16x64_bf16 v[32:35], v[64:67], a[240:247], v2
ds_read_b128 v[48:51], v1 offset:1024
v_smfmac_f32_16x16x64_bf16 v[36:39], v[64:67], v[160:167], v2
ds_read_b128 v[52:55], v1 offset:4096
v_smfmac_f32_16x16x64_bf16 v[40:43], v[64:67], v[216:223], v2
ds_read_b128 v[56:59], v1 offset:5120
v_smfmac_f32_16x16x64_bf16 v[16:19], v[68:71], a[24:31], v2
ds_read_b128 v[60:63], v1 offset:6144
v_smfmac_f32_16x16x64_bf16 v[20:23], v[68:71], a[80:87], v2
v_smfmac_f32_16x16x64_bf16 v[24:27], v[68:71], a[136:143], v2
v_smfmac_f32_16x16x64_bf16 v[28:31], v[68:71], a[192:199], v2
v_smfmac_f32_16x16x64_bf16 v[32:35], v[68:71], a[248:255], v2
v_smfmac_f32_16x16x64_bf16 v[36:39], v[68:71], v[168:175], v2
v_smfmac_f32_16x16x64_bf16 v[40:43], v[68:71], v[224:231], v2
s_branch LA1_ph2
LA1_ok1:
v_smfmac_f32_16x16x64_bf16 v[16:19], v[72:75], a[16:23], v2
v_smfmac_f32_16x16x64_bf16 v[20:23], v[72:75], a[72:79], v2
v_smfmac_f32_16x16x64_bf16 v[24:27], v[72:75], a[128:135], v2
v_smfmac_f32_16x16x64_bf16 v[28:31], v[72:75], a[184:191], v2
s_waitcnt lgkmcnt(0)
s_barrier
ds_read_b128 v[44:47], v1 offset:0
v_smfmac_f32_16x16x64_bf16 v[32:35], v[72:75], a[240:247], v2
ds_read_b128 v[48:51], v1 offset:1024
v_smfmac_f32_16x16x64_bf16 v[36:39], v[72:75], v[160:167], v2
ds_read_b128 v[52:55], v1 offset:4096
v_smfmac_f32_16x16x64_bf16 v[40:43], v[72:75], v[216:223], v2
ds_read_b128 v[56:59], v1 offset:5120
v_smfmac_f32_16x16x64_bf16 v[16:19], v[76:79], a[24:31], v2
ds_read_b128 v[60:63], v1 offset:6144
v_smfmac_f32_16x16x64_bf16 v[20:23], v[76:79], a[80:87], v2
v_smfmac_f32_16x16x64_bf16 v[24:27], v[76:79], a[136:143], v2
v_smfmac_f32_16x16x64_bf16 v[28:31], v[76:79], a[192:199], v2
v_smfmac_f32_16x16x64_bf16 v[32:35], v[76:79], a[248:255], v2
v_smfmac_f32_16x16x64_bf16 v[36:39], v[76:79], v[168:175], v2
v_smfmac_f32_16x16x64_bf16 v[40:43], v[76:79], v[224:231], v2
LA1_ph2:
s_waitcnt lgkmcnt(4)
v_smfmac_f32_16x16x64_bf16 v[16:19], v[44:47], a[0:7], v2
s_waitcnt lgkmcnt(3)
v_smfmac_f32_16x16x64_bf16 v[16:19], v[48:51], a[8:15], v2
s_waitcnt lgkmcnt(2)
v_smfmac_f32_16x16x64_bf16 v[16:19], v[52:55], a[32:39], v2
s_waitcnt lgkmcnt(1)
v_smfmac_f32_16x16x64_bf16 v[16:19], v[56:59], a[40:47], v2
ds_read_b128 v[112:115], v3 offset:0
s_waitcnt lgkmcnt(1)
v_smfmac_f32_16x16x64_bf16 v[16:19], v[60:63], a[48:55], v2
ds_read_b64 v[116:117], v4 offset:0
v_smfmac_f32_16x16x64_bf16 v[20:23], v[44:47], a[56:63], v2
v_smfmac_f32_16x16x64_bf16 v[20:23], v[48:51], a[64:71], v2
v_smfmac_f32_16x16x64_bf16 v[20:23], v[52:55], a[88:95], v2
v_cvt_pk_bf16_f32 v80, v16, v17
v_cvt_pk_bf16_f32 v81, v18, v19
v_smfmac_f32_16x16x64_bf16 v[20:23], v[56:59], a[96:103], v2
ds_write_b64 v7, v[80:81] offset:0
v_smfmac_f32_16x16x64_bf16 v[20:23], v[60:63], a[104:111], v2
v_smfmac_f32_16x16x64_bf16 v[24:27], v[44:47], a[112:119], v2
v_smfmac_f32_16x16x64_bf16 v[24:27], v[48:51], a[120:127], v2
v_smfmac_f32_16x16x64_bf16 v[24:27], v[52:55], a[144:151], v2
v_cvt_pk_bf16_f32 v82, v20, v21
v_cvt_pk_bf16_f32 v83, v22, v23
v_smfmac_f32_16x16x64_bf16 v[24:27], v[56:59], a[152:159], v2
ds_write_b64 v7, v[82:83] offset:512
s_waitcnt vmcnt(0)
v_smfmac_f32_16x16x64_bf16 v[24:27], v[60:63], a[160:167], v2
ds_read_b64_tr_b16 v[76:77], v8 offset:0
v_smfmac_f32_16x16x64_bf16 v[28:31], v[44:47], a[168:175], v2
ds_read_b64_tr_b16 v[78:79], v9 offset:0
v_smfmac_f32_16x16x64_bf16 v[28:31], v[48:51], a[176:183], v2
v_smfmac_f32_16x16x64_bf16 v[28:31], v[52:55], a[200:207], v2
v_cvt_pk_bf16_f32 v80, v24, v25
v_cvt_pk_bf16_f32 v81, v26, v27
v_smfmac_f32_16x16x64_bf16 v[28:31], v[56:59], a[208:215], v2
ds_write_b64 v7, v[80:81] offset:1024
v_smfmac_f32_16x16x64_bf16 v[28:31], v[60:63], a[216:223], v2
v_smfmac_f32_16x16x64_bf16 v[32:35], v[44:47], a[224:231], v2
s_waitcnt lgkmcnt(1)
v_mfma_f32_16x16x32_bf16 v[64:67], v[76:79], v[112:115], 0
ds_read_b128 v[112:115], v3 offset:512
v_smfmac_f32_16x16x64_bf16 v[32:35], v[48:51], a[232:239], v2
v_mfma_f32_16x16x32_bf16 v[68:71], v[76:79], v[84:87], 0
v_smfmac_f32_16x16x64_bf16 v[32:35], v[52:55], v[120:127], v2
v_cvt_pk_bf16_f32 v82, v28, v29
v_cvt_pk_bf16_f32 v83, v30, v31
v_smfmac_f32_16x16x64_bf16 v[32:35], v[56:59], v[128:135], v2
ds_write_b64 v7, v[82:83] offset:1536
v_mfma_f32_16x16x32_bf16 v[72:75], v[76:79], v[98:101], 0
buffer_load_dwordx4 v[84:87], v5, s[4:7], s18 offen offset:0 sc1
buffer_load_dwordx4 v[98:101], v5, s[4:7], s18 offen offset:256 sc1
v_smfmac_f32_16x16x64_bf16 v[32:35], v[60:63], v[136:143], v2
ds_read_b64_tr_b16 v[76:77], v8 offset:1024
v_smfmac_f32_16x16x64_bf16 v[36:39], v[44:47], v[144:151], v2
ds_read_b64_tr_b16 v[78:79], v9 offset:1024
v_smfmac_f32_16x16x64_bf16 v[36:39], v[48:51], v[152:159], v2
v_smfmac_f32_16x16x64_bf16 v[36:39], v[52:55], v[176:183], v2
v_cvt_pk_bf16_f32 v80, v32, v33
v_cvt_pk_bf16_f32 v81, v34, v35
v_smfmac_f32_16x16x64_bf16 v[36:39], v[56:59], v[184:191], v2
ds_write_b64 v7, v[80:81] offset:2048
v_smfmac_f32_16x16x64_bf16 v[36:39], v[60:63], v[192:199], v2
v_smfmac_f32_16x16x64_bf16 v[40:43], v[44:47], v[200:207], v2
s_waitcnt lgkmcnt(1)
v_mfma_f32_16x16x32_bf16 v[64:67], v[76:79], v[112:115], v[64:67]
ds_read_b128 v[112:115], v3 offset:1024
v_smfmac_f32_16x16x64_bf16 v[40:43], v[48:51], v[208:215], v2
v_mfma_f32_16x16x32_bf16 v[68:71], v[76:79], v[88:91], v[68:71]
v_smfmac_f32_16x16x64_bf16 v[40:43], v[52:55], v[232:239], v2
v_cvt_pk_bf16_f32 v82, v36, v37
v_cvt_pk_bf16_f32 v83, v38, v39
v_smfmac_f32_16x16x64_bf16 v[40:43], v[56:59], v[240:247], v2
ds_write_b64 v7, v[82:83] offset:2560
v_mfma_f32_16x16x32_bf16 v[72:75], v[76:79], v[102:105], v[72:75]
buffer_load_dwordx4 v[88:91], v5, s[4:7], s18 offen offset:2048 sc1
buffer_load_dwordx4 v[102:105], v5, s[4:7], s18 offen offset:2304 sc1
v_smfmac_f32_16x16x64_bf16 v[40:43], v[60:63], v[248:255], v2
ds_read_b64_tr_b16 v[76:77], v8 offset:2048
ds_read_b64_tr_b16 v[78:79], v9 offset:2048
s_nop 5
v_cvt_pk_bf16_f32 v80, v40, v41
v_cvt_pk_bf16_f32 v81, v42, v43
s_nop 1
v_mfma_f32_16x16x16_bf16 v[36:39], v[80:81], v[14:15], 0
s_waitcnt lgkmcnt(0)
v_mfma_f32_16x16x32_bf16 v[64:67], v[76:79], v[112:115], v[64:67]
v_mfma_f32_16x16x32_bf16 v[68:71], v[76:79], v[92:95], v[68:71]
v_mfma_f32_16x16x32_bf16 v[72:75], v[76:79], v[106:109], v[72:75]
v_cvt_pk_bf16_f32 v82, v36, v37
v_cvt_pk_bf16_f32 v83, v38, v39
s_nop 1
v_mfma_f32_16x16x16_bf16 v[64:67], v[82:83], v[116:117], v[64:67]
v_mfma_f32_16x16x16_bf16 v[68:71], v[82:83], v[96:97], v[68:71]
v_mfma_f32_16x16x16_bf16 v[72:75], v[82:83], v[110:111], v[72:75]
s_nop 5
v_permlane32_swap_b32 v64, v65
v_permlane32_swap_b32 v66, v67
v_add_f32 v64, v64, v65
v_add_f32 v66, v66, v67
ds_write_b32 v11, v64
ds_write_b32 v11, v66 offset:512
v_permlane32_swap_b32 v68, v72
v_permlane32_swap_b32 v69, v73
v_permlane32_swap_b32 v70, v74
v_permlane32_swap_b32 v71, v75
v_add_f32 v68, v68, v72
ds_write_b32 v10, v68 offset:0
v_add_f32 v69, v69, v73
ds_write_b32 v10, v69 offset:256
v_add_f32 v70, v70, v74
ds_write_b32 v10, v70 offset:512
v_add_f32 v71, v71, v75
ds_write_b32 v10, v71 offset:768
s_waitcnt lgkmcnt(0)
s_barrier
s_add_u32 s20, s18, 4096
buffer_load_dwordx4 v[92:95], v5, s[4:7], s20 offen offset:0 sc1
buffer_load_dwordx4 v[106:109], v5, s[4:7], s20 offen offset:256 sc1
buffer_load_dwordx2 v[96:97], v6, s[4:7], s18 offen offset:0 sc1
buffer_load_dwordx2 v[110:111], v6, s[4:7], s18 offen offset:256 sc1
s_sleep 14
s_add_u32 s18, s18, 28672
s_add_u32 s12, s12, 1
s_add_u32 s64, s64, 7168
s_add_u32 s65, s65, 7168
s_add_u32 s17, s17, 10240
s_add_u32 s15, s15, 10240
s_cmp_lt_u32 s12, 63
s_cbranch_scc1 LA1_loop
s_branch LA_fin
LA2_entry:
s_mov_b32 s64, 44045312
s_mov_b32 s65, 44046336
LA2_loop:
v_mov_b64 v[16:17], 0
v_mov_b64 v[18:19], 0
v_mov_b64 v[20:21], 0
v_mov_b64 v[22:23], 0
v_mov_b64 v[24:25], 0
v_mov_b64 v[26:27], 0
v_mov_b64 v[28:29], 0
v_mov_b64 v[30:31], 0
v_mov_b64 v[32:33], 0
v_mov_b64 v[34:35], 0
v_mov_b64 v[36:37], 0
v_mov_b64 v[38:39], 0
v_mov_b64 v[40:41], 0
v_mov_b64 v[42:43], 0
s_mov_b32 s28, 0
buffer_load_dwordx4 v[64:67], v1, s[4:7], s64 offen sc1
buffer_load_dwordx4 v[68:71], v1, s[4:7], s65 offen sc1
LA2_pl:
buffer_load_dwordx4 v[72:75], v1, s[4:7], s64 offen sc1
buffer_load_dwordx4 v[76:79], v1, s[4:7], s65 offen sc1
s_waitcnt vmcnt(2)
ds_write_b128 v1, v[64:67] offset:5120
ds_write_b128 v1, v[68:71] offset:6144
v_max3_u32 v80, v64, v65, v66
v_max3_u32 v81, v67, v68, v69
v_max3_u32 v80, v80, v70, v71
v_max_u32 v80, v80, v81
v_cmp_eq_u32 vcc, -1, v80
s_cbranch_vccz LA2_ok0
buffer_load_dwordx4 v[64:67], v1, s[4:7], s64 offen sc1
buffer_load_dwordx4 v[68:71], v1, s[4:7], s65 offen sc1
s_waitcnt vmcnt(2)
ds_write_b128 v1, v[72:75] offset:5120
ds_write_b128 v1, v[76:79] offset:6144
v_max3_u32 v80, v72, v73, v74
v_max3_u32 v81, v75, v76, v77
v_max3_u32 v80, v80, v78, v79
v_max_u32 v80, v80, v81
v_cmp_eq_u32 vcc, -1, v80
s_cbranch_vccz LA2_ok1
s_add_u32 s28, s28, 1
s_cmp_lt_u32 s28, 20000
s_cbranch_scc1 LA2_pl
s_waitcnt vmcnt(0)
s_branch LA2_ok1
LA2_ok0:
v_smfmac_f32_16x16x64_bf16 v[16:19], v[64:67], a[40:47], v2
v_smfmac_f32_16x16x64_bf16 v[20:23], v[64:67], a[96:103], v2
v_smfmac_f32_16x16x64_bf16 v[24:27], v[64:67], a[152:159], v2
v_smfmac_f32_16x16x64_bf16 v[28:31], v[64:67], a[208:215], v2
s_waitcnt lgkmcnt(0)
s_barrier
ds_read_b128 v[44:47], v1 offset:0
v_smfmac_f32_16x16x64_bf16 v[32:35], v[64:67], v[128:135], v2
ds_read_b128 v[48:51], v1 offset:1024
v_smfmac_f32_16x16x64_bf16 v[36:39], v[64:67], v[184:191], v2
ds_read_b128 v[52:55], v1 offset:2048
v_smfmac_f32_16x16x64_bf16 v[40:43], v[64:67], v[240:247], v2
ds_read_b128 v[56:59], v1 offset:3072
v_smfmac_f32_16x16x64_bf16 v[16:19], v[68:71], a[48:55], v2
ds_read_b128 v[60:63], v1 offset:4096
v_smfmac_f32_16x16x64_bf16 v[20:23], v[68:71], a[104:111], v2
v_smfmac_f32_16x16x64_bf16 v[24:27], v[68:71], a[160:167], v2
v_smfmac_f32_16x16x64_bf16 v[28:31], v[68:71], a[216:223], v2
v_smfmac_f32_16x16x64_bf16 v[32:35], v[68:71], v[136:143], v2
v_smfmac_f32_16x16x64_bf16 v[36:39], v[68:71], v[192:199], v2
v_smfmac_f32_16x16x64_bf16 v[40:43], v[68:71], v[248:255], v2
s_branch LA2_ph2
LA2_ok1:
v_smfmac_f32_16x16x64_bf16 v[16:19], v[72:75], a[40:47], v2
v_smfmac_f32_16x16x64_bf16 v[20:23], v[72:75], a[96:103], v2
v_smfmac_f32_16x16x64_bf16 v[24:27], v[72:75], a[152:159], v2
v_smfmac_f32_16x16x64_bf16 v[28:31], v[72:75], a[208:215], v2
s_waitcnt lgkmcnt(0)
s_barrier
ds_read_b128 v[44:47], v1 offset:0
v_smfmac_f32_16x16x64_bf16 v[32:35], v[72:75], v[128:135], v2
ds_read_b128 v[48:51], v1 offset:1024
v_smfmac_f32_16x16x64_bf16 v[36:39], v[72:75], v[184:191], v2
ds_read_b128 v[52:55], v1 offset:2048
v_smfmac_f32_16x16x64_bf16 v[40:43], v[72:75], v[240:247], v2
ds_read_b128 v[56:59], v1 offset:3072
v_smfmac_f32_16x16x64_bf16 v[16:19], v[76:79], a[48:55], v2
ds_read_b128 v[60:63], v1 offset:4096
v_smfmac_f32_16x16x64_bf16 v[20:23], v[76:79], a[104:111], v2
v_smfmac_f32_16x16x64_bf16 v[24:27], v[76:79], a[160:167], v2
v_smfmac_f32_16x16x64_bf16 v[28:31], v[76:79], a[216:223], v2
v_smfmac_f32_16x16x64_bf16 v[32:35], v[76:79], v[136:143], v2
v_smfmac_f32_16x16x64_bf16 v[36:39], v[76:79], v[192:199], v2
v_smfmac_f32_16x16x64_bf16 v[40:43], v[76:79], v[248:255], v2
LA2_ph2:
s_waitcnt lgkmcnt(4)
v_smfmac_f32_16x16x64_bf16 v[16:19], v[44:47], a[0:7], v2
s_waitcnt lgkmcnt(3)
v_smfmac_f32_16x16x64_bf16 v[16:19], v[48:51], a[8:15], v2
s_waitcnt lgkmcnt(2)
v_smfmac_f32_16x16x64_bf16 v[16:19], v[52:55], a[16:23], v2
s_waitcnt lgkmcnt(1)
v_smfmac_f32_16x16x64_bf16 v[16:19], v[56:59], a[24:31], v2
ds_read_b128 v[112:115], v3 offset:0
s_waitcnt lgkmcnt(1)
v_smfmac_f32_16x16x64_bf16 v[16:19], v[60:63], a[32:39], v2
ds_read_b64 v[116:117], v4 offset:0
v_smfmac_f32_16x16x64_bf16 v[20:23], v[44:47], a[56:63], v2
v_smfmac_f32_16x16x64_bf16 v[20:23], v[48:51], a[64:71], v2
v_smfmac_f32_16x16x64_bf16 v[20:23], v[52:55], a[72:79], v2
v_cvt_pk_bf16_f32 v80, v16, v17
v_cvt_pk_bf16_f32 v81, v18, v19
v_smfmac_f32_16x16x64_bf16 v[20:23], v[56:59], a[80:87], v2
ds_write_b64 v7, v[80:81] offset:0
v_smfmac_f32_16x16x64_bf16 v[20:23], v[60:63], a[88:95], v2
v_smfmac_f32_16x16x64_bf16 v[24:27], v[44:47], a[112:119], v2
v_smfmac_f32_16x16x64_bf16 v[24:27], v[48:51], a[120:127], v2
v_smfmac_f32_16x16x64_bf16 v[24:27], v[52:55], a[128:135], v2
v_cvt_pk_bf16_f32 v82, v20, v21
v_cvt_pk_bf16_f32 v83, v22, v23
v_smfmac_f32_16x16x64_bf16 v[24:27], v[56:59], a[136:143], v2
ds_write_b64 v7, v[82:83] offset:512
s_waitcnt vmcnt(0)
v_smfmac_f32_16x16x64_bf16 v[24:27], v[60:63], a[144:151], v2
ds_read_b64_tr_b16 v[76:77], v8 offset:0
v_smfmac_f32_16x16x64_bf16 v[28:31], v[44:47], a[168:175], v2
ds_read_b64_tr_b16 v[78:79], v9 offset:0
v_smfmac_f32_16x16x64_bf16 v[28:31], v[48:51], a[176:183], v2
v_smfmac_f32_16x16x64_bf16 v[28:31], v[52:55], a[184:191], v2
v_cvt_pk_bf16_f32 v80, v24, v25
v_cvt_pk_bf16_f32 v81, v26, v27
v_smfmac_f32_16x16x64_bf16 v[28:31], v[56:59], a[192:199], v2
ds_write_b64 v7, v[80:81] offset:1024
v_smfmac_f32_16x16x64_bf16 v[28:31], v[60:63], a[200:207], v2
v_smfmac_f32_16x16x64_bf16 v[32:35], v[44:47], a[224:231], v2
s_waitcnt lgkmcnt(1)
v_mfma_f32_16x16x32_bf16 v[64:67], v[76:79], v[112:115], 0
ds_read_b128 v[112:115], v3 offset:512
v_smfmac_f32_16x16x64_bf16 v[32:35], v[48:51], a[232:239], v2
v_mfma_f32_16x16x32_bf16 v[68:71], v[76:79], v[84:87], 0
v_smfmac_f32_16x16x64_bf16 v[32:35], v[52:55], a[240:247], v2
v_cvt_pk_bf16_f32 v82, v28, v29
v_cvt_pk_bf16_f32 v83, v30, v31
v_smfmac_f32_16x16x64_bf16 v[32:35], v[56:59], a[248:255], v2
ds_write_b64 v7, v[82:83] offset:1536
v_mfma_f32_16x16x32_bf16 v[72:75], v[76:79], v[98:101], 0
buffer_load_dwordx4 v[84:87], v5, s[4:7], s18 offen offset:0 sc1
buffer_load_dwordx4 v[98:101], v5, s[4:7], s18 offen offset:256 sc1
v_smfmac_f32_16x16x64_bf16 v[32:35], v[60:63], v[120:127], v2
ds_read_b64_tr_b16 v[76:77], v8 offset:1024
v_smfmac_f32_16x16x64_bf16 v[36:39], v[44:47], v[144:151], v2
ds_read_b64_tr_b16 v[78:79], v9 offset:1024
v_smfmac_f32_16x16x64_bf16 v[36:39], v[48:51], v[152:159], v2
v_smfmac_f32_16x16x64_bf16 v[36:39], v[52:55], v[160:167], v2
v_cvt_pk_bf16_f32 v80, v32, v33
v_cvt_pk_bf16_f32 v81, v34, v35
v_smfmac_f32_16x16x64_bf16 v[36:39], v[56:59], v[168:175], v2
ds_write_b64 v7, v[80:81] offset:2048
v_smfmac_f32_16x16x64_bf16 v[36:39], v[60:63], v[176:183], v2
v_smfmac_f32_16x16x64_bf16 v[40:43], v[44:47], v[200:207], v2
s_waitcnt lgkmcnt(1)
v_mfma_f32_16x16x32_bf16 v[64:67], v[76:79], v[112:115], v[64:67]
ds_read_b128 v[112:115], v3 offset:1024
v_smfmac_f32_16x16x64_bf16 v[40:43], v[48:51], v[208:215], v2
v_mfma_f32_16x16x32_bf16 v[68:71], v[76:79], v[88:91], v[68:71]
v_smfmac_f32_16x16x64_bf16 v[40:43], v[52:55], v[216:223], v2
v_cvt_pk_bf16_f32 v82, v36, v37
v_cvt_pk_bf16_f32 v83, v38, v39
v_smfmac_f32_16x16x64_bf16 v[40:43], v[56:59], v[224:231], v2
ds_write_b64 v7, v[82:83] offset:2560
v_mfma_f32_16x16x32_bf16 v[72:75], v[76:79], v[102:105], v[72:75]
buffer_load_dwordx4 v[88:91], v5, s[4:7], s18 offen offset:2048 sc1
buffer_load_dwordx4 v[102:105], v5, s[4:7], s18 offen offset:2304 sc1
v_smfmac_f32_16x16x64_bf16 v[40:43], v[60:63], v[232:239], v2
ds_read_b64_tr_b16 v[76:77], v8 offset:2048
ds_read_b64_tr_b16 v[78:79], v9 offset:2048
s_nop 5
v_cvt_pk_bf16_f32 v80, v40, v41
v_cvt_pk_bf16_f32 v81, v42, v43
s_nop 1
v_mfma_f32_16x16x16_bf16 v[36:39], v[80:81], v[14:15], 0
s_waitcnt lgkmcnt(0)
v_mfma_f32_16x16x32_bf16 v[64:67], v[76:79], v[112:115], v[64:67]
v_mfma_f32_16x16x32_bf16 v[68:71], v[76:79], v[92:95], v[68:71]
v_mfma_f32_16x16x32_bf16 v[72:75], v[76:79], v[106:109], v[72:75]
v_cvt_pk_bf16_f32 v82, v36, v37
v_cvt_pk_bf16_f32 v83, v38, v39
s_nop 1
v_mfma_f32_16x16x16_bf16 v[64:67], v[82:83], v[116:117], v[64:67]
v_mfma_f32_16x16x16_bf16 v[68:71], v[82:83], v[96:97], v[68:71]
v_mfma_f32_16x16x16_bf16 v[72:75], v[82:83], v[110:111], v[72:75]
s_nop 5
v_permlane32_swap_b32 v64, v65
v_permlane32_swap_b32 v66, v67
v_add_f32 v64, v64, v65
v_add_f32 v66, v66, v67
ds_write_b32 v11, v64
ds_write_b32 v11, v66 offset:512
v_permlane32_swap_b32 v68, v72
v_permlane32_swap_b32 v69, v73
v_permlane32_swap_b32 v70, v74
v_permlane32_swap_b32 v71, v75
v_add_f32 v68, v68, v72
ds_write_b32 v10, v68 offset:0
v_add_f32 v69, v69, v73
ds_write_b32 v10, v69 offset:256
v_add_f32 v70, v70, v74
ds_write_b32 v10, v70 offset:512
v_add_f32 v71, v71, v75
ds_write_b32 v10, v71 offset:768
s_waitcnt lgkmcnt(0)
s_barrier
s_add_u32 s20, s18, 4096
buffer_load_dwordx4 v[92:95], v5, s[4:7], s20 offen offset:0 sc1
buffer_load_dwordx4 v[106:109], v5, s[4:7], s20 offen offset:256 sc1
buffer_load_dwordx2 v[96:97], v6, s[4:7], s18 offen offset:0 sc1
buffer_load_dwordx2 v[110:111], v6, s[4:7], s18 offen offset:256 sc1
s_sleep 14
s_add_u32 s18, s18, 28672
s_add_u32 s12, s12, 1
s_add_u32 s64, s64, 7168
s_add_u32 s65, s65, 7168
s_add_u32 s17, s17, 10240
s_add_u32 s15, s15, 10240
s_cmp_lt_u32 s12, 63
s_cbranch_scc1 LA2_loop
s_branch LA_fin
LA3_entry:
s_mov_b32 s64, 44043264
s_mov_b32 s65, 44044288
LA3_loop:
v_mov_b64 v[16:17], 0
v_mov_b64 v[18:19], 0
v_mov_b64 v[20:21], 0
v_mov_b64 v[22:23], 0
v_mov_b64 v[24:25], 0
v_mov_b64 v[26:27], 0
v_mov_b64 v[28:29], 0
v_mov_b64 v[30:31], 0
v_mov_b64 v[32:33], 0
v_mov_b64 v[34:35], 0
v_mov_b64 v[36:37], 0
v_mov_b64 v[38:39], 0
v_mov_b64 v[40:41], 0
v_mov_b64 v[42:43], 0
s_mov_b32 s28, 0
buffer_load_dwordx4 v[64:67], v1, s[4:7], s64 offen sc1
buffer_load_dwordx4 v[68:71], v1, s[4:7], s65 offen sc1
LA3_pl:
buffer_load_dwordx4 v[72:75], v1, s[4:7], s64 offen sc1
buffer_load_dwordx4 v[76:79], v1, s[4:7], s65 offen sc1
s_waitcnt vmcnt(2)
ds_write_b128 v1, v[64:67] offset:3072
ds_write_b128 v1, v[68:71] offset:4096
v_max3_u32 v80, v64, v65, v66
v_max3_u32 v81, v67, v68, v69
v_max3_u32 v80, v80, v70, v71
v_max_u32 v80, v80, v81
v_cmp_eq_u32 vcc, -1, v80
s_cbranch_vccz LA3_ok0
buffer_load_dwordx4 v[64:67], v1, s[4:7], s64 offen sc1
buffer_load_dwordx4 v[68:71], v1, s[4:7], s65 offen sc1
s_waitcnt vmcnt(2)
ds_write_b128 v1, v[72:75] offset:3072
ds_write_b128 v1, v[76:79] offset:4096
v_max3_u32 v80, v72, v73, v74
v_max3_u32 v81, v75, v76, v77
v_max3_u32 v80, v80, v78, v79
v_max_u32 v80, v80, v81
v_cmp_eq_u32 vcc, -1, v80
s_cbranch_vccz LA3_ok1
s_add_u32 s28, s28, 1
s_cmp_lt_u32 s28, 20000
s_cbranch_scc1 LA3_pl
s_waitcnt vmcnt(0)
s_branch LA3_ok1
LA3_ok0:
v_smfmac_f32_16x16x64_bf16 v[16:19], v[64:67], a[24:31], v2
v_smfmac_f32_16x16x64_bf16 v[20:23], v[64:67], a[80:87], v2
v_smfmac_f32_16x16x64_bf16 v[24:27], v[64:67], a[136:143], v2
v_smfmac_f32_16x16x64_bf16 v[28:31], v[64:67], a[192:199], v2
s_waitcnt lgkmcnt(0)
s_barrier
ds_read_b128 v[44:47], v1 offset:5120
v_smfmac_f32_16x16x64_bf16 v[32:35], v[64:67], a[248:255], v2
ds_read_b128 v[48:51], v1 offset:6144
v_smfmac_f32_16x16x64_bf16 v[36:39], v[64:67], v[168:175], v2
ds_read_b128 v[52:55], v1 offset:0
v_smfmac_f32_16x16x64_bf16 v[40:43], v[64:67], v[224:231], v2
ds_read_b128 v[56:59], v1 offset:1024
v_smfmac_f32_16x16x64_bf16 v[16:19], v[68:71], a[32:39], v2
ds_read_b128 v[60:63], v1 offset:2048
v_smfmac_f32_16x16x64_bf16 v[20:23], v[68:71], a[88:95], v2
v_smfmac_f32_16x16x64_bf16 v[24:27], v[68:71], a[144:151], v2
v_smfmac_f32_16x16x64_bf16 v[28:31], v[68:71], a[200:207], v2
v_smfmac_f32_16x16x64_bf16 v[32:35], v[68:71], v[120:127], v2
v_smfmac_f32_16x16x64_bf16 v[36:39], v[68:71], v[176:183], v2
v_smfmac_f32_16x16x64_bf16 v[40:43], v[68:71], v[232:239], v2
s_branch LA3_ph2
LA3_ok1:
v_smfmac_f32_16x16x64_bf16 v[16:19], v[72:75], a[24:31], v2
v_smfmac_f32_16x16x64_bf16 v[20:23], v[72:75], a[80:87], v2
v_smfmac_f32_16x16x64_bf16 v[24:27], v[72:75], a[136:143], v2
v_smfmac_f32_16x16x64_bf16 v[28:31], v[72:75], a[192:199], v2
s_waitcnt lgkmcnt(0)
s_barrier
ds_read_b128 v[44:47], v1 offset:5120
v_smfmac_f32_16x16x64_bf16 v[32:35], v[72:75], a[248:255], v2
ds_read_b128 v[48:51], v1 offset:6144
v_smfmac_f32_16x16x64_bf16 v[36:39], v[72:75], v[168:175], v2
ds_read_b128 v[52:55], v1 offset:0
v_smfmac_f32_16x16x64_bf16 v[40:43], v[72:75], v[224:231], v2
ds_read_b128 v[56:59], v1 offset:1024
v_smfmac_f32_16x16x64_bf16 v[16:19], v[76:79], a[32:39], v2
ds_read_b128 v[60:63], v1 offset:2048
v_smfmac_f32_16x16x64_bf16 v[20:23], v[76:79], a[88:95], v2
v_smfmac_f32_16x16x64_bf16 v[24:27], v[76:79], a[144:151], v2
v_smfmac_f32_16x16x64_bf16 v[28:31], v[76:79], a[200:207], v2
v_smfmac_f32_16x16x64_bf16 v[32:35], v[76:79], v[120:127], v2
v_smfmac_f32_16x16x64_bf16 v[36:39], v[76:79], v[176:183], v2
v_smfmac_f32_16x16x64_bf16 v[40:43], v[76:79], v[232:239], v2
LA3_ph2:
s_waitcnt lgkmcnt(4)
v_smfmac_f32_16x16x64_bf16 v[16:19], v[44:47], a[40:47], v2
s_waitcnt lgkmcnt(3)
v_smfmac_f32_16x16x64_bf16 v[16:19], v[48:51], a[48:55], v2
s_waitcnt lgkmcnt(2)
v_smfmac_f32_16x16x64_bf16 v[16:19], v[52:55], a[0:7], v2
s_waitcnt lgkmcnt(1)
v_smfmac_f32_16x16x64_bf16 v[16:19], v[56:59], a[8:15], v2
ds_read_b128 v[112:115], v3 offset:0
s_waitcnt lgkmcnt(1)
v_smfmac_f32_16x16x64_bf16 v[16:19], v[60:63], a[16:23], v2
ds_read_b64 v[116:117], v4 offset:0
v_smfmac_f32_16x16x64_bf16 v[20:23], v[44:47], a[96:103], v2
v_smfmac_f32_16x16x64_bf16 v[20:23], v[48:51], a[104:111], v2
v_smfmac_f32_16x16x64_bf16 v[20:23], v[52:55], a[56:63], v2
v_cvt_pk_bf16_f32 v80, v16, v17
v_cvt_pk_bf16_f32 v81, v18, v19
v_smfmac_f32_16x16x64_bf16 v[20:23], v[56:59], a[64:71], v2
ds_write_b64 v7, v[80:81] offset:0
v_smfmac_f32_16x16x64_bf16 v[20:23], v[60:63], a[72:79], v2
v_smfmac_f32_16x16x64_bf16 v[24:27], v[44:47], a[152:159], v2
v_smfmac_f32_16x16x64_bf16 v[24:27], v[48:51], a[160:167], v2
v_smfmac_f32_16x16x64_bf16 v[24:27], v[52:55], a[112:119], v2
v_cvt_pk_bf16_f32 v82, v20, v21
v_cvt_pk_bf16_f32 v83, v22, v23
v_smfmac_f32_16x16x64_bf16 v[24:27], v[56:59], a[120:127], v2
ds_write_b64 v7, v[82:83] offset:512
s_waitcnt vmcnt(0)
v_smfmac_f32_16x16x64_bf16 v[24:27], v[60:63], a[128:135], v2
ds_read_b64_tr_b16 v[76:77], v8 offset:0
v_smfmac_f32_16x16x64_bf16 v[28:31], v[44:47], a[208:215], v2
ds_read_b64_tr_b16 v[78:79], v9 offset:0
v_smfmac_f32_16x16x64_bf16 v[28:31], v[48:51], a[216:223], v2
v_smfmac_f32_16x16x64_bf16 v[28:31], v[52:55], a[168:175], v2
v_cvt_pk_bf16_f32 v80, v24, v25
v_cvt_pk_bf16_f32 v81, v26, v27
v_smfmac_f32_16x16x64_bf16 v[28:31], v[56:59], a[176:183], v2
ds_write_b64 v7, v[80:81] offset:1024
v_smfmac_f32_16x16x64_bf16 v[28:31], v[60:63], a[184:191], v2
v_smfmac_f32_16x16x64_bf16 v[32:35], v[44:47], v[128:135], v2
s_waitcnt lgkmcnt(1)
v_mfma_f32_16x16x32_bf16 v[64:67], v[76:79], v[112:115], 0
ds_read_b128 v[112:115], v3 offset:512
v_smfmac_f32_16x16x64_bf16 v[32:35], v[48:51], v[136:143], v2
v_mfma_f32_16x16x32_bf16 v[68:71], v[76:79], v[84:87], 0
v_smfmac_f32_16x16x64_bf16 v[32:35], v[52:55], a[224:231], v2
v_cvt_pk_bf16_f32 v82, v28, v29
v_cvt_pk_bf16_f32 v83, v30, v31
v_smfmac_f32_16x16x64_bf16 v[32:35], v[56:59], a[232:239], v2
ds_write_b64 v7, v[82:83] offset:1536
v_mfma_f32_16x16x32_bf16 v[72:75], v[76:79], v[98:101], 0
buffer_load_dwordx4 v[84:87], v5, s[4:7], s18 offen offset:0 sc1
buffer_load_dwordx4 v[98:101], v5, s[4:7], s18 offen offset:256 sc1
v_smfmac_f32_16x16x64_bf16 v[32:35], v[60:63], a[240:247], v2
ds_read_b64_tr_b16 v[76:77], v8 offset:1024
v_smfmac_f32_16x16x64_bf16 v[36:39], v[44:47], v[184:191], v2
ds_read_b64_tr_b16 v[78:79], v9 offset:1024
v_smfmac_f32_16x16x64_bf16 v[36:39], v[48:51], v[192:199], v2
v_smfmac_f32_16x16x64_bf16 v[36:39], v[52:55], v[144:151], v2
v_cvt_pk_bf16_f32 v80, v32, v33
v_cvt_pk_bf16_f32 v81, v34, v35
v_smfmac_f32_16x16x64_bf16 v[36:39], v[56:59], v[152:159], v2
ds_write_b64 v7, v[80:81] offset:2048
v_smfmac_f32_16x16x64_bf16 v[36:39], v[60:63], v[160:167], v2
v_smfmac_f32_16x16x64_bf16 v[40:43], v[44:47], v[240:247], v2
s_waitcnt lgkmcnt(1)
v_mfma_f32_16x16x32_bf16 v[64:67], v[76:79], v[112:115], v[64:67]
ds_read_b128 v[112:115], v3 offset:1024
v_smfmac_f32_16x16x64_bf16 v[40:43], v[48:51], v[248:255], v2
v_mfma_f32_16x16x32_bf16 v[68:71], v[76:79], v[88:91], v[68:71]
v_smfmac_f32_16x16x64_bf16 v[40:43], v[52:55], v[200:207], v2
v_cvt_pk_bf16_f32 v82, v36, v37
v_cvt_pk_bf16_f32 v83, v38, v39
v_smfmac_f32_16x16x64_bf16 v[40:43], v[56:59], v[208:215], v2
ds_write_b64 v7, v[82:83] offset:2560
v_mfma_f32_16x16x32_bf16 v[72:75], v[76:79], v[102:105], v[72:75]
buffer_load_dwordx4 v[88:91], v5, s[4:7], s18 offen offset:2048 sc1
buffer_load_dwordx4 v[102:105], v5, s[4:7], s18 offen offset:2304 sc1
v_smfmac_f32_16x16x64_bf16 v[40:43], v[60:63], v[216:223], v2
ds_read_b64_tr_b16 v[76:77], v8 offset:2048
ds_read_b64_tr_b16 v[78:79], v9 offset:2048
s_nop 5
v_cvt_pk_bf16_f32 v80, v40, v41
v_cvt_pk_bf16_f32 v81, v42, v43
s_nop 1
v_mfma_f32_16x16x16_bf16 v[36:39], v[80:81], v[14:15], 0
s_waitcnt lgkmcnt(0)
v_mfma_f32_16x16x32_bf16 v[64:67], v[76:79], v[112:115], v[64:67]
v_mfma_f32_16x16x32_bf16 v[68:71], v[76:79], v[92:95], v[68:71]
v_mfma_f32_16x16x32_bf16 v[72:75], v[76:79], v[106:109], v[72:75]
v_cvt_pk_bf16_f32 v82, v36, v37
v_cvt_pk_bf16_f32 v83, v38, v39
s_nop 1
v_mfma_f32_16x16x16_bf16 v[64:67], v[82:83], v[116:117], v[64:67]
v_mfma_f32_16x16x16_bf16 v[68:71], v[82:83], v[96:97], v[68:71]
v_mfma_f32_16x16x16_bf16 v[72:75], v[82:83], v[110:111], v[72:75]
s_nop 5
v_permlane32_swap_b32 v64, v65
v_permlane32_swap_b32 v66, v67
v_add_f32 v64, v64, v65
v_add_f32 v66, v66, v67
ds_write_b32 v11, v64
ds_write_b32 v11, v66 offset:512
v_permlane32_swap_b32 v68, v72
v_permlane32_swap_b32 v69, v73
v_permlane32_swap_b32 v70, v74
v_permlane32_swap_b32 v71, v75
v_add_f32 v68, v68, v72
ds_write_b32 v10, v68 offset:0
v_add_f32 v69, v69, v73
ds_write_b32 v10, v69 offset:256
v_add_f32 v70, v70, v74
ds_write_b32 v10, v70 offset:512
v_add_f32 v71, v71, v75
ds_write_b32 v10, v71 offset:768
s_waitcnt lgkmcnt(0)
s_barrier
s_add_u32 s20, s18, 4096
buffer_load_dwordx4 v[92:95], v5, s[4:7], s20 offen offset:0 sc1
buffer_load_dwordx4 v[106:109], v5, s[4:7], s20 offen offset:256 sc1
buffer_load_dwordx2 v[96:97], v6, s[4:7], s18 offen offset:0 sc1
buffer_load_dwordx2 v[110:111], v6, s[4:7], s18 offen offset:256 sc1
s_sleep 14
s_add_u32 s18, s18, 28672
s_add_u32 s12, s12, 1
s_add_u32 s64, s64, 7168
s_add_u32 s65, s65, 7168
s_add_u32 s17, s17, 10240
s_add_u32 s15, s15, 10240
s_cmp_lt_u32 s12, 63
s_cbranch_scc1 LA3_loop
LA_fin:
s_waitcnt vmcnt(0)
s_branch L_exit
LB_pre:
s_cmp_lg_u32 s24, 0
s_cbranch_scc1 LB_bf_w
v_and_b32 v4, 15, v1
v_lshlrev_b32 v4, 7, v4
v_add_u32 v4, 75017344, v4
s_mov_b32 s47, 0
LB_bf_p:
buffer_load_dword v5, v4, s[4:7], 0 offen sc1
s_waitcnt vmcnt(0)
v_cmp_gt_u32 vcc, 7, v5
s_cbranch_vccz LB_bf_w
s_add_u32 s47, s47, 1
s_cmp_lt_u32 s47, 20000
s_cbranch_scc1 LB_bf_p
LB_bf_w:
s_barrier
v_and_b32 v1, 63, v0
v_lshlrev_b32 v2, 4, v1
v_and_b32 v3, 8, v1
v_cmp_ne_u32 vcc, 0, v3
v_mov_b32 v3, 0x4444
v_mov_b32 v4, 0xeeee
v_cndmask_b32 v3, v3, v4, vcc
s_lshl_b32 s20, s14, 1
s_min_u32 s21, s20, 6
s_add_u32 s20, s20, 1
s_min_u32 s22, s20, 6
s_lshl_b32 s21, s21, 10
s_lshl_b32 s22, s22, 10
v_add_u32 v4, s21, v2
v_add_u32 v5, s22, v2
s_sub_u32 s15, s13, 16
s_mul_i32 s23, s14, 14336
s_add_u32 s23, s23, 16384
v_add_u32 v6, s23, v2
s_lshl_b32 s20, s14, 2
s_add_u32 s20, s20, 0
s_mul_i32 s20, s20, 28
s_lshl_b32 s21, s15, 1
s_add_u32 s20, s20, s21
s_add_u32 s20, s20, 0
s_mul_i32 s20, s20, 14336
s_add_u32 s20, s20, 6422528
s_add_u32 s21, s20, 0
buffer_load_dwordx4 a[0:3], v2, s[4:7], s21 offen offset:0 sc1
buffer_load_dwordx4 a[4:7], v2, s[4:7], s21 offen offset:1024 sc1
s_add_u32 s21, s20, 2048
buffer_load_dwordx4 a[8:11], v2, s[4:7], s21 offen offset:0 sc1
buffer_load_dwordx4 a[12:15], v2, s[4:7], s21 offen offset:1024 sc1
s_add_u32 s21, s20, 4096
buffer_load_dwordx4 a[16:19], v2, s[4:7], s21 offen offset:0 sc1
buffer_load_dwordx4 a[20:23], v2, s[4:7], s21 offen offset:1024 sc1
s_waitcnt vmcnt(32)
s_lshl_b32 s20, s14, 2
s_add_u32 s20, s20, 0
s_mul_i32 s20, s20, 28
s_lshl_b32 s21, s15, 1
s_add_u32 s20, s20, s21
s_add_u32 s20, s20, 1
s_mul_i32 s20, s20, 14336
s_add_u32 s20, s20, 6422528
s_add_u32 s21, s20, 0
buffer_load_dwordx4 a[56:59], v2, s[4:7], s21 offen offset:0 sc1
buffer_load_dwordx4 a[60:63], v2, s[4:7], s21 offen offset:1024 sc1
s_add_u32 s21, s20, 2048
buffer_load_dwordx4 a[64:67], v2, s[4:7], s21 offen offset:0 sc1
buffer_load_dwordx4 a[68:71], v2, s[4:7], s21 offen offset:1024 sc1
s_add_u32 s21, s20, 4096
buffer_load_dwordx4 a[72:75], v2, s[4:7], s21 offen offset:0 sc1
buffer_load_dwordx4 a[76:79], v2, s[4:7], s21 offen offset:1024 sc1
s_waitcnt vmcnt(32)
s_lshl_b32 s20, s14, 2
s_add_u32 s20, s20, 1
s_mul_i32 s20, s20, 28
s_lshl_b32 s21, s15, 1
s_add_u32 s20, s20, s21
s_add_u32 s20, s20, 0
s_mul_i32 s20, s20, 14336
s_add_u32 s20, s20, 6422528
s_add_u32 s21, s20, 0
buffer_load_dwordx4 a[112:115], v2, s[4:7], s21 offen offset:0 sc1
buffer_load_dwordx4 a[116:119], v2, s[4:7], s21 offen offset:1024 sc1
s_add_u32 s21, s20, 2048
buffer_load_dwordx4 a[120:123], v2, s[4:7], s21 offen offset:0 sc1
buffer_load_dwordx4 a[124:127], v2, s[4:7], s21 offen offset:1024 sc1
s_add_u32 s21, s20, 4096
buffer_load_dwordx4 a[128:131], v2, s[4:7], s21 offen offset:0 sc1
buffer_load_dwordx4 a[132:135], v2, s[4:7], s21 offen offset:1024 sc1
s_waitcnt vmcnt(32)
s_lshl_b32 s20, s14, 2
s_add_u32 s20, s20, 1
s_mul_i32 s20, s20, 28
s_lshl_b32 s21, s15, 1
s_add_u32 s20, s20, s21
s_add_u32 s20, s20, 1
s_mul_i32 s20, s20, 14336
s_add_u32 s20, s20, 6422528
s_add_u32 s21, s20, 0
buffer_load_dwordx4 a[168:171], v2, s[4:7], s21 offen offset:0 sc1
buffer_load_dwordx4 a[172:175], v2, s[4:7], s21 offen offset:1024 sc1
s_add_u32 s21, s20, 2048
buffer_load_dwordx4 a[176:179], v2, s[4:7], s21 offen offset:0 sc1
buffer_load_dwordx4 a[180:183], v2, s[4:7], s21 offen offset:1024 sc1
s_add_u32 s21, s20, 4096
buffer_load_dwordx4 a[184:187], v2, s[4:7], s21 offen offset:0 sc1
buffer_load_dwordx4 a[188:191], v2, s[4:7], s21 offen offset:1024 sc1
s_waitcnt vmcnt(32)
s_lshl_b32 s20, s14, 2
s_add_u32 s20, s20, 2
s_mul_i32 s20, s20, 28
s_lshl_b32 s21, s15, 1
s_add_u32 s20, s20, s21
s_add_u32 s20, s20, 0
s_mul_i32 s20, s20, 14336
s_add_u32 s20, s20, 6422528
s_add_u32 s21, s20, 0
buffer_load_dwordx4 a[224:227], v2, s[4:7], s21 offen offset:0 sc1
buffer_load_dwordx4 a[228:231], v2, s[4:7], s21 offen offset:1024 sc1
s_add_u32 s21, s20, 2048
buffer_load_dwordx4 a[232:235], v2, s[4:7], s21 offen offset:0 sc1
buffer_load_dwordx4 a[236:239], v2, s[4:7], s21 offen offset:1024 sc1
s_add_u32 s21, s20, 4096
buffer_load_dwordx4 a[240:243], v2, s[4:7], s21 offen offset:0 sc1
buffer_load_dwordx4 a[244:247], v2, s[4:7], s21 offen offset:1024 sc1
s_waitcnt vmcnt(32)
s_lshl_b32 s20, s14, 2
s_add_u32 s20, s20, 2
s_mul_i32 s20, s20, 28
s_lshl_b32 s21, s15, 1
s_add_u32 s20, s20, s21
s_add_u32 s20, s20, 1
s_mul_i32 s20, s20, 14336
s_add_u32 s20, s20, 6422528
s_add_u32 s21, s20, 0
buffer_load_dwordx4 v[144:147], v2, s[4:7], s21 offen offset:0 sc1
buffer_load_dwordx4 v[148:151], v2, s[4:7], s21 offen offset:1024 sc1
s_add_u32 s21, s20, 2048
buffer_load_dwordx4 v[152:155], v2, s[4:7], s21 offen offset:0 sc1
buffer_load_dwordx4 v[156:159], v2, s[4:7], s21 offen offset:1024 sc1
s_add_u32 s21, s20, 4096
buffer_load_dwordx4 v[160:163], v2, s[4:7], s21 offen offset:0 sc1
buffer_load_dwordx4 v[164:167], v2, s[4:7], s21 offen offset:1024 sc1
s_waitcnt vmcnt(32)
s_lshl_b32 s20, s14, 2
s_add_u32 s20, s20, 3
s_mul_i32 s20, s20, 28
s_lshl_b32 s21, s15, 1
s_add_u32 s20, s20, s21
s_add_u32 s20, s20, 0
s_mul_i32 s20, s20, 14336
s_add_u32 s20, s20, 6422528
s_add_u32 s21, s20, 0
buffer_load_dwordx4 v[200:203], v2, s[4:7], s21 offen offset:0 sc1
buffer_load_dwordx4 v[204:207], v2, s[4:7], s21 offen offset:1024 sc1
s_add_u32 s21, s20, 2048
buffer_load_dwordx4 v[208:211], v2, s[4:7], s21 offen offset:0 sc1
buffer_load_dwordx4 v[212:215], v2, s[4:7], s21 offen offset:1024 sc1
s_add_u32 s21, s20, 4096
buffer_load_dwordx4 v[216:219], v2, s[4:7], s21 offen offset:0 sc1
buffer_load_dwordx4 v[220:223], v2, s[4:7], s21 offen offset:1024 sc1
s_waitcnt vmcnt(32)
s_lshl_b32 s20, s14, 2
s_add_u32 s20, s20, 3
s_mul_i32 s20, s20, 28
s_lshl_b32 s21, s15, 1
s_add_u32 s20, s20, s21
s_add_u32 s20, s20, 1
s_mul_i32 s20, s20, 14336
s_add_u32 s20, s20, 6422528
s_add_u32 s21, s20, 0
s_add_u32 m0, s23, 0
s_add_u32 s22, s21, 0
buffer_load_dwordx4 v2, s[4:7], s22 offen sc1 lds
s_add_u32 m0, s23, 1024
s_add_u32 s22, s21, 1024
buffer_load_dwordx4 v2, s[4:7], s22 offen sc1 lds
s_add_u32 s21, s20, 2048
s_add_u32 m0, s23, 2048
s_add_u32 s22, s21, 0
buffer_load_dwordx4 v2, s[4:7], s22 offen sc1 lds
s_add_u32 m0, s23, 3072
s_add_u32 s22, s21, 1024
buffer_load_dwordx4 v2, s[4:7], s22 offen sc1 lds
s_add_u32 s21, s20, 4096
s_add_u32 m0, s23, 4096
s_add_u32 s22, s21, 0
buffer_load_dwordx4 v2, s[4:7], s22 offen sc1 lds
s_add_u32 m0, s23, 5120
s_add_u32 s22, s21, 1024
buffer_load_dwordx4 v2, s[4:7], s22 offen sc1 lds
s_waitcnt vmcnt(32)
v_and_b32 v12, 15, v1
v_lshlrev_b32 v12, 7, v12
v_add_u32 v12, 75021696, v12
s_mov_b32 s28, 0
LB_bf2_p:
buffer_load_dword v13, v12, s[4:7], 0 offen sc1
s_waitcnt vmcnt(0)
v_cmp_gt_u32 vcc, 7, v13
s_cbranch_vccz LB_bf2_w
s_add_u32 s28, s28, 1
s_cmp_lt_u32 s28, 20000
s_cbranch_scc1 LB_bf2_p
LB_bf2_w:
s_lshl_b32 s20, s14, 2
s_add_u32 s20, s20, 0
s_mul_i32 s20, s20, 28
s_lshl_b32 s21, s15, 1
s_add_u32 s20, s20, s21
s_add_u32 s20, s20, 0
s_mul_i32 s20, s20, 14336
s_add_u32 s20, s20, 6422528
s_add_u32 s21, s20, 6144
buffer_load_dwordx4 a[24:27], v2, s[4:7], s21 offen offset:0 sc1
buffer_load_dwordx4 a[28:31], v2, s[4:7], s21 offen offset:1024 sc1
s_add_u32 s21, s20, 8192
buffer_load_dwordx4 a[32:35], v2, s[4:7], s21 offen offset:0 sc1
buffer_load_dwordx4 a[36:39], v2, s[4:7], s21 offen offset:1024 sc1
s_add_u32 s21, s20, 10240
buffer_load_dwordx4 a[40:43], v2, s[4:7], s21 offen offset:0 sc1
buffer_load_dwordx4 a[44:47], v2, s[4:7], s21 offen offset:1024 sc1
s_add_u32 s21, s20, 12288
buffer_load_dwordx4 a[48:51], v2, s[4:7], s21 offen offset:0 sc1
buffer_load_dwordx4 a[52:55], v2, s[4:7], s21 offen offset:1024 sc1
s_waitcnt vmcnt(32)
s_lshl_b32 s20, s14, 2
s_add_u32 s20, s20, 0
s_mul_i32 s20, s20, 28
s_lshl_b32 s21, s15, 1
s_add_u32 s20, s20, s21
s_add_u32 s20, s20, 1
s_mul_i32 s20, s20, 14336
s_add_u32 s20, s20, 6422528
s_add_u32 s21, s20, 6144
buffer_load_dwordx4 a[80:83], v2, s[4:7], s21 offen offset:0 sc1
buffer_load_dwordx4 a[84:87], v2, s[4:7], s21 offen offset:1024 sc1
s_add_u32 s21, s20, 8192
buffer_load_dwordx4 a[88:91], v2, s[4:7], s21 offen offset:0 sc1
buffer_load_dwordx4 a[92:95], v2, s[4:7], s21 offen offset:1024 sc1
s_add_u32 s21, s20, 10240
buffer_load_dwordx4 a[96:99], v2, s[4:7], s21 offen offset:0 sc1
buffer_load_dwordx4 a[100:103], v2, s[4:7], s21 offen offset:1024 sc1
s_add_u32 s21, s20, 12288
buffer_load_dwordx4 a[104:107], v2, s[4:7], s21 offen offset:0 sc1
buffer_load_dwordx4 a[108:111], v2, s[4:7], s21 offen offset:1024 sc1
s_waitcnt vmcnt(32)
s_lshl_b32 s20, s14, 2
s_add_u32 s20, s20, 1
s_mul_i32 s20, s20, 28
s_lshl_b32 s21, s15, 1
s_add_u32 s20, s20, s21
s_add_u32 s20, s20, 0
s_mul_i32 s20, s20, 14336
s_add_u32 s20, s20, 6422528
s_add_u32 s21, s20, 6144
buffer_load_dwordx4 a[136:139], v2, s[4:7], s21 offen offset:0 sc1
buffer_load_dwordx4 a[140:143], v2, s[4:7], s21 offen offset:1024 sc1
s_add_u32 s21, s20, 8192
buffer_load_dwordx4 a[144:147], v2, s[4:7], s21 offen offset:0 sc1
buffer_load_dwordx4 a[148:151], v2, s[4:7], s21 offen offset:1024 sc1
s_add_u32 s21, s20, 10240
buffer_load_dwordx4 a[152:155], v2, s[4:7], s21 offen offset:0 sc1
buffer_load_dwordx4 a[156:159], v2, s[4:7], s21 offen offset:1024 sc1
s_add_u32 s21, s20, 12288
buffer_load_dwordx4 a[160:163], v2, s[4:7], s21 offen offset:0 sc1
buffer_load_dwordx4 a[164:167], v2, s[4:7], s21 offen offset:1024 sc1
s_waitcnt vmcnt(32)
s_lshl_b32 s20, s14, 2
s_add_u32 s20, s20, 1
s_mul_i32 s20, s20, 28
s_lshl_b32 s21, s15, 1
s_add_u32 s20, s20, s21
s_add_u32 s20, s20, 1
s_mul_i32 s20, s20, 14336
s_add_u32 s20, s20, 6422528
s_add_u32 s21, s20, 6144
buffer_load_dwordx4 a[192:195], v2, s[4:7], s21 offen offset:0 sc1
buffer_load_dwordx4 a[196:199], v2, s[4:7], s21 offen offset:1024 sc1
s_add_u32 s21, s20, 8192
buffer_load_dwordx4 a[200:203], v2, s[4:7], s21 offen offset:0 sc1
buffer_load_dwordx4 a[204:207], v2, s[4:7], s21 offen offset:1024 sc1
s_add_u32 s21, s20, 10240
buffer_load_dwordx4 a[208:211], v2, s[4:7], s21 offen offset:0 sc1
buffer_load_dwordx4 a[212:215], v2, s[4:7], s21 offen offset:1024 sc1
s_add_u32 s21, s20, 12288
buffer_load_dwordx4 a[216:219], v2, s[4:7], s21 offen offset:0 sc1
buffer_load_dwordx4 a[220:223], v2, s[4:7], s21 offen offset:1024 sc1
s_waitcnt vmcnt(32)
s_lshl_b32 s20, s14, 2
s_add_u32 s20, s20, 2
s_mul_i32 s20, s20, 28
s_lshl_b32 s21, s15, 1
s_add_u32 s20, s20, s21
s_add_u32 s20, s20, 0
s_mul_i32 s20, s20, 14336
s_add_u32 s20, s20, 6422528
s_add_u32 s21, s20, 6144
buffer_load_dwordx4 a[248:251], v2, s[4:7], s21 offen offset:0 sc1
buffer_load_dwordx4 a[252:255], v2, s[4:7], s21 offen offset:1024 sc1
s_add_u32 s21, s20, 8192
buffer_load_dwordx4 v[120:123], v2, s[4:7], s21 offen offset:0 sc1
buffer_load_dwordx4 v[124:127], v2, s[4:7], s21 offen offset:1024 sc1
s_add_u32 s21, s20, 10240
buffer_load_dwordx4 v[128:131], v2, s[4:7], s21 offen offset:0 sc1
buffer_load_dwordx4 v[132:135], v2, s[4:7], s21 offen offset:1024 sc1
s_add_u32 s21, s20, 12288
buffer_load_dwordx4 v[136:139], v2, s[4:7], s21 offen offset:0 sc1
buffer_load_dwordx4 v[140:143], v2, s[4:7], s21 offen offset:1024 sc1
s_waitcnt vmcnt(32)
s_lshl_b32 s20, s14, 2
s_add_u32 s20, s20, 2
s_mul_i32 s20, s20, 28
s_lshl_b32 s21, s15, 1
s_add_u32 s20, s20, s21
s_add_u32 s20, s20, 1
s_mul_i32 s20, s20, 14336
s_add_u32 s20, s20, 6422528
s_add_u32 s21, s20, 6144
buffer_load_dwordx4 v[168:171], v2, s[4:7], s21 offen offset:0 sc1
buffer_load_dwordx4 v[172:175], v2, s[4:7], s21 offen offset:1024 sc1
s_add_u32 s21, s20, 8192
buffer_load_dwordx4 v[176:179], v2, s[4:7], s21 offen offset:0 sc1
buffer_load_dwordx4 v[180:183], v2, s[4:7], s21 offen offset:1024 sc1
s_add_u32 s21, s20, 10240
buffer_load_dwordx4 v[184:187], v2, s[4:7], s21 offen offset:0 sc1
buffer_load_dwordx4 v[188:191], v2, s[4:7], s21 offen offset:1024 sc1
s_add_u32 s21, s20, 12288
buffer_load_dwordx4 v[192:195], v2, s[4:7], s21 offen offset:0 sc1
buffer_load_dwordx4 v[196:199], v2, s[4:7], s21 offen offset:1024 sc1
s_waitcnt vmcnt(32)
s_lshl_b32 s20, s14, 2
s_add_u32 s20, s20, 3
s_mul_i32 s20, s20, 28
s_lshl_b32 s21, s15, 1
s_add_u32 s20, s20, s21
s_add_u32 s20, s20, 0
s_mul_i32 s20, s20, 14336
s_add_u32 s20, s20, 6422528
s_add_u32 s21, s20, 6144
buffer_load_dwordx4 v[224:227], v2, s[4:7], s21 offen offset:0 sc1
buffer_load_dwordx4 v[228:231], v2, s[4:7], s21 offen offset:1024 sc1
s_add_u32 s21, s20, 8192
buffer_load_dwordx4 v[232:235], v2, s[4:7], s21 offen offset:0 sc1
buffer_load_dwordx4 v[236:239], v2, s[4:7], s21 offen offset:1024 sc1
s_add_u32 s21, s20, 10240
buffer_load_dwordx4 v[240:243], v2, s[4:7], s21 offen offset:0 sc1
buffer_load_dwordx4 v[244:247], v2, s[4:7], s21 offen offset:1024 sc1
s_add_u32 s21, s20, 12288
buffer_load_dwordx4 v[248:251], v2, s[4:7], s21 offen offset:0 sc1
buffer_load_dwordx4 v[252:255], v2, s[4:7], s21 offen offset:1024 sc1
s_waitcnt vmcnt(32)
s_lshl_b32 s20, s14, 2
s_add_u32 s20, s20, 3
s_mul_i32 s20, s20, 28
s_lshl_b32 s21, s15, 1
s_add_u32 s20, s20, s21
s_add_u32 s20, s20, 1
s_mul_i32 s20, s20, 14336
s_add_u32 s20, s20, 6422528
s_add_u32 s21, s20, 6144
s_add_u32 m0, s23, 6144
s_add_u32 s22, s21, 0
buffer_load_dwordx4 v2, s[4:7], s22 offen sc1 lds
s_add_u32 m0, s23, 7168
s_add_u32 s22, s21, 1024
buffer_load_dwordx4 v2, s[4:7], s22 offen sc1 lds
s_add_u32 s21, s20, 8192
s_add_u32 m0, s23, 8192
s_add_u32 s22, s21, 0
buffer_load_dwordx4 v2, s[4:7], s22 offen sc1 lds
s_add_u32 m0, s23, 9216
s_add_u32 s22, s21, 1024
buffer_load_dwordx4 v2, s[4:7], s22 offen sc1 lds
s_add_u32 s21, s20, 10240
s_add_u32 m0, s23, 10240
s_add_u32 s22, s21, 0
buffer_load_dwordx4 v2, s[4:7], s22 offen sc1 lds
s_add_u32 m0, s23, 11264
s_add_u32 s22, s21, 1024
buffer_load_dwordx4 v2, s[4:7], s22 offen sc1 lds
s_add_u32 s21, s20, 12288
s_add_u32 m0, s23, 12288
s_add_u32 s22, s21, 0
buffer_load_dwordx4 v2, s[4:7], s22 offen sc1 lds
s_add_u32 m0, s23, 13312
s_add_u32 s22, s21, 1024
buffer_load_dwordx4 v2, s[4:7], s22 offen sc1 lds
s_waitcnt vmcnt(32)
s_waitcnt vmcnt(0)
s_lshl_b32 s20, s14, 11
v_add_u32 v7, s20, v2
v_lshrrev_b32 v12, 5, v1
v_lshlrev_b32 v12, 1, v12
v_bfe_u32 v13, v1, 3, 1
v_add_u32 v12, v12, v13
v_lshlrev_b32 v12, 7, v12
v_and_b32 v13, 7, v1
v_lshl_add_u32 v12, v13, 4, v12
s_lshl_b32 s20, s14, 9
s_add_u32 s20, s20, 8192
v_add_u32 v8, s20, v12
s_lshr_b32 s20, s14, 1
s_lshl_b32 s20, s20, 10
s_and_b32 s21, s14, 1
s_lshl_b32 s21, s21, 8
s_add_u32 s20, s20, s21
s_add_u32 s20, s20, 7168
v_lshl_add_u32 v9, v1, 2, s20
v_lshrrev_b32 v12, 2, v1
v_lshrrev_b32 v13, 3, v12
v_lshlrev_b32 v13, 7, v13
v_and_b32 v14, 3, v1
v_lshl_add_u32 v13, v14, 4, v13
v_bfe_u32 v14, v12, 1, 2
v_lshl_add_u32 v13, v14, 2, v13
s_lshl_b32 s20, s15, 2
s_lshr_b32 s21, s14, 1
s_lshl_b32 s21, s21, 1
s_add_u32 s20, s20, s21
s_lshl_b32 s20, s20, 7
s_and_b32 s21, s14, 1
s_lshl_b32 s21, s21, 6
s_add_u32 s20, s20, s21
v_add_u32 v10, s20, v13
s_lshl_b32 s20, s15, 14
s_lshl_b32 s21, s14, 12
s_add_u32 s20, s20, s21
v_add_u32 v11, s20, v2
s_lshl_b32 s20, s14, 11
s_add_u32 s20, s20, 7168
v_add_u32 v1, s20, v2
s_lshl_b32 s20, s14, 2
s_mul_i32 s20, s20, 28
s_lshl_b32 s21, s15, 1
s_add_u32 s20, s20, s21
s_lshl_b32 s20, s20, 10
s_add_u32 s18, s20, 12845056
s_mov_b32 s12, 0
s_mov_b32 s16, 44040192
s_mov_b32 s17, 44498944
s_mov_b32 s19, 44924928
s_cmp_lg_u32 s14, 0
s_cbranch_scc1 LB_ln_w
v_mov_b32 v12, 75019392
s_mov_b32 s28, 0
LB_ln_p:
buffer_load_dword v13, v12, s[4:7], 0 offen sc1
s_waitcnt vmcnt(0)
v_readfirstlane_b32 s20, v13
s_add_u32 s28, s28, 1
s_nop 1
s_cmp_ge_u32 s20, 256
s_cbranch_scc1 LB_ln_w
s_cmp_gt_u32 s28, 20000
s_cbranch_scc1 LB_ln_w
s_sleep 2
s_branch LB_ln_p
LB_ln_w:
s_barrier
s_mov_b32 s69, 0
s_mov_b32 s62, 0x0f0f0f0f
s_mov_b32 s63, 0x0f0f0f0f
LB_loop:
s_cmp_lg_u32 s69, 0
s_cbranch_scc1 LB_uok
s_and_b32 s20, s12, 3
s_cmp_lg_u32 s20, 0
s_cbranch_scc1 LB_uok
s_lshl_b32 s20, s12, 7
v_lshlrev_b32 v40, 3, v2
v_and_b32 v42, 0x180, v40
v_add_u32 v42, s20, v42
v_and_b32 v40, 0x380, v40
v_add_u32 v40, 7168, v40
v_cmp_gt_u32 vcc, 512, v2
s_nop 1
v_cndmask_b32 v40, v40, v42, vcc
s_mov_b32 s20, 75006080
s_mov_b32 s28, 0
LB_up:
buffer_load_dword v41, v40, s[4:7], s20 offen sc1
s_waitcnt vmcnt(0)
v_cmp_gt_u32 vcc, 28, v41
s_nop 3
s_cmp_eq_u32 vcc_hi, 0
s_cselect_b32 s69, 1, 0
s_cmp_eq_u32 vcc_lo, 0
s_cbranch_scc1 LB_uok
s_add_u32 s28, s28, 1
s_cmp_lt_u32 s28, 20000
s_cbranch_scc1 LB_up
LB_uok:
s_mov_b32 s28, 0
buffer_load_dwordx4 v[40:43], v4, s[4:7], s16 offen sc1
buffer_load_dwordx4 v[44:47], v5, s[4:7], s16 offen sc1
LB_mp:
buffer_load_dwordx4 v[52:55], v4, s[4:7], s16 offen sc1
buffer_load_dwordx4 v[56:59], v5, s[4:7], s16 offen sc1
s_waitcnt vmcnt(2)
v_max3_u32 v48, v40, v41, v42
v_max3_u32 v49, v43, v44, v45
v_max3_u32 v48, v48, v46, v47
v_max_u32 v48, v48, v49
v_cmp_eq_u32 vcc, -1, v48
s_cbranch_vccz LB_mk0
buffer_load_dwordx4 v[40:43], v4, s[4:7], s16 offen sc1
buffer_load_dwordx4 v[44:47], v5, s[4:7], s16 offen sc1
s_waitcnt vmcnt(2)
v_max3_u32 v48, v52, v53, v54
v_max3_u32 v49, v55, v56, v57
v_max3_u32 v48, v48, v58, v59
v_max_u32 v48, v48, v49
v_cmp_eq_u32 vcc, -1, v48
s_cbranch_vccz LB_mk1
s_add_u32 s28, s28, 1
s_cmp_lt_u32 s28, 20000
s_cbranch_scc1 LB_mp
s_waitcnt vmcnt(0)
s_branch LB_mk1
LB_mk0:
ds_write_b128 v4, v[40:43] offset:0
ds_write_b128 v5, v[44:47] offset:0
s_branch LB_mj
LB_mk1:
ds_write_b128 v4, v[52:55] offset:0
ds_write_b128 v5, v[56:59] offset:0
LB_mj:
s_add_u32 s20, s18, 0
buffer_load_dwordx4 v[84:87], v2, s[4:7], s20 offen offset:0 sc1
s_add_u32 s20, s18, 0
buffer_load_dwordx4 v[92:95], v2, s[4:7], s20 offen offset:1024 sc1
s_add_u32 s20, s18, 28672
buffer_load_dwordx4 v[88:91], v2, s[4:7], s20 offen offset:0 sc1
s_add_u32 s20, s18, 28672
buffer_load_dwordx4 v[96:99], v2, s[4:7], s20 offen offset:1024 sc1
s_add_u32 s20, s18, 57344
buffer_load_dwordx4 v[100:103], v2, s[4:7], s20 offen offset:0 sc1
s_add_u32 s20, s18, 57344
buffer_load_dwordx4 v[108:111], v2, s[4:7], s20 offen offset:1024 sc1
s_add_u32 s20, s18, 86016
buffer_load_dwordx4 v[104:107], v2, s[4:7], s20 offen offset:0 sc1
s_add_u32 s20, s18, 86016
buffer_load_dwordx4 v[112:115], v2, s[4:7], s20 offen offset:1024 sc1
s_waitcnt vmcnt(8) lgkmcnt(0)
s_barrier
ds_read_b128 v[12:15], v2 offset:0
ds_read_b128 v[16:19], v2 offset:1024
ds_read_b128 v[20:23], v2 offset:2048
ds_read_b128 v[24:27], v2 offset:3072
ds_read_b128 v[28:31], v2 offset:4096
ds_read_b128 v[32:35], v2 offset:5120
ds_read_b128 v[36:39], v2 offset:6144
v_mov_b64 v[40:41], 0
v_mov_b64 v[42:43], 0
v_mov_b64 v[44:45], 0
v_mov_b64 v[46:47], 0
v_mov_b64 v[116:117], 0
v_mov_b64 v[118:119], 0
s_waitcnt lgkmcnt(6)
v_smfmac_f32_16x16x64_bf16 v[40:43], v[12:15], a[0:7], v3
ds_read_b128 v[52:55], v6 offset:0
ds_read_b128 v[56:59], v6 offset:1024
s_waitcnt lgkmcnt(7)
v_smfmac_f32_16x16x64_bf16 v[40:43], v[16:19], a[8:15], v3
s_add_u32 s18, s18, 458752
s_waitcnt lgkmcnt(6)
v_smfmac_f32_16x16x64_bf16 v[40:43], v[20:23], a[16:23], v3
s_waitcnt lgkmcnt(5)
v_smfmac_f32_16x16x64_bf16 v[40:43], v[24:27], a[24:31], v3
s_waitcnt lgkmcnt(4)
v_smfmac_f32_16x16x64_bf16 v[40:43], v[28:31], a[32:39], v3
s_waitcnt lgkmcnt(3)
v_smfmac_f32_16x16x64_bf16 v[40:43], v[32:35], a[40:47], v3
s_waitcnt lgkmcnt(2)
v_smfmac_f32_16x16x64_bf16 v[40:43], v[36:39], a[48:55], v3
s_waitcnt lgkmcnt(0)
v_smfmac_f32_16x16x64_bf16 v[116:119], v[12:15], v[52:59], v3
v_smfmac_f32_16x16x64_bf16 v[44:47], v[12:15], a[56:63], v3
ds_read_b128 v[60:63], v6 offset:2048
ds_read_b128 v[64:67], v6 offset:3072
v_smfmac_f32_16x16x64_bf16 v[44:47], v[16:19], a[64:71], v3
v_smfmac_f32_16x16x64_bf16 v[44:47], v[20:23], a[72:79], v3
v_cvt_pk_bf16_f32 v68, v40, v41
v_cvt_pk_bf16_f32 v70, v42, v43
v_smfmac_f32_16x16x64_bf16 v[44:47], v[24:27], a[80:87], v3
v_mov_b64 v[40:41], 0
v_smfmac_f32_16x16x64_bf16 v[44:47], v[28:31], a[88:95], v3
v_mov_b64 v[42:43], 0
v_smfmac_f32_16x16x64_bf16 v[44:47], v[32:35], a[96:103], v3
v_smfmac_f32_16x16x64_bf16 v[44:47], v[36:39], a[104:111], v3
s_waitcnt lgkmcnt(0)
v_smfmac_f32_16x16x64_bf16 v[116:119], v[16:19], v[60:67], v3
v_smfmac_f32_16x16x64_bf16 v[40:43], v[12:15], a[112:119], v3
ds_read_b128 v[52:55], v6 offset:4096
ds_read_b128 v[56:59], v6 offset:5120
v_smfmac_f32_16x16x64_bf16 v[40:43], v[16:19], a[120:127], v3
v_smfmac_f32_16x16x64_bf16 v[40:43], v[20:23], a[128:135], v3
v_cvt_pk_bf16_f32 v76, v44, v45
v_cvt_pk_bf16_f32 v78, v46, v47
v_smfmac_f32_16x16x64_bf16 v[40:43], v[24:27], a[136:143], v3
v_mov_b64 v[44:45], 0
v_smfmac_f32_16x16x64_bf16 v[40:43], v[28:31], a[144:151], v3
v_mov_b64 v[46:47], 0
v_smfmac_f32_16x16x64_bf16 v[40:43], v[32:35], a[152:159], v3
v_smfmac_f32_16x16x64_bf16 v[40:43], v[36:39], a[160:167], v3
s_waitcnt lgkmcnt(0)
v_smfmac_f32_16x16x64_bf16 v[116:119], v[20:23], v[52:59], v3
v_smfmac_f32_16x16x64_bf16 v[44:47], v[12:15], a[168:175], v3
ds_read_b128 v[60:63], v6 offset:6144
ds_read_b128 v[64:67], v6 offset:7168
v_smfmac_f32_16x16x64_bf16 v[44:47], v[16:19], a[176:183], v3
v_smfmac_f32_16x16x64_bf16 v[44:47], v[20:23], a[184:191], v3
v_cvt_pk_bf16_f32 v69, v40, v41
v_cvt_pk_bf16_f32 v71, v42, v43
v_smfmac_f32_16x16x64_bf16 v[44:47], v[24:27], a[192:199], v3
v_mov_b64 v[40:41], 0
v_smfmac_f32_16x16x64_bf16 v[44:47], v[28:31], a[200:207], v3
v_mov_b64 v[42:43], 0
v_smfmac_f32_16x16x64_bf16 v[44:47], v[32:35], a[208:215], v3
v_smfmac_f32_16x16x64_bf16 v[44:47], v[36:39], a[216:223], v3
s_waitcnt lgkmcnt(0)
v_smfmac_f32_16x16x64_bf16 v[116:119], v[24:27], v[60:67], v3
v_smfmac_f32_16x16x64_bf16 v[40:43], v[12:15], a[224:231], v3
ds_read_b128 v[52:55], v6 offset:8192
ds_read_b128 v[56:59], v6 offset:9216
v_smfmac_f32_16x16x64_bf16 v[40:43], v[16:19], a[232:239], v3
v_smfmac_f32_16x16x64_bf16 v[40:43], v[20:23], a[240:247], v3
v_cvt_pk_bf16_f32 v77, v44, v45
v_cvt_pk_bf16_f32 v79, v46, v47
v_smfmac_f32_16x16x64_bf16 v[40:43], v[24:27], a[248:255], v3
v_mov_b64 v[44:45], 0
v_smfmac_f32_16x16x64_bf16 v[40:43], v[28:31], v[120:127], v3
v_mov_b64 v[46:47], 0
v_smfmac_f32_16x16x64_bf16 v[40:43], v[32:35], v[128:135], v3
v_smfmac_f32_16x16x64_bf16 v[40:43], v[36:39], v[136:143], v3
s_waitcnt lgkmcnt(0)
v_smfmac_f32_16x16x64_bf16 v[116:119], v[28:31], v[52:59], v3
v_smfmac_f32_16x16x64_bf16 v[44:47], v[12:15], v[144:151], v3
ds_read_b128 v[60:63], v6 offset:10240
ds_read_b128 v[64:67], v6 offset:11264
v_smfmac_f32_16x16x64_bf16 v[44:47], v[16:19], v[152:159], v3
v_smfmac_f32_16x16x64_bf16 v[44:47], v[20:23], v[160:167], v3
v_cvt_pk_bf16_f32 v72, v40, v41
v_cvt_pk_bf16_f32 v74, v42, v43
v_smfmac_f32_16x16x64_bf16 v[44:47], v[24:27], v[168:175], v3
v_mov_b64 v[40:41], 0
v_smfmac_f32_16x16x64_bf16 v[44:47], v[28:31], v[176:183], v3
v_mov_b64 v[42:43], 0
v_smfmac_f32_16x16x64_bf16 v[44:47], v[32:35], v[184:191], v3
v_smfmac_f32_16x16x64_bf16 v[44:47], v[36:39], v[192:199], v3
s_waitcnt lgkmcnt(0)
v_smfmac_f32_16x16x64_bf16 v[116:119], v[32:35], v[60:67], v3
v_smfmac_f32_16x16x64_bf16 v[40:43], v[12:15], v[200:207], v3
ds_read_b128 v[52:55], v6 offset:12288
ds_read_b128 v[56:59], v6 offset:13312
v_smfmac_f32_16x16x64_bf16 v[40:43], v[16:19], v[208:215], v3
v_smfmac_f32_16x16x64_bf16 v[40:43], v[20:23], v[216:223], v3
v_cvt_pk_bf16_f32 v80, v44, v45
v_cvt_pk_bf16_f32 v82, v46, v47
v_smfmac_f32_16x16x64_bf16 v[40:43], v[24:27], v[224:231], v3
v_smfmac_f32_16x16x64_bf16 v[40:43], v[28:31], v[232:239], v3
v_smfmac_f32_16x16x64_bf16 v[40:43], v[32:35], v[240:247], v3
v_smfmac_f32_16x16x64_bf16 v[40:43], v[36:39], v[248:255], v3
s_waitcnt lgkmcnt(0)
v_smfmac_f32_16x16x64_bf16 v[116:119], v[36:39], v[52:59], v3
s_nop 6
v_cvt_pk_bf16_f32 v73, v40, v41
v_cvt_pk_bf16_f32 v75, v42, v43
v_cvt_pk_bf16_f32 v81, v116, v117
v_cvt_pk_bf16_f32 v83, v118, v119
s_cmp_ge_u32 s12, 63
s_cbranch_scc1 LB_fin
v_mov_b64 v[24:25], 0
v_mov_b64 v[26:27], 0
v_mov_b64 v[28:29], 0
v_mov_b64 v[30:31], 0
s_add_u32 s61, s16, 7168
s_mov_b32 s28, 0
buffer_load_dwordx4 v[12:15], v7, s[4:7], s17 offen sc1
buffer_load_dwordx4 v[16:19], v7, s[4:7], s17 offen offset:1024 sc1
buffer_load_dwordx4 v[20:23], v8, s[4:7], s17 offen sc1
s_sleep 2
LB_pp:
buffer_load_dwordx4 v[52:55], v7, s[4:7], s17 offen sc1
buffer_load_dwordx4 v[56:59], v7, s[4:7], s17 offen offset:1024 sc1
buffer_load_dwordx4 v[60:63], v8, s[4:7], s17 offen sc1
s_waitcnt vmcnt(3)
v_or3_b32 v32, v12, v13, v14
v_or3_b32 v33, v15, v16, v17
v_or3_b32 v34, v18, v19, v20
v_or3_b32 v32, v32, v21, v22
v_or3_b32 v33, v33, v34, v23
v_or_b32 v32, v32, v33
v_and_b32 v32, 0x80008000, v32
v_cmp_ne_u32 vcc, 0, v32
s_cbranch_vccz LB_pk0
buffer_load_dwordx4 v[12:15], v7, s[4:7], s17 offen sc1
buffer_load_dwordx4 v[16:19], v7, s[4:7], s17 offen offset:1024 sc1
buffer_load_dwordx4 v[20:23], v8, s[4:7], s17 offen sc1
s_waitcnt vmcnt(3)
v_or3_b32 v32, v52, v53, v54
v_or3_b32 v33, v55, v56, v57
v_or3_b32 v34, v58, v59, v60
v_or3_b32 v32, v32, v61, v62
v_or3_b32 v33, v33, v34, v63
v_or_b32 v32, v32, v33
v_and_b32 v32, 0x80008000, v32
v_cmp_ne_u32 vcc, 0, v32
s_cbranch_vccz LB_pk1
s_add_u32 s28, s28, 1
s_cmp_lt_u32 s28, 20000
s_cbranch_scc1 LB_pp
s_waitcnt vmcnt(0)
s_branch LB_pk1
LB_pk0:
v_smfmac_f32_16x16x64_bf16 v[24:27], v[20:23], v[68:75], v3
v_smfmac_f32_16x16x64_bf16 v[28:31], v[20:23], v[76:83], v3
v_smfmac_f32_16x16x64_bf16 v[24:27], v[12:15], v[84:91], v3
v_smfmac_f32_16x16x64_bf16 v[28:31], v[12:15], v[92:99], v3
v_smfmac_f32_16x16x64_bf16 v[24:27], v[16:19], v[100:107], v3
v_smfmac_f32_16x16x64_bf16 v[28:31], v[16:19], v[108:115], v3
s_branch LB_pv
LB_pk1:
v_smfmac_f32_16x16x64_bf16 v[24:27], v[60:63], v[68:75], v3
v_smfmac_f32_16x16x64_bf16 v[28:31], v[60:63], v[76:83], v3
v_smfmac_f32_16x16x64_bf16 v[24:27], v[52:55], v[84:91], v3
v_smfmac_f32_16x16x64_bf16 v[28:31], v[52:55], v[92:99], v3
v_smfmac_f32_16x16x64_bf16 v[24:27], v[56:59], v[100:107], v3
v_smfmac_f32_16x16x64_bf16 v[28:31], v[56:59], v[108:115], v3
LB_pv:
s_nop 5
ds_write_b128 v1, v[24:27]
s_nop 1
ds_write_b128 v1, v[28:31] offset:1024
s_waitcnt lgkmcnt(0)
s_barrier
ds_read_b32 v32, v9 offset:0
ds_read_b32 v33, v9 offset:512
ds_read_b32 v34, v9 offset:2048
ds_read_b32 v35, v9 offset:2560
ds_read_b32 v36, v9 offset:4096
ds_read_b32 v37, v9 offset:4608
ds_read_b32 v38, v9 offset:6144
ds_read_b32 v39, v9 offset:6656
s_waitcnt lgkmcnt(4)
v_add_f32 v32, v32, v33
v_add_f32 v34, v34, v35
s_waitcnt lgkmcnt(0)
v_add_f32 v36, v36, v37
v_add_f32 v38, v38, v39
v_add_f32 v32, v32, v34
v_add_f32 v36, v36, v38
v_add_f32 v32, v32, v36
s_nop 1
v_mov_b32_dpp v33, v32 row_shl:4 row_mask:0xf bank_mask:0xf
v_cvt_pk_bf16_f32 v32, v32, v33
v_min_u32 v32, 0xfffffffe, v32
s_mov_b64 exec, s[62:63]
buffer_store_dword v32, v10, s[4:7], s61 offen
s_mov_b64 exec, -1
s_sleep 6
s_add_u32 s12, s12, 1
s_add_u32 s16, s16, 7168
s_add_u32 s17, s17, 10240
s_add_u32 s19, s19, 229376
s_branch LB_loop
LB_fin:
s_add_u32 s19, s19, 229376
s_waitcnt vmcnt(0)
s_branch L_exit
L_warm:
v_and_b32 v1, 63, v0
v_lshlrev_b32 v2, 4, v1
s_cmp_lg_u32 s24, 0
s_cbranch_scc1 LWM_ln_w
v_mov_b32 v4, 75019392
s_mov_b32 s47, 0
LWM_ln_p:
buffer_load_dword v5, v4, s[4:7], 0 offen sc1
s_waitcnt vmcnt(0)
v_readfirstlane_b32 s46, v5
s_add_u32 s47, s47, 1
s_nop 1
s_cmp_ge_u32 s46, 256
s_cbranch_scc1 LWM_ln_w
s_cmp_gt_u32 s47, 20000
s_cbranch_scc1 LWM_ln_w
s_sleep 1
s_branch LWM_ln_p
LWM_ln_w:
s_barrier
v_and_b32 v1, 63, v0
v_lshlrev_b32 v2, 7, v1
v_lshlrev_b32 v6, 4, v1
s_sub_u32 s20, s13, 30
s_lshl_b32 s20, s20, 2
s_add_u32 s15, s20, s14
s_mov_b32 s12, 1
s_lshl_b32 s20, s15, 10
s_add_u32 s16, s20, 44047360
s_cmp_eq_u32 s15, 7
s_cbranch_scc1 LWM_w
LWM_f:
s_mov_b32 s28, 0
LWM_fp:
buffer_load_dwordx4 v[8:11], v6, s[4:7], s16 offen sc1
s_waitcnt vmcnt(0)
v_max3_u32 v12, v8, v9, v10
v_max_u32 v12, v12, v11
v_cmp_eq_u32 vcc, -1, v12
s_cbranch_vccz LWM_fg
s_add_u32 s28, s28, 1
s_cmp_gt_u32 s28, 20000
s_cbranch_scc1 LWM_fg
s_sleep 2
s_branch LWM_fp
LWM_fg:
s_add_u32 s20, s16, 30474240
buffer_store_dwordx4 v[8:11], v6, s[4:7], s20 offen sc1
s_add_u32 s16, s16, 7168
s_add_u32 s12, s12, 1
s_cmp_lt_u32 s12, 64
s_waitcnt vmcnt(0)
s_cbranch_scc1 LWM_f
s_branch L_exit
LWM_w:
v_mov_b32 v3, 0
s_mov_b32 s12, 0
s_mov_b32 s16, 44040192
s_mov_b32 s17, 44498944
s_mov_b32 s18, 42262528
LWM_loop:
s_mov_b32 s28, 0
LWM_p:
buffer_load_dword v4, v3, s[4:7], s16 offen sc1
s_waitcnt vmcnt(0)
v_cmp_eq_u32 vcc, -1, v4
s_cbranch_vccz LWM_go
s_add_u32 s28, s28, 1
s_cmp_gt_u32 s28, 20000
s_cbranch_scc1 LWM_go
s_sleep 2
s_branch LWM_p
LWM_go:
s_add_u32 s20, s16, 7168
buffer_load_dword v5, v2, s[4:7], s20 offen sc1
buffer_load_dword v5, v2, s[4:7], s17 offen sc1
s_add_u32 s20, s17, 8192
buffer_load_dword v5, v2, s[4:7], s20 offen sc1
s_add_u32 s20, s18, 0
buffer_load_dword v5, v2, s[4:7], s20 offen sc1
s_add_u32 s20, s18, 8192
buffer_load_dword v5, v2, s[4:7], s20 offen sc1
s_add_u32 s20, s18, 16384
buffer_load_dword v5, v2, s[4:7], s20 offen sc1
s_add_u32 s20, s18, 24576
buffer_load_dword v5, v2, s[4:7], s20 offen sc1
s_add_u32 s12, s12, 1
s_add_u32 s16, s16, 7168
s_add_u32 s17, s17, 10240
s_add_u32 s18, s18, 28672
s_cmp_lt_u32 s12, 63
s_cbranch_scc1 LWM_loop
s_branch L_exit
L_worker:
s_sub_u32 s22, s13, 64
v_lshlrev_b32 v4, 4, v0
v_mov_b32 v8, -1
v_mov_b32 v9, -1
v_mov_b32 v10, -1
v_mov_b32 v11, -1
s_mul_i32 s28, s22, 4944
s_add_u32 s28, s28, 44047360
s_add_u32 s29, s28, 4944
s_min_u32 s29, s29, 45154304
v_add_u32 v5, s28, v4
v_cmp_gt_u32 vcc, s29, v5
s_and_saveexec_b64 s[30:31], vcc
s_cbranch_execz L_fl0
buffer_store_dwordx4 v[8:11], v5, s[4:7], 0 offen sc1
L_fl0:
s_mov_b64 exec, s[30:31]
s_add_u32 s28, s28, 4096
v_add_u32 v5, s28, v4
v_cmp_gt_u32 vcc, s29, v5
s_and_saveexec_b64 s[30:31], vcc
s_cbranch_execz L_fl1
buffer_store_dwordx4 v[8:11], v5, s[4:7], 0 offen sc1
L_fl1:
s_mov_b64 exec, s[30:31]
s_add_u32 s28, s28, 4096
s_mul_i32 s28, s22, 2016
s_add_u32 s28, s28, 74521600
v_cmp_gt_u32 vcc, 2016, v4
s_and_saveexec_b64 s[30:31], vcc
s_cbranch_execz L_fl2
buffer_store_dwordx4 v[8:11], v4, s[4:7], s28 offen sc1
L_fl2:
s_mov_b64 exec, s[30:31]
s_cmp_lg_u32 s22, 0
s_cbranch_scc1 L_nom0
s_load_dwordx2 s[16:17], s[0:1], 8
s_waitcnt lgkmcnt(0)
s_and_b32 s17, s17, 0xffff
s_mov_b32 s18, 7168
s_mov_b32 s19, 0x20000
v_add_u32 v5, 0, v0
v_and_b32 v6, 7, v5
v_mul_u32_u24 v6, 896, v6
v_lshrrev_b32 v7, 3, v5
v_lshl_add_u32 v6, v7, 4, v6
v_lshlrev_b32 v5, 4, v5
v_cmp_gt_u32 vcc, 7168, v5
s_and_saveexec_b64 s[30:31], vcc
s_cbranch_execz L_m0s0
buffer_load_dwordx4 v[12:15], v6, s[16:19], 0 offen
s_waitcnt vmcnt(0)
s_mov_b32 s28, 44040192
buffer_store_dwordx4 v[12:15], v5, s[4:7], s28 offen sc1
s_mov_b32 s28, 74514432
buffer_store_dwordx4 v[12:15], v5, s[4:7], s28 offen sc1
s_waitcnt vmcnt(0)
L_m0s0:
s_mov_b64 exec, s[30:31]
v_add_u32 v5, 256, v0
v_and_b32 v6, 7, v5
v_mul_u32_u24 v6, 896, v6
v_lshrrev_b32 v7, 3, v5
v_lshl_add_u32 v6, v7, 4, v6
v_lshlrev_b32 v5, 4, v5
v_cmp_gt_u32 vcc, 7168, v5
s_and_saveexec_b64 s[30:31], vcc
s_cbranch_execz L_m0s1
buffer_load_dwordx4 v[12:15], v6, s[16:19], 0 offen
s_waitcnt vmcnt(0)
s_mov_b32 s28, 44040192
buffer_store_dwordx4 v[12:15], v5, s[4:7], s28 offen sc1
s_mov_b32 s28, 74514432
buffer_store_dwordx4 v[12:15], v5, s[4:7], s28 offen sc1
s_waitcnt vmcnt(0)
L_m0s1:
s_mov_b64 exec, s[30:31]
L_nom0:
s_mul_i32 s68, s22, 9363
s_lshr_b32 s68, s68, 16
s_mul_i32 s69, s68, 7
s_sub_u32 s69, s22, s69
s_lshr_b32 s26, s68, 1
s_and_b32 s25, s68, 1
s_mov_b32 s67, 0
s_add_u32 s28, s69, 7
s_lshr_b32 s65, s28, 1
s_and_b32 s66, s28, 1
s_cmp_eq_u32 s25, 0
s_cbranch_scc0 L_p0B
L_p0r0:
s_mul_i32 s28, s67, 7
s_add_u32 s28, s28, s69
s_lshr_b32 s27, s28, 1
s_and_b32 s23, s28, 1
v_and_b32 v1, 63, v0
s_load_dwordx2 s[8:9], s[0:1], 16
s_load_dwordx2 s[12:13], s[0:1], 24
s_waitcnt lgkmcnt(0)
s_and_b32 s9, s9, 0xffff
s_mov_b32 s10, 3670016
s_mov_b32 s11, 0x20000
s_and_b32 s13, s13, 0xffff
s_mov_b32 s14, 3670016
s_mov_b32 s15, 0x20000
s_mul_i32 s36, s23, 14
s_cmp_lt_u32 s24, 2
s_cselect_b32 s37, 1, 0
s_lshl_b32 s28, s24, 2
s_cmp_eq_u32 s24, 3
s_cselect_b32 s29, 1, 0
s_sub_u32 s28, s28, s29
s_add_u32 s36, s36, s28
v_lshlrev_b32 v2, 4, v1
v_lshrrev_b32 v4, 5, v1
v_lshlrev_b32 v3, 13, v4
v_and_b32 v5, 31, v1
v_lshl_add_u32 v3, v5, 4, v3
v_mul_u32_u24 v6, 528, v4
v_lshl_add_u32 v6, v5, 4, v6
s_lshl_b32 s28, s27, 19
s_lshl_b32 s29, s26, 9
s_add_u32 s28, s28, s29
s_lshl_b32 s29, s24, 17
s_add_u32 s28, s28, s29
s_lshl_b32 s60, s65, 19
s_lshl_b32 s29, s26, 9
s_add_u32 s60, s60, s29
s_lshl_b32 s29, s24, 17
s_add_u32 s60, s60, s29
s_cmp_eq_u32 s67, 0
s_cbranch_scc1 Q20_r0
s_waitcnt vmcnt(0)
Q20_r0:
s_cmp_lg_u32 s67, 0
s_cbranch_scc1 Q20_sk1
s_add_u32 s30, s28, 0
buffer_load_dwordx4 v[208:211], v3, s[8:11], s30 offen
s_add_u32 s30, s28, 16384
buffer_load_dwordx4 v[212:215], v3, s[8:11], s30 offen
s_add_u32 s30, s28, 32768
buffer_load_dwordx4 v[216:219], v3, s[8:11], s30 offen
s_add_u32 s30, s28, 49152
buffer_load_dwordx4 v[220:223], v3, s[8:11], s30 offen
s_add_u32 s30, s28, 65536
buffer_load_dwordx4 v[224:227], v3, s[8:11], s30 offen
s_add_u32 s30, s28, 81920
buffer_load_dwordx4 v[228:231], v3, s[8:11], s30 offen
s_add_u32 s30, s28, 98304
buffer_load_dwordx4 v[232:235], v3, s[8:11], s30 offen
s_add_u32 s30, s28, 114688
buffer_load_dwordx4 v[236:239], v3, s[8:11], s30 offen
Q20_sk1:
s_mul_i32 s31, s26, 28
s_add_u32 s31, s31, s36
s_mul_i32 s31, s31, 7
s_add_u32 s31, s31, s27
s_lshl_b32 s31, s31, 11
s_mul_i32 s33, s25, 6422528
s_add_u32 s31, s31, s33
v_and_b32 v4, 15, v1
v_lshrrev_b32 v5, 3, v4
v_lshlrev_b32 v7, 4, v5
v_bfe_u32 v5, v4, 2, 1
v_lshl_add_u32 v7, v5, 2, v7
v_and_b32 v5, 1, v4
v_add_u32 v7, v7, v5
v_bfe_u32 v5, v4, 1, 1
v_lshl_add_u32 v7, v5, 3, v7
v_mul_u32_u24 v7, 528, v7
v_lshrrev_b32 v5, 4, v1
v_lshl_add_u32 v7, v5, 4, v7
s_mul_i32 s32, s36, 131072
s_lshl_b32 s33, s26, 9
s_add_u32 s32, s32, s33
s_mul_i32 s61, s66, 14
s_mul_i32 s33, s23, 14
s_sub_u32 s33, s36, s33
s_add_u32 s61, s61, s33
s_mul_i32 s61, s61, 131072
s_lshl_b32 s33, s26, 9
s_add_u32 s61, s61, s33
s_cmp_lg_u32 s67, 0
s_cbranch_scc1 Q20_sk2
s_add_u32 s30, s32, 0
buffer_load_dwordx4 v[20:23], v3, s[12:15], s30 offen
s_add_u32 s30, s32, 16384
buffer_load_dwordx4 v[24:27], v3, s[12:15], s30 offen
s_add_u32 s30, s32, 32768
buffer_load_dwordx4 v[28:31], v3, s[12:15], s30 offen
s_add_u32 s30, s32, 49152
buffer_load_dwordx4 v[32:35], v3, s[12:15], s30 offen
s_add_u32 s30, s32, 65536
buffer_load_dwordx4 v[36:39], v3, s[12:15], s30 offen
s_add_u32 s30, s32, 81920
buffer_load_dwordx4 v[40:43], v3, s[12:15], s30 offen
s_add_u32 s30, s32, 98304
buffer_load_dwordx4 v[44:47], v3, s[12:15], s30 offen
s_add_u32 s30, s32, 114688
buffer_load_dwordx4 v[48:51], v3, s[12:15], s30 offen
s_add_u32 s30, s32, 131072
buffer_load_dwordx4 v[52:55], v3, s[12:15], s30 offen
s_add_u32 s30, s32, 147456
buffer_load_dwordx4 v[56:59], v3, s[12:15], s30 offen
s_add_u32 s30, s32, 163840
buffer_load_dwordx4 v[60:63], v3, s[12:15], s30 offen
s_add_u32 s30, s32, 180224
buffer_load_dwordx4 v[64:67], v3, s[12:15], s30 offen
s_add_u32 s30, s32, 196608
buffer_load_dwordx4 v[68:71], v3, s[12:15], s30 offen
s_add_u32 s30, s32, 212992
buffer_load_dwordx4 v[72:75], v3, s[12:15], s30 offen
s_add_u32 s30, s32, 229376
buffer_load_dwordx4 v[76:79], v3, s[12:15], s30 offen
s_add_u32 s30, s32, 245760
buffer_load_dwordx4 v[80:83], v3, s[12:15], s30 offen
s_add_u32 s30, s32, 262144
buffer_load_dwordx4 v[84:87], v3, s[12:15], s30 offen
s_add_u32 s30, s32, 278528
buffer_load_dwordx4 v[88:91], v3, s[12:15], s30 offen
s_add_u32 s30, s32, 294912
buffer_load_dwordx4 v[92:95], v3, s[12:15], s30 offen
s_add_u32 s30, s32, 311296
buffer_load_dwordx4 v[96:99], v3, s[12:15], s30 offen
s_add_u32 s30, s32, 327680
buffer_load_dwordx4 v[100:103], v3, s[12:15], s30 offen
s_add_u32 s30, s32, 344064
buffer_load_dwordx4 v[104:107], v3, s[12:15], s30 offen
s_add_u32 s30, s32, 360448
buffer_load_dwordx4 v[108:111], v3, s[12:15], s30 offen
s_add_u32 s30, s32, 376832
buffer_load_dwordx4 v[112:115], v3, s[12:15], s30 offen
s_add_u32 s30, s32, 393216
buffer_load_dwordx4 v[116:119], v3, s[12:15], s30 offen
s_add_u32 s30, s32, 409600
buffer_load_dwordx4 v[120:123], v3, s[12:15], s30 offen
s_add_u32 s30, s32, 425984
buffer_load_dwordx4 v[124:127], v3, s[12:15], s30 offen
s_add_u32 s30, s32, 442368
buffer_load_dwordx4 v[128:131], v3, s[12:15], s30 offen
s_add_u32 s30, s32, 458752
buffer_load_dwordx4 v[132:135], v3, s[12:15], s30 offen
s_add_u32 s30, s32, 475136
buffer_load_dwordx4 v[136:139], v3, s[12:15], s30 offen
s_add_u32 s30, s32, 491520
buffer_load_dwordx4 v[140:143], v3, s[12:15], s30 offen
s_add_u32 s30, s32, 507904
buffer_load_dwordx4 v[144:147], v3, s[12:15], s30 offen
Q20_sk2:
s_waitcnt vmcnt(32)
s_mul_i32 s34, s24, 8448
v_add_u32 v4, s34, v6
ds_write_b128 v4, v[208:211] offset:0
ds_write_b128 v4, v[212:215] offset:1056
ds_write_b128 v4, v[216:219] offset:2112
ds_write_b128 v4, v[220:223] offset:3168
ds_write_b128 v4, v[224:227] offset:4224
ds_write_b128 v4, v[228:231] offset:5280
ds_write_b128 v4, v[232:235] offset:6336
ds_write_b128 v4, v[236:239] offset:7392
s_waitcnt lgkmcnt(0)
s_barrier
s_cmp_eq_u32 s67, 0
s_cbranch_scc1 Q2h0_s
s_cmp_lg_u32 s24, 0
s_cbranch_scc1 Q2h0_s
v_mov_b32 v12, 16
s_mov_b32 s47, 0
Q2h0_r_p:
buffer_load_dword v13, v12, s[92:95], 0 offen sc1
s_waitcnt vmcnt(0)
v_readfirstlane_b32 s46, v13
s_add_u32 s47, s47, 1
s_nop 1
s_cmp_lg_u32 s46, 0
s_cbranch_scc1 Q2h0_r_o
s_cmp_lt_u32 s47, 20000
s_cbranch_scc1 Q2h0_r_p
Q2h0_r_o:
s_lshl_b32 s46, s26, 7
s_add_u32 s46, s46, 75015296
v_mov_b32 v12, s46
v_mov_b32 v13, 1
s_mov_b64 exec, 1
buffer_atomic_add v13, v12, s[4:7], 0 offen
v_mov_b32 v12, 75019392
v_mov_b32 v13, 1
buffer_atomic_add v13, v12, s[4:7], 0 offen
s_mov_b64 exec, -1
Q2h0_s:
ds_read_b128 a[0:3], v7 offset:0
ds_read_b128 a[4:7], v7 offset:64
ds_read_b128 a[8:11], v7 offset:128
ds_read_b128 a[12:15], v7 offset:192
ds_read_b128 a[16:19], v7 offset:256
ds_read_b128 a[20:23], v7 offset:320
ds_read_b128 a[24:27], v7 offset:384
ds_read_b128 a[28:31], v7 offset:448
s_waitcnt lgkmcnt(4)
ds_read_b128 a[32:35], v7 offset:1056
ds_read_b128 a[36:39], v7 offset:1120
ds_read_b128 a[40:43], v7 offset:1184
ds_read_b128 a[44:47], v7 offset:1248
ds_read_b128 a[48:51], v7 offset:1312
ds_read_b128 a[52:55], v7 offset:1376
ds_read_b128 a[56:59], v7 offset:1440
ds_read_b128 a[60:63], v7 offset:1504
s_waitcnt lgkmcnt(4)
ds_read_b128 a[64:67], v7 offset:16896
ds_read_b128 a[68:71], v7 offset:16960
ds_read_b128 a[72:75], v7 offset:17024
ds_read_b128 a[76:79], v7 offset:17088
ds_read_b128 a[80:83], v7 offset:17152
ds_read_b128 a[84:87], v7 offset:17216
ds_read_b128 a[88:91], v7 offset:17280
ds_read_b128 a[92:95], v7 offset:17344
s_waitcnt lgkmcnt(4)
ds_read_b128 a[96:99], v7 offset:17952
ds_read_b128 a[100:103], v7 offset:18016
ds_read_b128 a[104:107], v7 offset:18080
ds_read_b128 a[108:111], v7 offset:18144
ds_read_b128 a[112:115], v7 offset:18208
ds_read_b128 a[116:119], v7 offset:18272
ds_read_b128 a[120:123], v7 offset:18336
ds_read_b128 a[124:127], v7 offset:18400
s_waitcnt lgkmcnt(4)
s_waitcnt lgkmcnt(0)
s_cmp_lg_u32 s67, 0
s_cbranch_scc1 Q20_sk3
s_add_u32 s30, s60, 0
buffer_load_dwordx4 v[208:211], v3, s[8:11], s30 offen
s_add_u32 s30, s60, 16384
buffer_load_dwordx4 v[212:215], v3, s[8:11], s30 offen
s_add_u32 s30, s60, 32768
buffer_load_dwordx4 v[216:219], v3, s[8:11], s30 offen
s_add_u32 s30, s60, 49152
buffer_load_dwordx4 v[220:223], v3, s[8:11], s30 offen
s_add_u32 s30, s60, 65536
buffer_load_dwordx4 v[224:227], v3, s[8:11], s30 offen
s_add_u32 s30, s60, 81920
buffer_load_dwordx4 v[228:231], v3, s[8:11], s30 offen
s_add_u32 s30, s60, 98304
buffer_load_dwordx4 v[232:235], v3, s[8:11], s30 offen
s_add_u32 s30, s60, 114688
buffer_load_dwordx4 v[236:239], v3, s[8:11], s30 offen
Q20_sk3:
s_mul_i32 s34, s24, 8448
s_add_u32 s34, s34, 33792
v_add_u32 v8, s34, v6
v_and_b32 v4, 15, v1
v_mul_u32_u24 v9, 528, v4
v_lshrrev_b32 v5, 4, v1
v_lshl_add_u32 v9, v5, 4, v9
v_add_u32 v9, s34, v9
v_mov_b32 v4, 0x3db8aa3b
s_waitcnt vmcnt(32)
ds_write_b128 v8, v[20:23] offset:0
ds_write_b128 v8, v[24:27] offset:1056
ds_write_b128 v8, v[28:31] offset:2112
ds_write_b128 v8, v[32:35] offset:3168
ds_write_b128 v8, v[36:39] offset:4224
ds_write_b128 v8, v[40:43] offset:5280
ds_write_b128 v8, v[44:47] offset:6336
ds_write_b128 v8, v[48:51] offset:7392
ds_read_b128 a[128:131], v9 offset:0
ds_read_b128 a[132:135], v9 offset:64
ds_read_b128 a[136:139], v9 offset:128
ds_read_b128 a[140:143], v9 offset:192
ds_read_b128 a[144:147], v9 offset:256
ds_read_b128 a[148:151], v9 offset:320
ds_read_b128 a[152:155], v9 offset:384
ds_read_b128 a[156:159], v9 offset:448
s_waitcnt lgkmcnt(0)
s_waitcnt vmcnt(24)
s_cmp_lg_u32 s67, 0
s_cbranch_scc1 Q20_sk4
s_add_u32 s30, s61, 0
buffer_load_dwordx4 v[20:23], v3, s[12:15], s30 offen
s_add_u32 s30, s61, 16384
buffer_load_dwordx4 v[24:27], v3, s[12:15], s30 offen
s_add_u32 s30, s61, 32768
buffer_load_dwordx4 v[28:31], v3, s[12:15], s30 offen
s_add_u32 s30, s61, 49152
buffer_load_dwordx4 v[32:35], v3, s[12:15], s30 offen
s_add_u32 s30, s61, 65536
buffer_load_dwordx4 v[36:39], v3, s[12:15], s30 offen
s_add_u32 s30, s61, 81920
buffer_load_dwordx4 v[40:43], v3, s[12:15], s30 offen
s_add_u32 s30, s61, 98304
buffer_load_dwordx4 v[44:47], v3, s[12:15], s30 offen
s_add_u32 s30, s61, 114688
buffer_load_dwordx4 v[48:51], v3, s[12:15], s30 offen
Q20_sk4:
v_mfma_f32_16x16x32_bf16 v[240:243], a[0:3], a[128:131], 0
ds_write_b128 v8, v[52:55] offset:33792
v_mfma_f32_16x16x32_bf16 v[240:243], a[4:7], a[132:135], v[240:243]
v_mfma_f32_16x16x32_bf16 v[240:243], a[8:11], a[136:139], v[240:243]
ds_write_b128 v8, v[56:59] offset:34848
v_mfma_f32_16x16x32_bf16 v[240:243], a[12:15], a[140:143], v[240:243]
v_mfma_f32_16x16x32_bf16 v[240:243], a[16:19], a[144:147], v[240:243]
ds_write_b128 v8, v[60:63] offset:35904
v_mfma_f32_16x16x32_bf16 v[240:243], a[20:23], a[148:151], v[240:243]
v_mfma_f32_16x16x32_bf16 v[240:243], a[24:27], a[152:155], v[240:243]
ds_write_b128 v8, v[64:67] offset:36960
v_mfma_f32_16x16x32_bf16 v[240:243], a[28:31], a[156:159], v[240:243]
v_mfma_f32_16x16x32_bf16 v[244:247], a[32:35], a[128:131], 0
ds_write_b128 v8, v[68:71] offset:38016
v_mfma_f32_16x16x32_bf16 v[244:247], a[36:39], a[132:135], v[244:247]
v_mfma_f32_16x16x32_bf16 v[244:247], a[40:43], a[136:139], v[244:247]
ds_write_b128 v8, v[72:75] offset:39072
v_mfma_f32_16x16x32_bf16 v[244:247], a[44:47], a[140:143], v[244:247]
v_mfma_f32_16x16x32_bf16 v[244:247], a[48:51], a[144:147], v[244:247]
ds_write_b128 v8, v[76:79] offset:40128
v_mfma_f32_16x16x32_bf16 v[244:247], a[52:55], a[148:151], v[244:247]
v_mfma_f32_16x16x32_bf16 v[244:247], a[56:59], a[152:155], v[244:247]
ds_write_b128 v8, v[80:83] offset:41184
v_mfma_f32_16x16x32_bf16 v[244:247], a[60:63], a[156:159], v[244:247]
v_mfma_f32_16x16x32_bf16 v[248:251], a[64:67], a[128:131], 0
ds_read_b128 a[160:163], v9 offset:33792
v_mfma_f32_16x16x32_bf16 v[248:251], a[68:71], a[132:135], v[248:251]
v_mfma_f32_16x16x32_bf16 v[248:251], a[72:75], a[136:139], v[248:251]
ds_read_b128 a[164:167], v9 offset:33856
v_mfma_f32_16x16x32_bf16 v[248:251], a[76:79], a[140:143], v[248:251]
v_mfma_f32_16x16x32_bf16 v[248:251], a[80:83], a[144:147], v[248:251]
ds_read_b128 a[168:171], v9 offset:33920
v_mfma_f32_16x16x32_bf16 v[248:251], a[84:87], a[148:151], v[248:251]
v_mfma_f32_16x16x32_bf16 v[248:251], a[88:91], a[152:155], v[248:251]
ds_read_b128 a[172:175], v9 offset:33984
v_mfma_f32_16x16x32_bf16 v[248:251], a[92:95], a[156:159], v[248:251]
v_mfma_f32_16x16x32_bf16 v[252:255], a[96:99], a[128:131], 0
ds_read_b128 a[176:179], v9 offset:34048
v_mfma_f32_16x16x32_bf16 v[252:255], a[100:103], a[132:135], v[252:255]
v_mfma_f32_16x16x32_bf16 v[252:255], a[104:107], a[136:139], v[252:255]
ds_read_b128 a[180:183], v9 offset:34112
v_mfma_f32_16x16x32_bf16 v[252:255], a[108:111], a[140:143], v[252:255]
v_mfma_f32_16x16x32_bf16 v[252:255], a[112:115], a[144:147], v[252:255]
ds_read_b128 a[184:187], v9 offset:34176
v_mfma_f32_16x16x32_bf16 v[252:255], a[116:119], a[148:151], v[252:255]
v_mfma_f32_16x16x32_bf16 v[252:255], a[120:123], a[152:155], v[252:255]
ds_read_b128 a[188:191], v9 offset:34240
v_mfma_f32_16x16x32_bf16 v[252:255], a[124:127], a[156:159], v[252:255]
s_nop 7
v_mul_f32 v240, v240, v4
v_mul_f32 v241, v241, v4
v_mul_f32 v242, v242, v4
v_mul_f32 v243, v243, v4
v_mul_f32 v244, v244, v4
v_mul_f32 v245, v245, v4
v_mul_f32 v246, v246, v4
v_mul_f32 v247, v247, v4
v_mul_f32 v248, v248, v4
v_mul_f32 v249, v249, v4
v_mul_f32 v250, v250, v4
v_mul_f32 v251, v251, v4
v_mul_f32 v252, v252, v4
v_mul_f32 v253, v253, v4
v_mul_f32 v254, v254, v4
v_mul_f32 v255, v255, v4
v_cvt_pk_bf16_f32 v12, v240, v241
v_cvt_pk_bf16_f32 v13, v242, v243
v_cvt_pk_bf16_f32 v14, v244, v245
v_cvt_pk_bf16_f32 v15, v246, v247
buffer_store_dwordx4 v[12:15], v2, s[4:7], s31 offen offset:0 sc1
v_cvt_pk_bf16_f32 v16, v248, v249
v_cvt_pk_bf16_f32 v17, v250, v251
v_cvt_pk_bf16_f32 v18, v252, v253
v_cvt_pk_bf16_f32 v19, v254, v255
buffer_store_dwordx4 v[16:19], v2, s[4:7], s31 offen offset:1024 sc1
s_nop 2
s_add_u32 s31, s31, 14336
s_waitcnt lgkmcnt(0)
s_waitcnt vmcnt(26)
s_cmp_lg_u32 s67, 0
s_cbranch_scc1 Q20_sk5
s_add_u32 s30, s61, 131072
buffer_load_dwordx4 v[52:55], v3, s[12:15], s30 offen
s_add_u32 s30, s61, 147456
buffer_load_dwordx4 v[56:59], v3, s[12:15], s30 offen
s_add_u32 s30, s61, 163840
buffer_load_dwordx4 v[60:63], v3, s[12:15], s30 offen
s_add_u32 s30, s61, 180224
buffer_load_dwordx4 v[64:67], v3, s[12:15], s30 offen
s_add_u32 s30, s61, 196608
buffer_load_dwordx4 v[68:71], v3, s[12:15], s30 offen
s_add_u32 s30, s61, 212992
buffer_load_dwordx4 v[72:75], v3, s[12:15], s30 offen
s_add_u32 s30, s61, 229376
buffer_load_dwordx4 v[76:79], v3, s[12:15], s30 offen
s_add_u32 s30, s61, 245760
buffer_load_dwordx4 v[80:83], v3, s[12:15], s30 offen
Q20_sk5:
v_mfma_f32_16x16x32_bf16 v[240:243], a[0:3], a[160:163], 0
ds_write_b128 v8, v[84:87] offset:0
v_mfma_f32_16x16x32_bf16 v[240:243], a[4:7], a[164:167], v[240:243]
v_mfma_f32_16x16x32_bf16 v[240:243], a[8:11], a[168:171], v[240:243]
ds_write_b128 v8, v[88:91] offset:1056
v_mfma_f32_16x16x32_bf16 v[240:243], a[12:15], a[172:175], v[240:243]
v_mfma_f32_16x16x32_bf16 v[240:243], a[16:19], a[176:179], v[240:243]
ds_write_b128 v8, v[92:95] offset:2112
v_mfma_f32_16x16x32_bf16 v[240:243], a[20:23], a[180:183], v[240:243]
v_mfma_f32_16x16x32_bf16 v[240:243], a[24:27], a[184:187], v[240:243]
ds_write_b128 v8, v[96:99] offset:3168
v_mfma_f32_16x16x32_bf16 v[240:243], a[28:31], a[188:191], v[240:243]
v_mfma_f32_16x16x32_bf16 v[244:247], a[32:35], a[160:163], 0
ds_write_b128 v8, v[100:103] offset:4224
v_mfma_f32_16x16x32_bf16 v[244:247], a[36:39], a[164:167], v[244:247]
v_mfma_f32_16x16x32_bf16 v[244:247], a[40:43], a[168:171], v[244:247]
ds_write_b128 v8, v[104:107] offset:5280
v_mfma_f32_16x16x32_bf16 v[244:247], a[44:47], a[172:175], v[244:247]
v_mfma_f32_16x16x32_bf16 v[244:247], a[48:51], a[176:179], v[244:247]
ds_write_b128 v8, v[108:111] offset:6336
v_mfma_f32_16x16x32_bf16 v[244:247], a[52:55], a[180:183], v[244:247]
v_mfma_f32_16x16x32_bf16 v[244:247], a[56:59], a[184:187], v[244:247]
ds_write_b128 v8, v[112:115] offset:7392
v_mfma_f32_16x16x32_bf16 v[244:247], a[60:63], a[188:191], v[244:247]
v_mfma_f32_16x16x32_bf16 v[248:251], a[64:67], a[160:163], 0
ds_read_b128 a[128:131], v9 offset:0
v_mfma_f32_16x16x32_bf16 v[248:251], a[68:71], a[164:167], v[248:251]
v_mfma_f32_16x16x32_bf16 v[248:251], a[72:75], a[168:171], v[248:251]
ds_read_b128 a[132:135], v9 offset:64
v_mfma_f32_16x16x32_bf16 v[248:251], a[76:79], a[172:175], v[248:251]
v_mfma_f32_16x16x32_bf16 v[248:251], a[80:83], a[176:179], v[248:251]
ds_read_b128 a[136:139], v9 offset:128
v_mfma_f32_16x16x32_bf16 v[248:251], a[84:87], a[180:183], v[248:251]
v_mfma_f32_16x16x32_bf16 v[248:251], a[88:91], a[184:187], v[248:251]
ds_read_b128 a[140:143], v9 offset:192
v_mfma_f32_16x16x32_bf16 v[248:251], a[92:95], a[188:191], v[248:251]
v_mfma_f32_16x16x32_bf16 v[252:255], a[96:99], a[160:163], 0
ds_read_b128 a[144:147], v9 offset:256
v_mfma_f32_16x16x32_bf16 v[252:255], a[100:103], a[164:167], v[252:255]
v_mfma_f32_16x16x32_bf16 v[252:255], a[104:107], a[168:171], v[252:255]
ds_read_b128 a[148:151], v9 offset:320
v_mfma_f32_16x16x32_bf16 v[252:255], a[108:111], a[172:175], v[252:255]
v_mfma_f32_16x16x32_bf16 v[252:255], a[112:115], a[176:179], v[252:255]
ds_read_b128 a[152:155], v9 offset:384
v_mfma_f32_16x16x32_bf16 v[252:255], a[116:119], a[180:183], v[252:255]
v_mfma_f32_16x16x32_bf16 v[252:255], a[120:123], a[184:187], v[252:255]
ds_read_b128 a[156:159], v9 offset:448
v_mfma_f32_16x16x32_bf16 v[252:255], a[124:127], a[188:191], v[252:255]
s_nop 7
v_mul_f32 v240, v240, v4
v_mul_f32 v241, v241, v4
v_mul_f32 v242, v242, v4
v_mul_f32 v243, v243, v4
v_mul_f32 v244, v244, v4
v_mul_f32 v245, v245, v4
v_mul_f32 v246, v246, v4
v_mul_f32 v247, v247, v4
v_mul_f32 v248, v248, v4
v_mul_f32 v249, v249, v4
v_mul_f32 v250, v250, v4
v_mul_f32 v251, v251, v4
v_mul_f32 v252, v252, v4
v_mul_f32 v253, v253, v4
v_mul_f32 v254, v254, v4
v_mul_f32 v255, v255, v4
v_cvt_pk_bf16_f32 v12, v240, v241
v_cvt_pk_bf16_f32 v13, v242, v243
v_cvt_pk_bf16_f32 v14, v244, v245
v_cvt_pk_bf16_f32 v15, v246, v247
buffer_store_dwordx4 v[12:15], v2, s[4:7], s31 offen offset:0 sc1
v_cvt_pk_bf16_f32 v16, v248, v249
v_cvt_pk_bf16_f32 v17, v250, v251
v_cvt_pk_bf16_f32 v18, v252, v253
v_cvt_pk_bf16_f32 v19, v254, v255
buffer_store_dwordx4 v[16:19], v2, s[4:7], s31 offen offset:1024 sc1
s_nop 2
s_add_u32 s31, s31, 14336
s_waitcnt lgkmcnt(0)
s_waitcnt vmcnt(28)
s_cmp_lg_u32 s67, 0
s_cbranch_scc1 Q20_sk6
s_add_u32 s30, s61, 262144
buffer_load_dwordx4 v[84:87], v3, s[12:15], s30 offen
s_add_u32 s30, s61, 278528
buffer_load_dwordx4 v[88:91], v3, s[12:15], s30 offen
s_add_u32 s30, s61, 294912
buffer_load_dwordx4 v[92:95], v3, s[12:15], s30 offen
s_add_u32 s30, s61, 311296
buffer_load_dwordx4 v[96:99], v3, s[12:15], s30 offen
s_add_u32 s30, s61, 327680
buffer_load_dwordx4 v[100:103], v3, s[12:15], s30 offen
s_add_u32 s30, s61, 344064
buffer_load_dwordx4 v[104:107], v3, s[12:15], s30 offen
s_add_u32 s30, s61, 360448
buffer_load_dwordx4 v[108:111], v3, s[12:15], s30 offen
s_add_u32 s30, s61, 376832
buffer_load_dwordx4 v[112:115], v3, s[12:15], s30 offen
Q20_sk6:
v_mfma_f32_16x16x32_bf16 v[240:243], a[0:3], a[128:131], 0
ds_write_b128 v8, v[116:119] offset:33792
v_mfma_f32_16x16x32_bf16 v[240:243], a[4:7], a[132:135], v[240:243]
v_mfma_f32_16x16x32_bf16 v[240:243], a[8:11], a[136:139], v[240:243]
ds_write_b128 v8, v[120:123] offset:34848
v_mfma_f32_16x16x32_bf16 v[240:243], a[12:15], a[140:143], v[240:243]
v_mfma_f32_16x16x32_bf16 v[240:243], a[16:19], a[144:147], v[240:243]
ds_write_b128 v8, v[124:127] offset:35904
v_mfma_f32_16x16x32_bf16 v[240:243], a[20:23], a[148:151], v[240:243]
v_mfma_f32_16x16x32_bf16 v[240:243], a[24:27], a[152:155], v[240:243]
ds_write_b128 v8, v[128:131] offset:36960
v_mfma_f32_16x16x32_bf16 v[240:243], a[28:31], a[156:159], v[240:243]
v_mfma_f32_16x16x32_bf16 v[244:247], a[32:35], a[128:131], 0
ds_write_b128 v8, v[132:135] offset:38016
v_mfma_f32_16x16x32_bf16 v[244:247], a[36:39], a[132:135], v[244:247]
v_mfma_f32_16x16x32_bf16 v[244:247], a[40:43], a[136:139], v[244:247]
ds_write_b128 v8, v[136:139] offset:39072
v_mfma_f32_16x16x32_bf16 v[244:247], a[44:47], a[140:143], v[244:247]
v_mfma_f32_16x16x32_bf16 v[244:247], a[48:51], a[144:147], v[244:247]
ds_write_b128 v8, v[140:143] offset:40128
v_mfma_f32_16x16x32_bf16 v[244:247], a[52:55], a[148:151], v[244:247]
v_mfma_f32_16x16x32_bf16 v[244:247], a[56:59], a[152:155], v[244:247]
ds_write_b128 v8, v[144:147] offset:41184
v_mfma_f32_16x16x32_bf16 v[244:247], a[60:63], a[156:159], v[244:247]
v_mfma_f32_16x16x32_bf16 v[248:251], a[64:67], a[128:131], 0
ds_read_b128 a[160:163], v9 offset:33792
v_mfma_f32_16x16x32_bf16 v[248:251], a[68:71], a[132:135], v[248:251]
v_mfma_f32_16x16x32_bf16 v[248:251], a[72:75], a[136:139], v[248:251]
ds_read_b128 a[164:167], v9 offset:33856
v_mfma_f32_16x16x32_bf16 v[248:251], a[76:79], a[140:143], v[248:251]
v_mfma_f32_16x16x32_bf16 v[248:251], a[80:83], a[144:147], v[248:251]
ds_read_b128 a[168:171], v9 offset:33920
v_mfma_f32_16x16x32_bf16 v[248:251], a[84:87], a[148:151], v[248:251]
v_mfma_f32_16x16x32_bf16 v[248:251], a[88:91], a[152:155], v[248:251]
ds_read_b128 a[172:175], v9 offset:33984
v_mfma_f32_16x16x32_bf16 v[248:251], a[92:95], a[156:159], v[248:251]
v_mfma_f32_16x16x32_bf16 v[252:255], a[96:99], a[128:131], 0
ds_read_b128 a[176:179], v9 offset:34048
v_mfma_f32_16x16x32_bf16 v[252:255], a[100:103], a[132:135], v[252:255]
v_mfma_f32_16x16x32_bf16 v[252:255], a[104:107], a[136:139], v[252:255]
ds_read_b128 a[180:183], v9 offset:34112
v_mfma_f32_16x16x32_bf16 v[252:255], a[108:111], a[140:143], v[252:255]
v_mfma_f32_16x16x32_bf16 v[252:255], a[112:115], a[144:147], v[252:255]
ds_read_b128 a[184:187], v9 offset:34176
v_mfma_f32_16x16x32_bf16 v[252:255], a[116:119], a[148:151], v[252:255]
v_mfma_f32_16x16x32_bf16 v[252:255], a[120:123], a[152:155], v[252:255]
ds_read_b128 a[188:191], v9 offset:34240
v_mfma_f32_16x16x32_bf16 v[252:255], a[124:127], a[156:159], v[252:255]
s_nop 7
v_mul_f32 v240, v240, v4
v_mul_f32 v241, v241, v4
v_mul_f32 v242, v242, v4
v_mul_f32 v243, v243, v4
v_mul_f32 v244, v244, v4
v_mul_f32 v245, v245, v4
v_mul_f32 v246, v246, v4
v_mul_f32 v247, v247, v4
v_mul_f32 v248, v248, v4
v_mul_f32 v249, v249, v4
v_mul_f32 v250, v250, v4
v_mul_f32 v251, v251, v4
v_mul_f32 v252, v252, v4
v_mul_f32 v253, v253, v4
v_mul_f32 v254, v254, v4
v_mul_f32 v255, v255, v4
v_cvt_pk_bf16_f32 v12, v240, v241
v_cvt_pk_bf16_f32 v13, v242, v243
v_cvt_pk_bf16_f32 v14, v244, v245
v_cvt_pk_bf16_f32 v15, v246, v247
buffer_store_dwordx4 v[12:15], v2, s[4:7], s31 offen offset:0 sc1
v_cvt_pk_bf16_f32 v16, v248, v249
v_cvt_pk_bf16_f32 v17, v250, v251
v_cvt_pk_bf16_f32 v18, v252, v253
v_cvt_pk_bf16_f32 v19, v254, v255
buffer_store_dwordx4 v[16:19], v2, s[4:7], s31 offen offset:1024 sc1
s_nop 2
s_add_u32 s31, s31, 14336
s_cmp_eq_u32 s37, 0
s_cbranch_scc1 Q20_exit
s_waitcnt lgkmcnt(0)
s_cmp_lg_u32 s67, 0
s_cbranch_scc1 Q20_sk7
s_add_u32 s30, s61, 393216
buffer_load_dwordx4 v[116:119], v3, s[12:15], s30 offen
s_add_u32 s30, s61, 409600
buffer_load_dwordx4 v[120:123], v3, s[12:15], s30 offen
s_add_u32 s30, s61, 425984
buffer_load_dwordx4 v[124:127], v3, s[12:15], s30 offen
s_add_u32 s30, s61, 442368
buffer_load_dwordx4 v[128:131], v3, s[12:15], s30 offen
s_add_u32 s30, s61, 458752
buffer_load_dwordx4 v[132:135], v3, s[12:15], s30 offen
s_add_u32 s30, s61, 475136
buffer_load_dwordx4 v[136:139], v3, s[12:15], s30 offen
s_add_u32 s30, s61, 491520
buffer_load_dwordx4 v[140:143], v3, s[12:15], s30 offen
s_add_u32 s30, s61, 507904
buffer_load_dwordx4 v[144:147], v3, s[12:15], s30 offen
Q20_sk7:
v_mfma_f32_16x16x32_bf16 v[240:243], a[0:3], a[160:163], 0
v_mfma_f32_16x16x32_bf16 v[240:243], a[4:7], a[164:167], v[240:243]
v_mfma_f32_16x16x32_bf16 v[240:243], a[8:11], a[168:171], v[240:243]
v_mfma_f32_16x16x32_bf16 v[240:243], a[12:15], a[172:175], v[240:243]
v_mfma_f32_16x16x32_bf16 v[240:243], a[16:19], a[176:179], v[240:243]
v_mfma_f32_16x16x32_bf16 v[240:243], a[20:23], a[180:183], v[240:243]
v_mfma_f32_16x16x32_bf16 v[240:243], a[24:27], a[184:187], v[240:243]
v_mfma_f32_16x16x32_bf16 v[240:243], a[28:31], a[188:191], v[240:243]
v_mfma_f32_16x16x32_bf16 v[244:247], a[32:35], a[160:163], 0
v_mfma_f32_16x16x32_bf16 v[244:247], a[36:39], a[164:167], v[244:247]
v_mfma_f32_16x16x32_bf16 v[244:247], a[40:43], a[168:171], v[244:247]
v_mfma_f32_16x16x32_bf16 v[244:247], a[44:47], a[172:175], v[244:247]
v_mfma_f32_16x16x32_bf16 v[244:247], a[48:51], a[176:179], v[244:247]
v_mfma_f32_16x16x32_bf16 v[244:247], a[52:55], a[180:183], v[244:247]
v_mfma_f32_16x16x32_bf16 v[244:247], a[56:59], a[184:187], v[244:247]
v_mfma_f32_16x16x32_bf16 v[244:247], a[60:63], a[188:191], v[244:247]
v_mfma_f32_16x16x32_bf16 v[248:251], a[64:67], a[160:163], 0
v_mfma_f32_16x16x32_bf16 v[248:251], a[68:71], a[164:167], v[248:251]
v_mfma_f32_16x16x32_bf16 v[248:251], a[72:75], a[168:171], v[248:251]
v_mfma_f32_16x16x32_bf16 v[248:251], a[76:79], a[172:175], v[248:251]
v_mfma_f32_16x16x32_bf16 v[248:251], a[80:83], a[176:179], v[248:251]
v_mfma_f32_16x16x32_bf16 v[248:251], a[84:87], a[180:183], v[248:251]
v_mfma_f32_16x16x32_bf16 v[248:251], a[88:91], a[184:187], v[248:251]
v_mfma_f32_16x16x32_bf16 v[248:251], a[92:95], a[188:191], v[248:251]
v_mfma_f32_16x16x32_bf16 v[252:255], a[96:99], a[160:163], 0
v_mfma_f32_16x16x32_bf16 v[252:255], a[100:103], a[164:167], v[252:255]
v_mfma_f32_16x16x32_bf16 v[252:255], a[104:107], a[168:171], v[252:255]
v_mfma_f32_16x16x32_bf16 v[252:255], a[108:111], a[172:175], v[252:255]
v_mfma_f32_16x16x32_bf16 v[252:255], a[112:115], a[176:179], v[252:255]
v_mfma_f32_16x16x32_bf16 v[252:255], a[116:119], a[180:183], v[252:255]
v_mfma_f32_16x16x32_bf16 v[252:255], a[120:123], a[184:187], v[252:255]
v_mfma_f32_16x16x32_bf16 v[252:255], a[124:127], a[188:191], v[252:255]
s_nop 7
v_mul_f32 v240, v240, v4
v_mul_f32 v241, v241, v4
v_mul_f32 v242, v242, v4
v_mul_f32 v243, v243, v4
v_mul_f32 v244, v244, v4
v_mul_f32 v245, v245, v4
v_mul_f32 v246, v246, v4
v_mul_f32 v247, v247, v4
v_mul_f32 v248, v248, v4
v_mul_f32 v249, v249, v4
v_mul_f32 v250, v250, v4
v_mul_f32 v251, v251, v4
v_mul_f32 v252, v252, v4
v_mul_f32 v253, v253, v4
v_mul_f32 v254, v254, v4
v_mul_f32 v255, v255, v4
v_cvt_pk_bf16_f32 v12, v240, v241
v_cvt_pk_bf16_f32 v13, v242, v243
v_cvt_pk_bf16_f32 v14, v244, v245
v_cvt_pk_bf16_f32 v15, v246, v247
buffer_store_dwordx4 v[12:15], v2, s[4:7], s31 offen offset:0 sc1
v_cvt_pk_bf16_f32 v16, v248, v249
v_cvt_pk_bf16_f32 v17, v250, v251
v_cvt_pk_bf16_f32 v18, v252, v253
v_cvt_pk_bf16_f32 v19, v254, v255
buffer_store_dwordx4 v[16:19], v2, s[4:7], s31 offen offset:1024 sc1
s_nop 2
s_add_u32 s31, s31, 14336
Q20_exit:
s_waitcnt lgkmcnt(0)
s_barrier
s_add_u32 s67, s67, 1
s_cmp_lt_u32 s67, 2
s_cbranch_scc1 L_p0r0
s_waitcnt vmcnt(0)
s_barrier
s_cmp_lg_u32 s24, 0
s_cbranch_scc1 Q2s0_s
v_mov_b32 v4, 16
s_mov_b32 s47, 0
Q2s0_r_p:
buffer_load_dword v5, v4, s[92:95], 0 offen sc1
s_waitcnt vmcnt(0)
v_readfirstlane_b32 s46, v5
s_add_u32 s47, s47, 1
s_nop 1
s_cmp_lg_u32 s46, 0
s_cbranch_scc1 Q2s0_r_o
s_cmp_lt_u32 s47, 20000
s_cbranch_scc1 Q2s0_r_p
Q2s0_r_o:
s_lshl_b32 s46, s26, 7
s_add_u32 s46, s46, 75019648
v_mov_b32 v4, s46
v_mov_b32 v5, 1
s_mov_b64 exec, 1
buffer_atomic_add v5, v4, s[4:7], 0 offen
s_mov_b64 exec, -1
Q2s0_s:
s_branch L_p0done
L_p0B:
L_p0r1:
s_mul_i32 s28, s67, 7
s_add_u32 s28, s28, s69
s_lshr_b32 s27, s28, 1
s_and_b32 s23, s28, 1
v_and_b32 v1, 63, v0
s_load_dwordx2 s[8:9], s[0:1], 32
s_load_dwordx2 s[12:13], s[0:1], 40
s_waitcnt lgkmcnt(0)
s_and_b32 s9, s9, 0xffff
s_mov_b32 s10, 3670016
s_mov_b32 s11, 0x20000
s_and_b32 s13, s13, 0xffff
s_mov_b32 s14, 3670016
s_mov_b32 s15, 0x20000
s_mul_i32 s36, s23, 14
s_cmp_lt_u32 s24, 2
s_cselect_b32 s37, 1, 0
s_lshl_b32 s28, s24, 2
s_cmp_eq_u32 s24, 3
s_cselect_b32 s29, 1, 0
s_sub_u32 s28, s28, s29
s_add_u32 s36, s36, s28
v_lshlrev_b32 v2, 4, v1
v_lshrrev_b32 v4, 5, v1
v_lshlrev_b32 v3, 13, v4
v_and_b32 v5, 31, v1
v_lshl_add_u32 v3, v5, 4, v3
v_mul_u32_u24 v6, 528, v4
v_lshl_add_u32 v6, v5, 4, v6
s_lshl_b32 s28, s27, 19
s_lshl_b32 s29, s26, 9
s_add_u32 s28, s28, s29
s_lshl_b32 s29, s24, 17
s_add_u32 s28, s28, s29
s_lshl_b32 s60, s65, 19
s_lshl_b32 s29, s26, 9
s_add_u32 s60, s60, s29
s_lshl_b32 s29, s24, 17
s_add_u32 s60, s60, s29
s_cmp_eq_u32 s67, 0
s_cbranch_scc1 Q21_r0
s_waitcnt vmcnt(0)
Q21_r0:
s_cmp_lg_u32 s67, 0
s_cbranch_scc1 Q21_sk1
s_add_u32 s30, s28, 0
buffer_load_dwordx4 v[148:151], v3, s[8:11], s30 offen
s_add_u32 s30, s28, 16384
buffer_load_dwordx4 v[152:155], v3, s[8:11], s30 offen
s_add_u32 s30, s28, 32768
buffer_load_dwordx4 v[156:159], v3, s[8:11], s30 offen
s_add_u32 s30, s28, 49152
buffer_load_dwordx4 v[160:163], v3, s[8:11], s30 offen
s_add_u32 s30, s28, 65536
buffer_load_dwordx4 v[164:167], v3, s[8:11], s30 offen
s_add_u32 s30, s28, 81920
buffer_load_dwordx4 v[168:171], v3, s[8:11], s30 offen
s_add_u32 s30, s28, 98304
buffer_load_dwordx4 v[172:175], v3, s[8:11], s30 offen
s_add_u32 s30, s28, 114688
buffer_load_dwordx4 v[176:179], v3, s[8:11], s30 offen
Q21_sk1:
s_mul_i32 s31, s26, 28
s_add_u32 s31, s31, s36
s_mul_i32 s31, s31, 7
s_add_u32 s31, s31, s27
s_lshl_b32 s31, s31, 11
s_mul_i32 s33, s25, 6422528
s_add_u32 s31, s31, s33
v_and_b32 v4, 15, v1
v_lshrrev_b32 v5, 3, v4
v_lshlrev_b32 v7, 4, v5
v_bfe_u32 v5, v4, 2, 1
v_lshl_add_u32 v7, v5, 2, v7
v_and_b32 v5, 1, v4
v_add_u32 v7, v7, v5
v_bfe_u32 v5, v4, 1, 1
v_lshl_add_u32 v7, v5, 3, v7
v_mul_u32_u24 v7, 528, v7
v_lshrrev_b32 v5, 4, v1
v_lshl_add_u32 v7, v5, 4, v7
v_mul_u32_u24 v4, 2341, v1
v_lshrrev_b32 v4, 16, v4
v_mul_u32_u24 v5, 28, v4
v_sub_u32 v5, v1, v5
v_mul_u32_u24 v10, 896, v4
v_lshl_add_u32 v10, v5, 4, v10
v_mul_u32_u24 v11, 448, v4
v_lshl_add_u32 v11, v5, 4, v11
v_cmp_le_u32 vcc, 56, v1
v_mov_b32 v4, 0x20000000
v_mov_b32 v5, 43008
v_cndmask_b32 v10, v10, v4, vcc
v_cndmask_b32 v11, v11, v5, vcc
s_mul_i32 s32, s26, 229376
s_mul_i32 s33, s23, 448
s_add_u32 s32, s32, s33
s_mul_i32 s33, s24, 7168
s_add_u32 s32, s32, s33
s_mul_i32 s61, s26, 229376
s_mul_i32 s33, s66, 448
s_add_u32 s61, s61, s33
s_mul_i32 s33, s24, 7168
s_add_u32 s61, s61, s33
s_cmp_lg_u32 s67, 0
s_cbranch_scc1 Q21_sk2
s_add_u32 s30, s32, 0
buffer_load_dwordx4 v[20:23], v10, s[12:15], s30 offen
s_add_u32 s30, s32, 1792
buffer_load_dwordx4 v[24:27], v10, s[12:15], s30 offen
s_add_u32 s30, s32, 3584
buffer_load_dwordx4 v[28:31], v10, s[12:15], s30 offen
s_add_u32 s30, s32, 5376
buffer_load_dwordx4 v[32:35], v10, s[12:15], s30 offen
s_add_u32 s30, s32, 28672
buffer_load_dwordx4 v[36:39], v10, s[12:15], s30 offen
s_add_u32 s30, s32, 30464
buffer_load_dwordx4 v[40:43], v10, s[12:15], s30 offen
s_add_u32 s30, s32, 32256
buffer_load_dwordx4 v[44:47], v10, s[12:15], s30 offen
s_add_u32 s30, s32, 34048
buffer_load_dwordx4 v[48:51], v10, s[12:15], s30 offen
s_add_u32 s30, s32, 57344
buffer_load_dwordx4 v[52:55], v10, s[12:15], s30 offen
s_add_u32 s30, s32, 59136
buffer_load_dwordx4 v[56:59], v10, s[12:15], s30 offen
s_add_u32 s30, s32, 60928
buffer_load_dwordx4 v[60:63], v10, s[12:15], s30 offen
s_add_u32 s30, s32, 62720
buffer_load_dwordx4 v[64:67], v10, s[12:15], s30 offen
s_add_u32 s30, s32, 86016
buffer_load_dwordx4 v[68:71], v10, s[12:15], s30 offen
s_add_u32 s30, s32, 87808
buffer_load_dwordx4 v[72:75], v10, s[12:15], s30 offen
s_add_u32 s30, s32, 89600
buffer_load_dwordx4 v[76:79], v10, s[12:15], s30 offen
s_add_u32 s30, s32, 91392
buffer_load_dwordx4 v[80:83], v10, s[12:15], s30 offen
s_add_u32 s30, s32, 114688
buffer_load_dwordx4 v[84:87], v10, s[12:15], s30 offen
s_add_u32 s30, s32, 116480
buffer_load_dwordx4 v[88:91], v10, s[12:15], s30 offen
s_add_u32 s30, s32, 118272
buffer_load_dwordx4 v[92:95], v10, s[12:15], s30 offen
s_add_u32 s30, s32, 120064
buffer_load_dwordx4 v[96:99], v10, s[12:15], s30 offen
s_add_u32 s30, s32, 143360
buffer_load_dwordx4 v[100:103], v10, s[12:15], s30 offen
s_add_u32 s30, s32, 145152
buffer_load_dwordx4 v[104:107], v10, s[12:15], s30 offen
s_add_u32 s30, s32, 146944
buffer_load_dwordx4 v[108:111], v10, s[12:15], s30 offen
s_add_u32 s30, s32, 148736
buffer_load_dwordx4 v[112:115], v10, s[12:15], s30 offen
s_add_u32 s30, s32, 172032
buffer_load_dwordx4 v[116:119], v10, s[12:15], s30 offen
s_add_u32 s30, s32, 173824
buffer_load_dwordx4 v[120:123], v10, s[12:15], s30 offen
s_add_u32 s30, s32, 175616
buffer_load_dwordx4 v[124:127], v10, s[12:15], s30 offen
s_add_u32 s30, s32, 177408
buffer_load_dwordx4 v[128:131], v10, s[12:15], s30 offen
s_add_u32 s30, s32, 200704
buffer_load_dwordx4 v[132:135], v10, s[12:15], s30 offen
s_add_u32 s30, s32, 202496
buffer_load_dwordx4 v[136:139], v10, s[12:15], s30 offen
s_add_u32 s30, s32, 204288
buffer_load_dwordx4 v[140:143], v10, s[12:15], s30 offen
s_add_u32 s30, s32, 206080
buffer_load_dwordx4 v[144:147], v10, s[12:15], s30 offen
Q21_sk2:
s_waitcnt vmcnt(32)
s_mul_i32 s34, s24, 8448
v_add_u32 v4, s34, v6
ds_write_b128 v4, v[148:151] offset:0
ds_write_b128 v4, v[152:155] offset:1056
ds_write_b128 v4, v[156:159] offset:2112
ds_write_b128 v4, v[160:163] offset:3168
ds_write_b128 v4, v[164:167] offset:4224
ds_write_b128 v4, v[168:171] offset:5280
ds_write_b128 v4, v[172:175] offset:6336
ds_write_b128 v4, v[176:179] offset:7392
s_waitcnt lgkmcnt(0)
s_barrier
s_cmp_eq_u32 s67, 0
s_cbranch_scc1 Q2h1_s
s_cmp_lg_u32 s24, 0
s_cbranch_scc1 Q2h1_s
v_mov_b32 v12, 16
s_mov_b32 s47, 0
Q2h1_r_p:
buffer_load_dword v13, v12, s[92:95], 0 offen sc1
s_waitcnt vmcnt(0)
v_readfirstlane_b32 s46, v13
s_add_u32 s47, s47, 1
s_nop 1
s_cmp_lg_u32 s46, 0
s_cbranch_scc1 Q2h1_r_o
s_cmp_lt_u32 s47, 20000
s_cbranch_scc1 Q2h1_r_p
Q2h1_r_o:
s_lshl_b32 s46, s26, 7
s_add_u32 s46, s46, 75017344
v_mov_b32 v12, s46
v_mov_b32 v13, 1
s_mov_b64 exec, 1
buffer_atomic_add v13, v12, s[4:7], 0 offen
v_mov_b32 v12, 75019392
v_mov_b32 v13, 1
buffer_atomic_add v13, v12, s[4:7], 0 offen
s_mov_b64 exec, -1
Q2h1_s:
ds_read_b128 a[0:3], v7 offset:0
ds_read_b128 a[4:7], v7 offset:64
ds_read_b128 a[8:11], v7 offset:128
ds_read_b128 a[12:15], v7 offset:192
ds_read_b128 a[16:19], v7 offset:256
ds_read_b128 a[20:23], v7 offset:320
ds_read_b128 a[24:27], v7 offset:384
ds_read_b128 a[28:31], v7 offset:448
s_waitcnt lgkmcnt(4)
ds_read_b128 a[32:35], v7 offset:1056
ds_read_b128 a[36:39], v7 offset:1120
ds_read_b128 a[40:43], v7 offset:1184
ds_read_b128 a[44:47], v7 offset:1248
ds_read_b128 a[48:51], v7 offset:1312
ds_read_b128 a[52:55], v7 offset:1376
ds_read_b128 a[56:59], v7 offset:1440
ds_read_b128 a[60:63], v7 offset:1504
s_waitcnt lgkmcnt(4)
ds_read_b128 a[64:67], v7 offset:16896
ds_read_b128 a[68:71], v7 offset:16960
ds_read_b128 a[72:75], v7 offset:17024
ds_read_b128 a[76:79], v7 offset:17088
ds_read_b128 a[80:83], v7 offset:17152
ds_read_b128 a[84:87], v7 offset:17216
ds_read_b128 a[88:91], v7 offset:17280
ds_read_b128 a[92:95], v7 offset:17344
s_waitcnt lgkmcnt(4)
ds_read_b128 a[96:99], v7 offset:17952
ds_read_b128 a[100:103], v7 offset:18016
ds_read_b128 a[104:107], v7 offset:18080
ds_read_b128 a[108:111], v7 offset:18144
ds_read_b128 a[112:115], v7 offset:18208
ds_read_b128 a[116:119], v7 offset:18272
ds_read_b128 a[120:123], v7 offset:18336
ds_read_b128 a[124:127], v7 offset:18400
s_waitcnt lgkmcnt(4)
s_waitcnt lgkmcnt(0)
s_cmp_lg_u32 s67, 0
s_cbranch_scc1 Q21_sk3
s_add_u32 s30, s60, 0
buffer_load_dwordx4 v[148:151], v3, s[8:11], s30 offen
s_add_u32 s30, s60, 16384
buffer_load_dwordx4 v[152:155], v3, s[8:11], s30 offen
s_add_u32 s30, s60, 32768
buffer_load_dwordx4 v[156:159], v3, s[8:11], s30 offen
s_add_u32 s30, s60, 49152
buffer_load_dwordx4 v[160:163], v3, s[8:11], s30 offen
s_add_u32 s30, s60, 65536
buffer_load_dwordx4 v[164:167], v3, s[8:11], s30 offen
s_add_u32 s30, s60, 81920
buffer_load_dwordx4 v[168:171], v3, s[8:11], s30 offen
s_add_u32 s30, s60, 98304
buffer_load_dwordx4 v[172:175], v3, s[8:11], s30 offen
s_add_u32 s30, s60, 114688
buffer_load_dwordx4 v[176:179], v3, s[8:11], s30 offen
Q21_sk3:
s_mul_i32 s34, s24, 3584
s_add_u32 s34, s34, 33792
v_add_u32 v8, s34, v11
v_lshrrev_b32 v4, 4, v1
v_lshlrev_b32 v4, 3, v4
v_bfe_u32 v5, v1, 2, 2
v_add_u32 v4, v4, v5
v_mul_u32_u24 v4, 448, v4
v_and_b32 v5, 3, v1
v_lshl_add_u32 v4, v5, 3, v4
s_mul_i32 s34, s23, 14
s_sub_u32 s34, s36, s34
s_lshl_b32 s34, s34, 5
s_add_u32 s34, s34, 33792
v_add_u32 v9, s34, v4
s_waitcnt vmcnt(36)
ds_write_b128 v8, v[20:23] offset:0
ds_write_b128 v8, v[24:27] offset:896
ds_write_b128 v8, v[28:31] offset:1792
ds_write_b128 v8, v[32:35] offset:2688
s_waitcnt vmcnt(32)
ds_write_b128 v8, v[36:39] offset:14336
ds_write_b128 v8, v[40:43] offset:15232
ds_write_b128 v8, v[44:47] offset:16128
ds_write_b128 v8, v[48:51] offset:17024
s_waitcnt lgkmcnt(0)
s_cmp_lg_u32 s67, 0
s_cbranch_scc1 Q21_sk4
s_add_u32 s30, s61, 0
buffer_load_dwordx4 v[20:23], v10, s[12:15], s30 offen
s_add_u32 s30, s61, 1792
buffer_load_dwordx4 v[24:27], v10, s[12:15], s30 offen
s_add_u32 s30, s61, 3584
buffer_load_dwordx4 v[28:31], v10, s[12:15], s30 offen
s_add_u32 s30, s61, 5376
buffer_load_dwordx4 v[32:35], v10, s[12:15], s30 offen
s_add_u32 s30, s61, 28672
buffer_load_dwordx4 v[36:39], v10, s[12:15], s30 offen
s_add_u32 s30, s61, 30464
buffer_load_dwordx4 v[40:43], v10, s[12:15], s30 offen
s_add_u32 s30, s61, 32256
buffer_load_dwordx4 v[44:47], v10, s[12:15], s30 offen
s_add_u32 s30, s61, 34048
buffer_load_dwordx4 v[48:51], v10, s[12:15], s30 offen
Q21_sk4:
s_barrier
ds_read_b64_tr_b16 v[208:209], v9 offset:0
ds_read_b64_tr_b16 v[210:211], v9 offset:1792
ds_read_b64_tr_b16 v[212:213], v9 offset:32
ds_read_b64_tr_b16 v[214:215], v9 offset:1824
ds_read_b64_tr_b16 v[216:217], v9 offset:64
ds_read_b64_tr_b16 v[218:219], v9 offset:1856
ds_read_b64_tr_b16 v[220:221], v9 offset:96
ds_read_b64_tr_b16 v[222:223], v9 offset:1888
s_waitcnt lgkmcnt(0)
v_mfma_f32_16x16x32_bf16 a[128:131], a[0:3], v[208:211], 0
ds_read_b64_tr_b16 v[224:225], v9 offset:14336
v_mfma_f32_16x16x32_bf16 a[132:135], a[32:35], v[208:211], 0
ds_read_b64_tr_b16 v[226:227], v9 offset:16128
v_mfma_f32_16x16x32_bf16 a[136:139], a[64:67], v[208:211], 0
ds_read_b64_tr_b16 v[228:229], v9 offset:14368
v_mfma_f32_16x16x32_bf16 a[140:143], a[96:99], v[208:211], 0
ds_read_b64_tr_b16 v[230:231], v9 offset:16160
v_mfma_f32_16x16x32_bf16 a[144:147], a[0:3], v[212:215], 0
ds_read_b64_tr_b16 v[232:233], v9 offset:14400
v_mfma_f32_16x16x32_bf16 a[148:151], a[32:35], v[212:215], 0
ds_read_b64_tr_b16 v[234:235], v9 offset:16192
v_mfma_f32_16x16x32_bf16 a[152:155], a[64:67], v[212:215], 0
ds_read_b64_tr_b16 v[236:237], v9 offset:14432
v_mfma_f32_16x16x32_bf16 a[156:159], a[96:99], v[212:215], 0
ds_read_b64_tr_b16 v[238:239], v9 offset:16224
v_mfma_f32_16x16x32_bf16 a[160:163], a[0:3], v[216:219], 0
v_mfma_f32_16x16x32_bf16 a[164:167], a[32:35], v[216:219], 0
v_mfma_f32_16x16x32_bf16 a[168:171], a[64:67], v[216:219], 0
v_mfma_f32_16x16x32_bf16 a[172:175], a[96:99], v[216:219], 0
v_mfma_f32_16x16x32_bf16 a[176:179], a[0:3], v[220:223], 0
v_mfma_f32_16x16x32_bf16 a[180:183], a[32:35], v[220:223], 0
v_mfma_f32_16x16x32_bf16 a[184:187], a[64:67], v[220:223], 0
v_mfma_f32_16x16x32_bf16 a[188:191], a[96:99], v[220:223], 0
s_waitcnt vmcnt(36)
ds_write_b128 v8, v[52:55] offset:28672
ds_write_b128 v8, v[56:59] offset:29568
ds_write_b128 v8, v[60:63] offset:30464
ds_write_b128 v8, v[64:67] offset:31360
s_waitcnt lgkmcnt(0)
s_cmp_lg_u32 s67, 0
s_cbranch_scc1 Q21_sk5
s_add_u32 s30, s61, 57344
buffer_load_dwordx4 v[52:55], v10, s[12:15], s30 offen
s_add_u32 s30, s61, 59136
buffer_load_dwordx4 v[56:59], v10, s[12:15], s30 offen
s_add_u32 s30, s61, 60928
buffer_load_dwordx4 v[60:63], v10, s[12:15], s30 offen
s_add_u32 s30, s61, 62720
buffer_load_dwordx4 v[64:67], v10, s[12:15], s30 offen
Q21_sk5:
s_barrier
s_waitcnt lgkmcnt(0)
v_mfma_f32_16x16x32_bf16 a[128:131], a[4:7], v[224:227], a[128:131]
ds_read_b64_tr_b16 v[208:209], v9 offset:28672
v_mfma_f32_16x16x32_bf16 a[132:135], a[36:39], v[224:227], a[132:135]
ds_read_b64_tr_b16 v[210:211], v9 offset:30464
v_mfma_f32_16x16x32_bf16 a[136:139], a[68:71], v[224:227], a[136:139]
ds_read_b64_tr_b16 v[212:213], v9 offset:28704
v_mfma_f32_16x16x32_bf16 a[140:143], a[100:103], v[224:227], a[140:143]
ds_read_b64_tr_b16 v[214:215], v9 offset:30496
v_mfma_f32_16x16x32_bf16 a[144:147], a[4:7], v[228:231], a[144:147]
ds_read_b64_tr_b16 v[216:217], v9 offset:28736
v_mfma_f32_16x16x32_bf16 a[148:151], a[36:39], v[228:231], a[148:151]
ds_read_b64_tr_b16 v[218:219], v9 offset:30528
v_mfma_f32_16x16x32_bf16 a[152:155], a[68:71], v[228:231], a[152:155]
ds_read_b64_tr_b16 v[220:221], v9 offset:28768
v_mfma_f32_16x16x32_bf16 a[156:159], a[100:103], v[228:231], a[156:159]
ds_read_b64_tr_b16 v[222:223], v9 offset:30560
v_mfma_f32_16x16x32_bf16 a[160:163], a[4:7], v[232:235], a[160:163]
v_mfma_f32_16x16x32_bf16 a[164:167], a[36:39], v[232:235], a[164:167]
v_mfma_f32_16x16x32_bf16 a[168:171], a[68:71], v[232:235], a[168:171]
v_mfma_f32_16x16x32_bf16 a[172:175], a[100:103], v[232:235], a[172:175]
v_mfma_f32_16x16x32_bf16 a[176:179], a[4:7], v[236:239], a[176:179]
v_mfma_f32_16x16x32_bf16 a[180:183], a[36:39], v[236:239], a[180:183]
v_mfma_f32_16x16x32_bf16 a[184:187], a[68:71], v[236:239], a[184:187]
v_mfma_f32_16x16x32_bf16 a[188:191], a[100:103], v[236:239], a[188:191]
s_waitcnt vmcnt(36)
ds_write_b128 v8, v[68:71] offset:0
ds_write_b128 v8, v[72:75] offset:896
ds_write_b128 v8, v[76:79] offset:1792
ds_write_b128 v8, v[80:83] offset:2688
s_waitcnt lgkmcnt(0)
s_cmp_lg_u32 s67, 0
s_cbranch_scc1 Q21_sk6
s_add_u32 s30, s61, 86016
buffer_load_dwordx4 v[68:71], v10, s[12:15], s30 offen
s_add_u32 s30, s61, 87808
buffer_load_dwordx4 v[72:75], v10, s[12:15], s30 offen
s_add_u32 s30, s61, 89600
buffer_load_dwordx4 v[76:79], v10, s[12:15], s30 offen
s_add_u32 s30, s61, 91392
buffer_load_dwordx4 v[80:83], v10, s[12:15], s30 offen
Q21_sk6:
s_barrier
s_waitcnt lgkmcnt(0)
v_mfma_f32_16x16x32_bf16 a[128:131], a[8:11], v[208:211], a[128:131]
ds_read_b64_tr_b16 v[224:225], v9 offset:0
v_mfma_f32_16x16x32_bf16 a[132:135], a[40:43], v[208:211], a[132:135]
ds_read_b64_tr_b16 v[226:227], v9 offset:1792
v_mfma_f32_16x16x32_bf16 a[136:139], a[72:75], v[208:211], a[136:139]
ds_read_b64_tr_b16 v[228:229], v9 offset:32
v_mfma_f32_16x16x32_bf16 a[140:143], a[104:107], v[208:211], a[140:143]
ds_read_b64_tr_b16 v[230:231], v9 offset:1824
v_mfma_f32_16x16x32_bf16 a[144:147], a[8:11], v[212:215], a[144:147]
ds_read_b64_tr_b16 v[232:233], v9 offset:64
v_mfma_f32_16x16x32_bf16 a[148:151], a[40:43], v[212:215], a[148:151]
ds_read_b64_tr_b16 v[234:235], v9 offset:1856
v_mfma_f32_16x16x32_bf16 a[152:155], a[72:75], v[212:215], a[152:155]
ds_read_b64_tr_b16 v[236:237], v9 offset:96
v_mfma_f32_16x16x32_bf16 a[156:159], a[104:107], v[212:215], a[156:159]
ds_read_b64_tr_b16 v[238:239], v9 offset:1888
v_mfma_f32_16x16x32_bf16 a[160:163], a[8:11], v[216:219], a[160:163]
v_mfma_f32_16x16x32_bf16 a[164:167], a[40:43], v[216:219], a[164:167]
v_mfma_f32_16x16x32_bf16 a[168:171], a[72:75], v[216:219], a[168:171]
v_mfma_f32_16x16x32_bf16 a[172:175], a[104:107], v[216:219], a[172:175]
v_mfma_f32_16x16x32_bf16 a[176:179], a[8:11], v[220:223], a[176:179]
v_mfma_f32_16x16x32_bf16 a[180:183], a[40:43], v[220:223], a[180:183]
v_mfma_f32_16x16x32_bf16 a[184:187], a[72:75], v[220:223], a[184:187]
v_mfma_f32_16x16x32_bf16 a[188:191], a[104:107], v[220:223], a[188:191]
s_waitcnt vmcnt(36)
ds_write_b128 v8, v[84:87] offset:14336
ds_write_b128 v8, v[88:91] offset:15232
ds_write_b128 v8, v[92:95] offset:16128
ds_write_b128 v8, v[96:99] offset:17024
s_waitcnt lgkmcnt(0)
s_cmp_lg_u32 s67, 0
s_cbranch_scc1 Q21_sk7
s_add_u32 s30, s61, 114688
buffer_load_dwordx4 v[84:87], v10, s[12:15], s30 offen
s_add_u32 s30, s61, 116480
buffer_load_dwordx4 v[88:91], v10, s[12:15], s30 offen
s_add_u32 s30, s61, 118272
buffer_load_dwordx4 v[92:95], v10, s[12:15], s30 offen
s_add_u32 s30, s61, 120064
buffer_load_dwordx4 v[96:99], v10, s[12:15], s30 offen
Q21_sk7:
s_barrier
s_waitcnt lgkmcnt(0)
v_mfma_f32_16x16x32_bf16 a[128:131], a[12:15], v[224:227], a[128:131]
ds_read_b64_tr_b16 v[208:209], v9 offset:14336
v_mfma_f32_16x16x32_bf16 a[132:135], a[44:47], v[224:227], a[132:135]
ds_read_b64_tr_b16 v[210:211], v9 offset:16128
v_mfma_f32_16x16x32_bf16 a[136:139], a[76:79], v[224:227], a[136:139]
ds_read_b64_tr_b16 v[212:213], v9 offset:14368
v_mfma_f32_16x16x32_bf16 a[140:143], a[108:111], v[224:227], a[140:143]
ds_read_b64_tr_b16 v[214:215], v9 offset:16160
v_mfma_f32_16x16x32_bf16 a[144:147], a[12:15], v[228:231], a[144:147]
ds_read_b64_tr_b16 v[216:217], v9 offset:14400
v_mfma_f32_16x16x32_bf16 a[148:151], a[44:47], v[228:231], a[148:151]
ds_read_b64_tr_b16 v[218:219], v9 offset:16192
v_mfma_f32_16x16x32_bf16 a[152:155], a[76:79], v[228:231], a[152:155]
ds_read_b64_tr_b16 v[220:221], v9 offset:14432
v_mfma_f32_16x16x32_bf16 a[156:159], a[108:111], v[228:231], a[156:159]
ds_read_b64_tr_b16 v[222:223], v9 offset:16224
v_mfma_f32_16x16x32_bf16 a[160:163], a[12:15], v[232:235], a[160:163]
v_mfma_f32_16x16x32_bf16 a[164:167], a[44:47], v[232:235], a[164:167]
v_mfma_f32_16x16x32_bf16 a[168:171], a[76:79], v[232:235], a[168:171]
v_mfma_f32_16x16x32_bf16 a[172:175], a[108:111], v[232:235], a[172:175]
v_mfma_f32_16x16x32_bf16 a[176:179], a[12:15], v[236:239], a[176:179]
v_mfma_f32_16x16x32_bf16 a[180:183], a[44:47], v[236:239], a[180:183]
v_mfma_f32_16x16x32_bf16 a[184:187], a[76:79], v[236:239], a[184:187]
v_mfma_f32_16x16x32_bf16 a[188:191], a[108:111], v[236:239], a[188:191]
s_waitcnt vmcnt(36)
ds_write_b128 v8, v[100:103] offset:28672
ds_write_b128 v8, v[104:107] offset:29568
ds_write_b128 v8, v[108:111] offset:30464
ds_write_b128 v8, v[112:115] offset:31360
s_waitcnt lgkmcnt(0)
s_cmp_lg_u32 s67, 0
s_cbranch_scc1 Q21_sk8
s_add_u32 s30, s61, 143360
buffer_load_dwordx4 v[100:103], v10, s[12:15], s30 offen
s_add_u32 s30, s61, 145152
buffer_load_dwordx4 v[104:107], v10, s[12:15], s30 offen
s_add_u32 s30, s61, 146944
buffer_load_dwordx4 v[108:111], v10, s[12:15], s30 offen
s_add_u32 s30, s61, 148736
buffer_load_dwordx4 v[112:115], v10, s[12:15], s30 offen
Q21_sk8:
s_barrier
s_waitcnt lgkmcnt(0)
v_mfma_f32_16x16x32_bf16 a[128:131], a[16:19], v[208:211], a[128:131]
ds_read_b64_tr_b16 v[224:225], v9 offset:28672
v_mfma_f32_16x16x32_bf16 a[132:135], a[48:51], v[208:211], a[132:135]
ds_read_b64_tr_b16 v[226:227], v9 offset:30464
v_mfma_f32_16x16x32_bf16 a[136:139], a[80:83], v[208:211], a[136:139]
ds_read_b64_tr_b16 v[228:229], v9 offset:28704
v_mfma_f32_16x16x32_bf16 a[140:143], a[112:115], v[208:211], a[140:143]
ds_read_b64_tr_b16 v[230:231], v9 offset:30496
v_mfma_f32_16x16x32_bf16 a[144:147], a[16:19], v[212:215], a[144:147]
ds_read_b64_tr_b16 v[232:233], v9 offset:28736
v_mfma_f32_16x16x32_bf16 a[148:151], a[48:51], v[212:215], a[148:151]
ds_read_b64_tr_b16 v[234:235], v9 offset:30528
v_mfma_f32_16x16x32_bf16 a[152:155], a[80:83], v[212:215], a[152:155]
ds_read_b64_tr_b16 v[236:237], v9 offset:28768
v_mfma_f32_16x16x32_bf16 a[156:159], a[112:115], v[212:215], a[156:159]
ds_read_b64_tr_b16 v[238:239], v9 offset:30560
v_mfma_f32_16x16x32_bf16 a[160:163], a[16:19], v[216:219], a[160:163]
v_mfma_f32_16x16x32_bf16 a[164:167], a[48:51], v[216:219], a[164:167]
v_mfma_f32_16x16x32_bf16 a[168:171], a[80:83], v[216:219], a[168:171]
v_mfma_f32_16x16x32_bf16 a[172:175], a[112:115], v[216:219], a[172:175]
v_mfma_f32_16x16x32_bf16 a[176:179], a[16:19], v[220:223], a[176:179]
v_mfma_f32_16x16x32_bf16 a[180:183], a[48:51], v[220:223], a[180:183]
v_mfma_f32_16x16x32_bf16 a[184:187], a[80:83], v[220:223], a[184:187]
v_mfma_f32_16x16x32_bf16 a[188:191], a[112:115], v[220:223], a[188:191]
s_waitcnt vmcnt(36)
ds_write_b128 v8, v[116:119] offset:0
ds_write_b128 v8, v[120:123] offset:896
ds_write_b128 v8, v[124:127] offset:1792
ds_write_b128 v8, v[128:131] offset:2688
s_waitcnt lgkmcnt(0)
s_cmp_lg_u32 s67, 0
s_cbranch_scc1 Q21_sk9
s_add_u32 s30, s61, 172032
buffer_load_dwordx4 v[116:119], v10, s[12:15], s30 offen
s_add_u32 s30, s61, 173824
buffer_load_dwordx4 v[120:123], v10, s[12:15], s30 offen
s_add_u32 s30, s61, 175616
buffer_load_dwordx4 v[124:127], v10, s[12:15], s30 offen
s_add_u32 s30, s61, 177408
buffer_load_dwordx4 v[128:131], v10, s[12:15], s30 offen
Q21_sk9:
s_barrier
s_waitcnt lgkmcnt(0)
v_mfma_f32_16x16x32_bf16 a[128:131], a[20:23], v[224:227], a[128:131]
ds_read_b64_tr_b16 v[208:209], v9 offset:0
v_mfma_f32_16x16x32_bf16 a[132:135], a[52:55], v[224:227], a[132:135]
ds_read_b64_tr_b16 v[210:211], v9 offset:1792
v_mfma_f32_16x16x32_bf16 a[136:139], a[84:87], v[224:227], a[136:139]
ds_read_b64_tr_b16 v[212:213], v9 offset:32
v_mfma_f32_16x16x32_bf16 a[140:143], a[116:119], v[224:227], a[140:143]
ds_read_b64_tr_b16 v[214:215], v9 offset:1824
v_mfma_f32_16x16x32_bf16 a[144:147], a[20:23], v[228:231], a[144:147]
ds_read_b64_tr_b16 v[216:217], v9 offset:64
v_mfma_f32_16x16x32_bf16 a[148:151], a[52:55], v[228:231], a[148:151]
ds_read_b64_tr_b16 v[218:219], v9 offset:1856
v_mfma_f32_16x16x32_bf16 a[152:155], a[84:87], v[228:231], a[152:155]
ds_read_b64_tr_b16 v[220:221], v9 offset:96
v_mfma_f32_16x16x32_bf16 a[156:159], a[116:119], v[228:231], a[156:159]
ds_read_b64_tr_b16 v[222:223], v9 offset:1888
v_mfma_f32_16x16x32_bf16 a[160:163], a[20:23], v[232:235], a[160:163]
v_mfma_f32_16x16x32_bf16 a[164:167], a[52:55], v[232:235], a[164:167]
v_mfma_f32_16x16x32_bf16 a[168:171], a[84:87], v[232:235], a[168:171]
v_mfma_f32_16x16x32_bf16 a[172:175], a[116:119], v[232:235], a[172:175]
v_mfma_f32_16x16x32_bf16 a[176:179], a[20:23], v[236:239], a[176:179]
v_mfma_f32_16x16x32_bf16 a[180:183], a[52:55], v[236:239], a[180:183]
v_mfma_f32_16x16x32_bf16 a[184:187], a[84:87], v[236:239], a[184:187]
v_mfma_f32_16x16x32_bf16 a[188:191], a[116:119], v[236:239], a[188:191]
s_waitcnt vmcnt(36)
ds_write_b128 v8, v[132:135] offset:14336
ds_write_b128 v8, v[136:139] offset:15232
ds_write_b128 v8, v[140:143] offset:16128
ds_write_b128 v8, v[144:147] offset:17024
s_waitcnt lgkmcnt(0)
s_cmp_lg_u32 s67, 0
s_cbranch_scc1 Q21_sk10
s_add_u32 s30, s61, 200704
buffer_load_dwordx4 v[132:135], v10, s[12:15], s30 offen
s_add_u32 s30, s61, 202496
buffer_load_dwordx4 v[136:139], v10, s[12:15], s30 offen
s_add_u32 s30, s61, 204288
buffer_load_dwordx4 v[140:143], v10, s[12:15], s30 offen
s_add_u32 s30, s61, 206080
buffer_load_dwordx4 v[144:147], v10, s[12:15], s30 offen
Q21_sk10:
s_barrier
s_waitcnt lgkmcnt(0)
v_mfma_f32_16x16x32_bf16 a[128:131], a[24:27], v[208:211], a[128:131]
ds_read_b64_tr_b16 v[224:225], v9 offset:14336
v_mfma_f32_16x16x32_bf16 a[132:135], a[56:59], v[208:211], a[132:135]
ds_read_b64_tr_b16 v[226:227], v9 offset:16128
v_mfma_f32_16x16x32_bf16 a[136:139], a[88:91], v[208:211], a[136:139]
ds_read_b64_tr_b16 v[228:229], v9 offset:14368
v_mfma_f32_16x16x32_bf16 a[140:143], a[120:123], v[208:211], a[140:143]
ds_read_b64_tr_b16 v[230:231], v9 offset:16160
v_mfma_f32_16x16x32_bf16 a[144:147], a[24:27], v[212:215], a[144:147]
ds_read_b64_tr_b16 v[232:233], v9 offset:14400
v_mfma_f32_16x16x32_bf16 a[148:151], a[56:59], v[212:215], a[148:151]
ds_read_b64_tr_b16 v[234:235], v9 offset:16192
v_mfma_f32_16x16x32_bf16 a[152:155], a[88:91], v[212:215], a[152:155]
ds_read_b64_tr_b16 v[236:237], v9 offset:14432
v_mfma_f32_16x16x32_bf16 a[156:159], a[120:123], v[212:215], a[156:159]
ds_read_b64_tr_b16 v[238:239], v9 offset:16224
v_mfma_f32_16x16x32_bf16 a[160:163], a[24:27], v[216:219], a[160:163]
v_mfma_f32_16x16x32_bf16 a[164:167], a[56:59], v[216:219], a[164:167]
v_mfma_f32_16x16x32_bf16 a[168:171], a[88:91], v[216:219], a[168:171]
v_mfma_f32_16x16x32_bf16 a[172:175], a[120:123], v[216:219], a[172:175]
v_mfma_f32_16x16x32_bf16 a[176:179], a[24:27], v[220:223], a[176:179]
v_mfma_f32_16x16x32_bf16 a[180:183], a[56:59], v[220:223], a[180:183]
v_mfma_f32_16x16x32_bf16 a[184:187], a[88:91], v[220:223], a[184:187]
v_mfma_f32_16x16x32_bf16 a[188:191], a[120:123], v[220:223], a[188:191]
s_waitcnt lgkmcnt(0)
v_mfma_f32_16x16x32_bf16 a[128:131], a[28:31], v[224:227], a[128:131]
v_mfma_f32_16x16x32_bf16 a[132:135], a[60:63], v[224:227], a[132:135]
v_mfma_f32_16x16x32_bf16 a[136:139], a[92:95], v[224:227], a[136:139]
v_mfma_f32_16x16x32_bf16 a[140:143], a[124:127], v[224:227], a[140:143]
v_mfma_f32_16x16x32_bf16 a[144:147], a[28:31], v[228:231], a[144:147]
v_mfma_f32_16x16x32_bf16 a[148:151], a[60:63], v[228:231], a[148:151]
v_mfma_f32_16x16x32_bf16 a[152:155], a[92:95], v[228:231], a[152:155]
v_mfma_f32_16x16x32_bf16 a[156:159], a[124:127], v[228:231], a[156:159]
v_mfma_f32_16x16x32_bf16 a[160:163], a[28:31], v[232:235], a[160:163]
v_mfma_f32_16x16x32_bf16 a[164:167], a[60:63], v[232:235], a[164:167]
v_mfma_f32_16x16x32_bf16 a[168:171], a[92:95], v[232:235], a[168:171]
v_mfma_f32_16x16x32_bf16 a[172:175], a[124:127], v[232:235], a[172:175]
v_mfma_f32_16x16x32_bf16 a[176:179], a[28:31], v[236:239], a[176:179]
v_mfma_f32_16x16x32_bf16 a[180:183], a[60:63], v[236:239], a[180:183]
v_mfma_f32_16x16x32_bf16 a[184:187], a[92:95], v[236:239], a[184:187]
v_mfma_f32_16x16x32_bf16 a[188:191], a[124:127], v[236:239], a[188:191]
s_nop 7
v_accvgpr_read_b32 v240, a128
v_accvgpr_read_b32 v241, a129
v_accvgpr_read_b32 v242, a130
v_accvgpr_read_b32 v243, a131
v_accvgpr_read_b32 v244, a132
v_accvgpr_read_b32 v245, a133
v_accvgpr_read_b32 v246, a134
v_accvgpr_read_b32 v247, a135
v_accvgpr_read_b32 v248, a136
v_accvgpr_read_b32 v249, a137
v_accvgpr_read_b32 v250, a138
v_accvgpr_read_b32 v251, a139
v_accvgpr_read_b32 v252, a140
v_accvgpr_read_b32 v253, a141
v_accvgpr_read_b32 v254, a142
v_accvgpr_read_b32 v255, a143
v_cvt_pk_bf16_f32 v12, v240, v241
v_cvt_pk_bf16_f32 v13, v242, v243
v_cvt_pk_bf16_f32 v14, v244, v245
v_cvt_pk_bf16_f32 v15, v246, v247
buffer_store_dwordx4 v[12:15], v2, s[4:7], s31 offen offset:0 sc1
v_cvt_pk_bf16_f32 v16, v248, v249
v_cvt_pk_bf16_f32 v17, v250, v251
v_cvt_pk_bf16_f32 v18, v252, v253
v_cvt_pk_bf16_f32 v19, v254, v255
buffer_store_dwordx4 v[16:19], v2, s[4:7], s31 offen offset:1024 sc1
s_nop 2
s_add_u32 s31, s31, 14336
v_accvgpr_read_b32 v240, a144
v_accvgpr_read_b32 v241, a145
v_accvgpr_read_b32 v242, a146
v_accvgpr_read_b32 v243, a147
v_accvgpr_read_b32 v244, a148
v_accvgpr_read_b32 v245, a149
v_accvgpr_read_b32 v246, a150
v_accvgpr_read_b32 v247, a151
v_accvgpr_read_b32 v248, a152
v_accvgpr_read_b32 v249, a153
v_accvgpr_read_b32 v250, a154
v_accvgpr_read_b32 v251, a155
v_accvgpr_read_b32 v252, a156
v_accvgpr_read_b32 v253, a157
v_accvgpr_read_b32 v254, a158
v_accvgpr_read_b32 v255, a159
v_cvt_pk_bf16_f32 v12, v240, v241
v_cvt_pk_bf16_f32 v13, v242, v243
v_cvt_pk_bf16_f32 v14, v244, v245
v_cvt_pk_bf16_f32 v15, v246, v247
buffer_store_dwordx4 v[12:15], v2, s[4:7], s31 offen offset:0 sc1
v_cvt_pk_bf16_f32 v16, v248, v249
v_cvt_pk_bf16_f32 v17, v250, v251
v_cvt_pk_bf16_f32 v18, v252, v253
v_cvt_pk_bf16_f32 v19, v254, v255
buffer_store_dwordx4 v[16:19], v2, s[4:7], s31 offen offset:1024 sc1
s_nop 2
s_add_u32 s31, s31, 14336
v_accvgpr_read_b32 v240, a160
v_accvgpr_read_b32 v241, a161
v_accvgpr_read_b32 v242, a162
v_accvgpr_read_b32 v243, a163
v_accvgpr_read_b32 v244, a164
v_accvgpr_read_b32 v245, a165
v_accvgpr_read_b32 v246, a166
v_accvgpr_read_b32 v247, a167
v_accvgpr_read_b32 v248, a168
v_accvgpr_read_b32 v249, a169
v_accvgpr_read_b32 v250, a170
v_accvgpr_read_b32 v251, a171
v_accvgpr_read_b32 v252, a172
v_accvgpr_read_b32 v253, a173
v_accvgpr_read_b32 v254, a174
v_accvgpr_read_b32 v255, a175
v_cvt_pk_bf16_f32 v12, v240, v241
v_cvt_pk_bf16_f32 v13, v242, v243
v_cvt_pk_bf16_f32 v14, v244, v245
v_cvt_pk_bf16_f32 v15, v246, v247
buffer_store_dwordx4 v[12:15], v2, s[4:7], s31 offen offset:0 sc1
v_cvt_pk_bf16_f32 v16, v248, v249
v_cvt_pk_bf16_f32 v17, v250, v251
v_cvt_pk_bf16_f32 v18, v252, v253
v_cvt_pk_bf16_f32 v19, v254, v255
buffer_store_dwordx4 v[16:19], v2, s[4:7], s31 offen offset:1024 sc1
s_nop 2
s_add_u32 s31, s31, 14336
s_cmp_eq_u32 s37, 0
s_cbranch_scc1 Q21_exit
v_accvgpr_read_b32 v240, a176
v_accvgpr_read_b32 v241, a177
v_accvgpr_read_b32 v242, a178
v_accvgpr_read_b32 v243, a179
v_accvgpr_read_b32 v244, a180
v_accvgpr_read_b32 v245, a181
v_accvgpr_read_b32 v246, a182
v_accvgpr_read_b32 v247, a183
v_accvgpr_read_b32 v248, a184
v_accvgpr_read_b32 v249, a185
v_accvgpr_read_b32 v250, a186
v_accvgpr_read_b32 v251, a187
v_accvgpr_read_b32 v252, a188
v_accvgpr_read_b32 v253, a189
v_accvgpr_read_b32 v254, a190
v_accvgpr_read_b32 v255, a191
v_cvt_pk_bf16_f32 v12, v240, v241
v_cvt_pk_bf16_f32 v13, v242, v243
v_cvt_pk_bf16_f32 v14, v244, v245
v_cvt_pk_bf16_f32 v15, v246, v247
buffer_store_dwordx4 v[12:15], v2, s[4:7], s31 offen offset:0 sc1
v_cvt_pk_bf16_f32 v16, v248, v249
v_cvt_pk_bf16_f32 v17, v250, v251
v_cvt_pk_bf16_f32 v18, v252, v253
v_cvt_pk_bf16_f32 v19, v254, v255
buffer_store_dwordx4 v[16:19], v2, s[4:7], s31 offen offset:1024 sc1
s_nop 2
s_add_u32 s31, s31, 14336
Q21_exit:
s_waitcnt lgkmcnt(0)
s_barrier
s_add_u32 s67, s67, 1
s_cmp_lt_u32 s67, 2
s_cbranch_scc1 L_p0r1
s_waitcnt vmcnt(0)
s_barrier
s_cmp_lg_u32 s24, 0
s_cbranch_scc1 Q2s1_s
v_mov_b32 v4, 16
s_mov_b32 s47, 0
Q2s1_r_p:
buffer_load_dword v5, v4, s[92:95], 0 offen sc1
s_waitcnt vmcnt(0)
v_readfirstlane_b32 s46, v5
s_add_u32 s47, s47, 1
s_nop 1
s_cmp_lg_u32 s46, 0
s_cbranch_scc1 Q2s1_r_o
s_cmp_lt_u32 s47, 20000
s_cbranch_scc1 Q2s1_r_p
Q2s1_r_o:
s_lshl_b32 s46, s26, 7
s_add_u32 s46, s46, 75021696
v_mov_b32 v4, s46
v_mov_b32 v5, 1
s_mov_b64 exec, 1
buffer_atomic_add v5, v4, s[4:7], 0 offen
s_mov_b64 exec, -1
Q2s1_s:
L_p0done:
s_barrier
v_and_b32 v1, 63, v0
v_lshlrev_b32 v2, 4, v1
s_cmp_lt_u32 s22, 64
s_cbranch_scc1 L_X
s_sub_u32 s22, s22, 64
s_cmp_ge_u32 s22, 140
s_cbranch_scc1 L_noU
s_mul_i32 s29, s22, 2341
s_lshr_b32 s29, s29, 16
s_mul_i32 s28, s29, 28
s_sub_u32 s28, s22, s28
s_mov_b32 s25, s29
s_lshl_b32 s30, s28, 4
s_lshl_b32 s31, s24, 2
s_add_u32 s30, s30, s31
s_lshl_b32 s31, s28, 4
s_mul_i32 s32, s31, 2341
s_lshr_b32 s32, s32, 16
s_mul_i32 s33, s32, 28
s_sub_u32 s33, s31, s33
s_add_u32 s31, s31, 15
s_mul_i32 s34, s31, 2341
s_lshr_b32 s34, s34, 16
s_mul_i32 s33, s34, 28
s_sub_u32 s33, s31, s33
s_cmp_lg_u32 s24, 0
s_cbranch_scc1 RU_wb_w
s_lshl_b32 s46, s32, 7
s_add_u32 s46, s46, 75017344
v_mov_b32 v4, s46
v_mov_b32 v5, 7
s_lshl_b32 s46, s32, 7
s_add_u32 s46, s46, 75021696
v_cmp_eq_u32 vcc, 16, v2
v_mov_b32 v6, s46
s_nop 0
v_cndmask_b32 v4, v4, v6, vcc
v_mov_b32 v6, 7
v_cndmask_b32 v5, v5, v6, vcc
s_lshl_b32 s46, s34, 7
s_add_u32 s46, s46, 75017344
v_cmp_eq_u32 vcc, 32, v2
v_mov_b32 v6, s46
s_nop 0
v_cndmask_b32 v4, v4, v6, vcc
v_mov_b32 v6, 7
v_cndmask_b32 v5, v5, v6, vcc
s_lshl_b32 s46, s34, 7
s_add_u32 s46, s46, 75021696
v_cmp_eq_u32 vcc, 48, v2
v_mov_b32 v6, s46
s_nop 0
v_cndmask_b32 v4, v4, v6, vcc
v_mov_b32 v6, 7
v_cndmask_b32 v5, v5, v6, vcc
s_mov_b32 s46, 75019392
v_cmp_eq_u32 vcc, 64, v2
v_mov_b32 v6, s46
s_nop 0
v_cndmask_b32 v4, v4, v6, vcc
v_mov_b32 v6, 256
v_cndmask_b32 v5, v5, v6, vcc
s_mov_b32 s47, 0
RU_wb_p:
buffer_load_dword v6, v4, s[4:7], 0 offen sc1
s_waitcnt vmcnt(0)
v_cmp_lt_u32 vcc, v6, v5
s_cbranch_vccz RU_wb_w
s_add_u32 s47, s47, 1
s_cmp_gt_u32 s47, 20000
s_cbranch_scc1 RU_wb_w
s_branch RU_wb_p
RU_wb_w:
s_barrier
s_mul_i32 s31, s30, 14336
s_add_u32 s31, s31, 6422528
s_mov_b32 s38, s31
s_mul_i32 s31, s24, 7168
v_add_u32 v104, s31, v2
v_mov_b32 v105, v2
s_mul_i32 s32, s25, 28672
s_mul_i32 s33, s24, 7168
s_add_u32 s32, s32, s33
s_add_u32 s32, s32, 59834368
s_add_u32 s33, s32, 4096
buffer_load_dwordx4 v[36:39], v2, s[4:7], s32 offen offset:0 sc1
buffer_load_dwordx4 v[40:43], v2, s[4:7], s32 offen offset:1024 sc1
buffer_load_dwordx4 v[44:47], v2, s[4:7], s32 offen offset:2048 sc1
buffer_load_dwordx4 v[48:51], v2, s[4:7], s32 offen offset:3072 sc1
buffer_load_dwordx4 v[52:55], v2, s[4:7], s33 offen offset:0 sc1
buffer_load_dwordx4 v[56:59], v2, s[4:7], s33 offen offset:1024 sc1
buffer_load_dwordx4 v[60:63], v2, s[4:7], s33 offen offset:2048 sc1
s_add_u32 s31, s38, 0
buffer_load_dwordx4 a[0:3], v2, s[4:7], s31 offen sc1
s_add_u32 s31, s38, 14336
buffer_load_dwordx4 a[56:59], v2, s[4:7], s31 offen sc1
s_add_u32 s31, s38, 28672
buffer_load_dwordx4 a[112:115], v2, s[4:7], s31 offen sc1
s_add_u32 s31, s38, 43008
buffer_load_dwordx4 a[168:171], v2, s[4:7], s31 offen sc1
s_add_u32 s31, s38, 1024
buffer_load_dwordx4 a[4:7], v2, s[4:7], s31 offen sc1
s_add_u32 s31, s38, 15360
buffer_load_dwordx4 a[60:63], v2, s[4:7], s31 offen sc1
s_add_u32 s31, s38, 29696
buffer_load_dwordx4 a[116:119], v2, s[4:7], s31 offen sc1
s_add_u32 s31, s38, 44032
buffer_load_dwordx4 a[172:175], v2, s[4:7], s31 offen sc1
s_add_u32 s31, s38, 2048
buffer_load_dwordx4 a[8:11], v2, s[4:7], s31 offen sc1
s_add_u32 s31, s38, 16384
buffer_load_dwordx4 a[64:67], v2, s[4:7], s31 offen sc1
s_add_u32 s31, s38, 30720
buffer_load_dwordx4 a[120:123], v2, s[4:7], s31 offen sc1
s_add_u32 s31, s38, 45056
buffer_load_dwordx4 a[176:179], v2, s[4:7], s31 offen sc1
s_add_u32 s31, s38, 3072
buffer_load_dwordx4 a[12:15], v2, s[4:7], s31 offen sc1
s_add_u32 s31, s38, 17408
buffer_load_dwordx4 a[68:71], v2, s[4:7], s31 offen sc1
s_add_u32 s31, s38, 31744
buffer_load_dwordx4 a[124:127], v2, s[4:7], s31 offen sc1
s_add_u32 s31, s38, 46080
buffer_load_dwordx4 a[180:183], v2, s[4:7], s31 offen sc1
s_add_u32 s31, s38, 4096
buffer_load_dwordx4 a[16:19], v2, s[4:7], s31 offen sc1
s_add_u32 s31, s38, 18432
buffer_load_dwordx4 a[72:75], v2, s[4:7], s31 offen sc1
s_add_u32 s31, s38, 32768
buffer_load_dwordx4 a[128:131], v2, s[4:7], s31 offen sc1
s_add_u32 s31, s38, 47104
buffer_load_dwordx4 a[184:187], v2, s[4:7], s31 offen sc1
s_add_u32 s31, s38, 5120
buffer_load_dwordx4 a[20:23], v2, s[4:7], s31 offen sc1
s_add_u32 s31, s38, 19456
buffer_load_dwordx4 a[76:79], v2, s[4:7], s31 offen sc1
s_add_u32 s31, s38, 33792
buffer_load_dwordx4 a[132:135], v2, s[4:7], s31 offen sc1
s_add_u32 s31, s38, 48128
buffer_load_dwordx4 a[188:191], v2, s[4:7], s31 offen sc1
s_add_u32 s31, s38, 6144
buffer_load_dwordx4 a[24:27], v2, s[4:7], s31 offen sc1
s_add_u32 s31, s38, 20480
buffer_load_dwordx4 a[80:83], v2, s[4:7], s31 offen sc1
s_add_u32 s31, s38, 34816
buffer_load_dwordx4 a[136:139], v2, s[4:7], s31 offen sc1
s_add_u32 s31, s38, 49152
buffer_load_dwordx4 a[192:195], v2, s[4:7], s31 offen sc1
s_add_u32 s31, s38, 7168
buffer_load_dwordx4 a[28:31], v2, s[4:7], s31 offen sc1
s_add_u32 s31, s38, 21504
buffer_load_dwordx4 a[84:87], v2, s[4:7], s31 offen sc1
s_add_u32 s31, s38, 35840
buffer_load_dwordx4 a[140:143], v2, s[4:7], s31 offen sc1
s_add_u32 s31, s38, 50176
buffer_load_dwordx4 a[196:199], v2, s[4:7], s31 offen sc1
s_add_u32 s31, s38, 8192
buffer_load_dwordx4 a[32:35], v2, s[4:7], s31 offen sc1
s_add_u32 s31, s38, 22528
buffer_load_dwordx4 a[88:91], v2, s[4:7], s31 offen sc1
s_add_u32 s31, s38, 36864
buffer_load_dwordx4 a[144:147], v2, s[4:7], s31 offen sc1
s_add_u32 s31, s38, 51200
buffer_load_dwordx4 a[200:203], v2, s[4:7], s31 offen sc1
s_add_u32 s31, s38, 9216
buffer_load_dwordx4 a[36:39], v2, s[4:7], s31 offen sc1
s_add_u32 s31, s38, 23552
buffer_load_dwordx4 a[92:95], v2, s[4:7], s31 offen sc1
s_add_u32 s31, s38, 37888
buffer_load_dwordx4 a[148:151], v2, s[4:7], s31 offen sc1
s_add_u32 s31, s38, 52224
buffer_load_dwordx4 a[204:207], v2, s[4:7], s31 offen sc1
s_add_u32 s31, s38, 10240
buffer_load_dwordx4 a[40:43], v2, s[4:7], s31 offen sc1
s_add_u32 s31, s38, 24576
buffer_load_dwordx4 a[96:99], v2, s[4:7], s31 offen sc1
s_add_u32 s31, s38, 38912
buffer_load_dwordx4 a[152:155], v2, s[4:7], s31 offen sc1
s_add_u32 s31, s38, 53248
buffer_load_dwordx4 a[208:211], v2, s[4:7], s31 offen sc1
s_add_u32 s31, s38, 11264
buffer_load_dwordx4 a[44:47], v2, s[4:7], s31 offen sc1
s_add_u32 s31, s38, 25600
buffer_load_dwordx4 a[100:103], v2, s[4:7], s31 offen sc1
s_add_u32 s31, s38, 39936
buffer_load_dwordx4 a[156:159], v2, s[4:7], s31 offen sc1
s_add_u32 s31, s38, 54272
buffer_load_dwordx4 a[212:215], v2, s[4:7], s31 offen sc1
s_add_u32 s31, s38, 12288
buffer_load_dwordx4 a[48:51], v2, s[4:7], s31 offen sc1
s_add_u32 s31, s38, 26624
buffer_load_dwordx4 a[104:107], v2, s[4:7], s31 offen sc1
s_add_u32 s31, s38, 40960
buffer_load_dwordx4 a[160:163], v2, s[4:7], s31 offen sc1
s_add_u32 s31, s38, 55296
buffer_load_dwordx4 a[216:219], v2, s[4:7], s31 offen sc1
s_add_u32 s31, s38, 13312
buffer_load_dwordx4 a[52:55], v2, s[4:7], s31 offen sc1
s_add_u32 s31, s38, 27648
buffer_load_dwordx4 a[108:111], v2, s[4:7], s31 offen sc1
s_add_u32 s31, s38, 41984
buffer_load_dwordx4 a[164:167], v2, s[4:7], s31 offen sc1
s_add_u32 s31, s38, 56320
buffer_load_dwordx4 a[220:223], v2, s[4:7], s31 offen sc1
s_waitcnt vmcnt(56)
ds_write_b128 v104, v[36:39] offset:0
ds_write_b128 v104, v[40:43] offset:1024
ds_write_b128 v104, v[44:47] offset:2048
ds_write_b128 v104, v[48:51] offset:3072
ds_write_b128 v104, v[52:55] offset:4096
ds_write_b128 v104, v[56:59] offset:5120
ds_write_b128 v104, v[60:63] offset:6144
v_xor_b32 v104, 0x8000, v104
s_waitcnt lgkmcnt(0)
s_barrier
s_mov_b32 s34, s25
s_add_u32 s25, s25, 5
ds_read_b128 v[4:7], v105 offset:0
ds_read_b128 v[8:11], v105 offset:14336
ds_read_b128 v[12:15], v105 offset:1024
ds_read_b128 v[16:19], v105 offset:15360
ds_read_b128 v[20:23], v105 offset:2048
ds_read_b128 v[24:27], v105 offset:16384
s_waitcnt vmcnt(52)
s_waitcnt lgkmcnt(4)
v_mfma_f32_16x16x32_bf16 v[64:67], v[4:7], a[0:3], 0
v_mfma_f32_16x16x32_bf16 v[68:71], v[8:11], a[0:3], 0
v_mfma_f32_16x16x32_bf16 v[72:75], v[4:7], a[56:59], 0
v_mfma_f32_16x16x32_bf16 v[76:79], v[8:11], a[56:59], 0
ds_read_b128 v[28:31], v105 offset:3072
ds_read_b128 v[32:35], v105 offset:17408
v_mfma_f32_16x16x32_bf16 v[80:83], v[4:7], a[112:115], 0
v_mfma_f32_16x16x32_bf16 v[84:87], v[8:11], a[112:115], 0
v_mfma_f32_16x16x32_bf16 v[88:91], v[4:7], a[168:171], 0
v_mfma_f32_16x16x32_bf16 v[92:95], v[8:11], a[168:171], 0
s_waitcnt vmcnt(48)
s_waitcnt lgkmcnt(4)
v_mfma_f32_16x16x32_bf16 v[64:67], v[12:15], a[4:7], v[64:67]
v_mfma_f32_16x16x32_bf16 v[68:71], v[16:19], a[4:7], v[68:71]
v_mfma_f32_16x16x32_bf16 v[72:75], v[12:15], a[60:63], v[72:75]
v_mfma_f32_16x16x32_bf16 v[76:79], v[16:19], a[60:63], v[76:79]
ds_read_b128 v[4:7], v105 offset:4096
ds_read_b128 v[8:11], v105 offset:18432
v_mfma_f32_16x16x32_bf16 v[80:83], v[12:15], a[116:119], v[80:83]
v_mfma_f32_16x16x32_bf16 v[84:87], v[16:19], a[116:119], v[84:87]
v_mfma_f32_16x16x32_bf16 v[88:91], v[12:15], a[172:175], v[88:91]
v_mfma_f32_16x16x32_bf16 v[92:95], v[16:19], a[172:175], v[92:95]
s_waitcnt vmcnt(44)
s_waitcnt lgkmcnt(4)
v_mfma_f32_16x16x32_bf16 v[64:67], v[20:23], a[8:11], v[64:67]
v_mfma_f32_16x16x32_bf16 v[68:71], v[24:27], a[8:11], v[68:71]
v_mfma_f32_16x16x32_bf16 v[72:75], v[20:23], a[64:67], v[72:75]
v_mfma_f32_16x16x32_bf16 v[76:79], v[24:27], a[64:67], v[76:79]
ds_read_b128 v[12:15], v105 offset:5120
ds_read_b128 v[16:19], v105 offset:19456
v_mfma_f32_16x16x32_bf16 v[80:83], v[20:23], a[120:123], v[80:83]
v_mfma_f32_16x16x32_bf16 v[84:87], v[24:27], a[120:123], v[84:87]
v_mfma_f32_16x16x32_bf16 v[88:91], v[20:23], a[176:179], v[88:91]
v_mfma_f32_16x16x32_bf16 v[92:95], v[24:27], a[176:179], v[92:95]
s_waitcnt vmcnt(40)
s_waitcnt lgkmcnt(4)
v_mfma_f32_16x16x32_bf16 v[64:67], v[28:31], a[12:15], v[64:67]
v_mfma_f32_16x16x32_bf16 v[68:71], v[32:35], a[12:15], v[68:71]
v_mfma_f32_16x16x32_bf16 v[72:75], v[28:31], a[68:71], v[72:75]
v_mfma_f32_16x16x32_bf16 v[76:79], v[32:35], a[68:71], v[76:79]
ds_read_b128 v[20:23], v105 offset:6144
ds_read_b128 v[24:27], v105 offset:20480
v_mfma_f32_16x16x32_bf16 v[80:83], v[28:31], a[124:127], v[80:83]
v_mfma_f32_16x16x32_bf16 v[84:87], v[32:35], a[124:127], v[84:87]
v_mfma_f32_16x16x32_bf16 v[88:91], v[28:31], a[180:183], v[88:91]
v_mfma_f32_16x16x32_bf16 v[92:95], v[32:35], a[180:183], v[92:95]
s_waitcnt vmcnt(36)
s_waitcnt lgkmcnt(4)
v_mfma_f32_16x16x32_bf16 v[64:67], v[4:7], a[16:19], v[64:67]
v_mfma_f32_16x16x32_bf16 v[68:71], v[8:11], a[16:19], v[68:71]
v_mfma_f32_16x16x32_bf16 v[72:75], v[4:7], a[72:75], v[72:75]
v_mfma_f32_16x16x32_bf16 v[76:79], v[8:11], a[72:75], v[76:79]
ds_read_b128 v[28:31], v105 offset:7168
ds_read_b128 v[32:35], v105 offset:21504
v_mfma_f32_16x16x32_bf16 v[80:83], v[4:7], a[128:131], v[80:83]
v_mfma_f32_16x16x32_bf16 v[84:87], v[8:11], a[128:131], v[84:87]
v_mfma_f32_16x16x32_bf16 v[88:91], v[4:7], a[184:187], v[88:91]
v_mfma_f32_16x16x32_bf16 v[92:95], v[8:11], a[184:187], v[92:95]
s_waitcnt vmcnt(32)
s_waitcnt lgkmcnt(4)
v_mfma_f32_16x16x32_bf16 v[64:67], v[12:15], a[20:23], v[64:67]
v_mfma_f32_16x16x32_bf16 v[68:71], v[16:19], a[20:23], v[68:71]
v_mfma_f32_16x16x32_bf16 v[72:75], v[12:15], a[76:79], v[72:75]
v_mfma_f32_16x16x32_bf16 v[76:79], v[16:19], a[76:79], v[76:79]
ds_read_b128 v[4:7], v105 offset:8192
ds_read_b128 v[8:11], v105 offset:22528
v_mfma_f32_16x16x32_bf16 v[80:83], v[12:15], a[132:135], v[80:83]
v_mfma_f32_16x16x32_bf16 v[84:87], v[16:19], a[132:135], v[84:87]
v_mfma_f32_16x16x32_bf16 v[88:91], v[12:15], a[188:191], v[88:91]
v_mfma_f32_16x16x32_bf16 v[92:95], v[16:19], a[188:191], v[92:95]
s_waitcnt vmcnt(28)
s_waitcnt lgkmcnt(4)
v_mfma_f32_16x16x32_bf16 v[64:67], v[20:23], a[24:27], v[64:67]
v_mfma_f32_16x16x32_bf16 v[68:71], v[24:27], a[24:27], v[68:71]
v_mfma_f32_16x16x32_bf16 v[72:75], v[20:23], a[80:83], v[72:75]
v_mfma_f32_16x16x32_bf16 v[76:79], v[24:27], a[80:83], v[76:79]
ds_read_b128 v[12:15], v105 offset:9216
ds_read_b128 v[16:19], v105 offset:23552
v_mfma_f32_16x16x32_bf16 v[80:83], v[20:23], a[136:139], v[80:83]
v_mfma_f32_16x16x32_bf16 v[84:87], v[24:27], a[136:139], v[84:87]
v_mfma_f32_16x16x32_bf16 v[88:91], v[20:23], a[192:195], v[88:91]
v_mfma_f32_16x16x32_bf16 v[92:95], v[24:27], a[192:195], v[92:95]
s_mul_i32 s32, s25, 28672
s_mul_i32 s33, s24, 7168
s_add_u32 s32, s32, s33
s_add_u32 s32, s32, 59834368
s_add_u32 s33, s32, 4096
buffer_load_dwordx4 v[36:39], v2, s[4:7], s32 offen offset:0 sc1
buffer_load_dwordx4 v[40:43], v2, s[4:7], s32 offen offset:1024 sc1
buffer_load_dwordx4 v[44:47], v2, s[4:7], s32 offen offset:2048 sc1
buffer_load_dwordx4 v[48:51], v2, s[4:7], s32 offen offset:3072 sc1
buffer_load_dwordx4 v[52:55], v2, s[4:7], s33 offen offset:0 sc1
buffer_load_dwordx4 v[56:59], v2, s[4:7], s33 offen offset:1024 sc1
buffer_load_dwordx4 v[60:63], v2, s[4:7], s33 offen offset:2048 sc1
s_waitcnt vmcnt(31)
s_waitcnt lgkmcnt(4)
v_mfma_f32_16x16x32_bf16 v[64:67], v[28:31], a[28:31], v[64:67]
v_mfma_f32_16x16x32_bf16 v[68:71], v[32:35], a[28:31], v[68:71]
v_mfma_f32_16x16x32_bf16 v[72:75], v[28:31], a[84:87], v[72:75]
v_mfma_f32_16x16x32_bf16 v[76:79], v[32:35], a[84:87], v[76:79]
ds_read_b128 v[20:23], v105 offset:10240
ds_read_b128 v[24:27], v105 offset:24576
v_mfma_f32_16x16x32_bf16 v[80:83], v[28:31], a[140:143], v[80:83]
v_mfma_f32_16x16x32_bf16 v[84:87], v[32:35], a[140:143], v[84:87]
v_mfma_f32_16x16x32_bf16 v[88:91], v[28:31], a[196:199], v[88:91]
v_mfma_f32_16x16x32_bf16 v[92:95], v[32:35], a[196:199], v[92:95]
s_waitcnt vmcnt(27)
s_waitcnt lgkmcnt(4)
v_mfma_f32_16x16x32_bf16 v[64:67], v[4:7], a[32:35], v[64:67]
v_mfma_f32_16x16x32_bf16 v[68:71], v[8:11], a[32:35], v[68:71]
v_mfma_f32_16x16x32_bf16 v[72:75], v[4:7], a[88:91], v[72:75]
v_mfma_f32_16x16x32_bf16 v[76:79], v[8:11], a[88:91], v[76:79]
ds_read_b128 v[28:31], v105 offset:11264
ds_read_b128 v[32:35], v105 offset:25600
v_mfma_f32_16x16x32_bf16 v[80:83], v[4:7], a[144:147], v[80:83]
v_mfma_f32_16x16x32_bf16 v[84:87], v[8:11], a[144:147], v[84:87]
v_mfma_f32_16x16x32_bf16 v[88:91], v[4:7], a[200:203], v[88:91]
v_mfma_f32_16x16x32_bf16 v[92:95], v[8:11], a[200:203], v[92:95]
s_waitcnt vmcnt(23)
s_waitcnt lgkmcnt(4)
v_mfma_f32_16x16x32_bf16 v[64:67], v[12:15], a[36:39], v[64:67]
v_mfma_f32_16x16x32_bf16 v[68:71], v[16:19], a[36:39], v[68:71]
v_mfma_f32_16x16x32_bf16 v[72:75], v[12:15], a[92:95], v[72:75]
v_mfma_f32_16x16x32_bf16 v[76:79], v[16:19], a[92:95], v[76:79]
ds_read_b128 v[4:7], v105 offset:12288
ds_read_b128 v[8:11], v105 offset:26624
v_mfma_f32_16x16x32_bf16 v[80:83], v[12:15], a[148:151], v[80:83]
v_mfma_f32_16x16x32_bf16 v[84:87], v[16:19], a[148:151], v[84:87]
v_mfma_f32_16x16x32_bf16 v[88:91], v[12:15], a[204:207], v[88:91]
v_mfma_f32_16x16x32_bf16 v[92:95], v[16:19], a[204:207], v[92:95]
s_waitcnt vmcnt(19)
s_waitcnt lgkmcnt(4)
v_mfma_f32_16x16x32_bf16 v[64:67], v[20:23], a[40:43], v[64:67]
v_mfma_f32_16x16x32_bf16 v[68:71], v[24:27], a[40:43], v[68:71]
v_mfma_f32_16x16x32_bf16 v[72:75], v[20:23], a[96:99], v[72:75]
v_mfma_f32_16x16x32_bf16 v[76:79], v[24:27], a[96:99], v[76:79]
ds_read_b128 v[12:15], v105 offset:13312
ds_read_b128 v[16:19], v105 offset:27648
v_mfma_f32_16x16x32_bf16 v[80:83], v[20:23], a[152:155], v[80:83]
v_mfma_f32_16x16x32_bf16 v[84:87], v[24:27], a[152:155], v[84:87]
v_mfma_f32_16x16x32_bf16 v[88:91], v[20:23], a[208:211], v[88:91]
v_mfma_f32_16x16x32_bf16 v[92:95], v[24:27], a[208:211], v[92:95]
s_waitcnt vmcnt(15)
s_waitcnt lgkmcnt(4)
v_mfma_f32_16x16x32_bf16 v[64:67], v[28:31], a[44:47], v[64:67]
v_mfma_f32_16x16x32_bf16 v[68:71], v[32:35], a[44:47], v[68:71]
v_mfma_f32_16x16x32_bf16 v[72:75], v[28:31], a[100:103], v[72:75]
v_mfma_f32_16x16x32_bf16 v[76:79], v[32:35], a[100:103], v[76:79]
v_mfma_f32_16x16x32_bf16 v[80:83], v[28:31], a[156:159], v[80:83]
v_mfma_f32_16x16x32_bf16 v[84:87], v[32:35], a[156:159], v[84:87]
v_mfma_f32_16x16x32_bf16 v[88:91], v[28:31], a[212:215], v[88:91]
v_mfma_f32_16x16x32_bf16 v[92:95], v[32:35], a[212:215], v[92:95]
s_waitcnt vmcnt(11)
s_waitcnt lgkmcnt(2)
v_mfma_f32_16x16x32_bf16 v[64:67], v[4:7], a[48:51], v[64:67]
v_mfma_f32_16x16x32_bf16 v[68:71], v[8:11], a[48:51], v[68:71]
v_mfma_f32_16x16x32_bf16 v[72:75], v[4:7], a[104:107], v[72:75]
v_mfma_f32_16x16x32_bf16 v[76:79], v[8:11], a[104:107], v[76:79]
v_mfma_f32_16x16x32_bf16 v[80:83], v[4:7], a[160:163], v[80:83]
v_mfma_f32_16x16x32_bf16 v[84:87], v[8:11], a[160:163], v[84:87]
v_mfma_f32_16x16x32_bf16 v[88:91], v[4:7], a[216:219], v[88:91]
v_mfma_f32_16x16x32_bf16 v[92:95], v[8:11], a[216:219], v[92:95]
s_waitcnt vmcnt(7)
s_waitcnt lgkmcnt(0)
v_mfma_f32_16x16x32_bf16 v[64:67], v[12:15], a[52:55], v[64:67]
v_mfma_f32_16x16x32_bf16 v[68:71], v[16:19], a[52:55], v[68:71]
v_mfma_f32_16x16x32_bf16 v[72:75], v[12:15], a[108:111], v[72:75]
v_mfma_f32_16x16x32_bf16 v[76:79], v[16:19], a[108:111], v[76:79]
v_mfma_f32_16x16x32_bf16 v[80:83], v[12:15], a[164:167], v[80:83]
v_mfma_f32_16x16x32_bf16 v[84:87], v[16:19], a[164:167], v[84:87]
v_mfma_f32_16x16x32_bf16 v[88:91], v[12:15], a[220:223], v[88:91]
v_mfma_f32_16x16x32_bf16 v[92:95], v[16:19], a[220:223], v[92:95]
s_branch RU_epi
RU_loop:
s_mov_b32 s34, s25
s_add_u32 s25, s25, 5
s_cmp_ge_u32 s25, 64
s_cbranch_scc1 RU_nopf
s_mul_i32 s32, s25, 28672
s_mul_i32 s33, s24, 7168
s_add_u32 s32, s32, s33
s_add_u32 s32, s32, 59834368
s_add_u32 s33, s32, 4096
buffer_load_dwordx4 v[36:39], v2, s[4:7], s32 offen offset:0 sc1
buffer_load_dwordx4 v[40:43], v2, s[4:7], s32 offen offset:1024 sc1
buffer_load_dwordx4 v[44:47], v2, s[4:7], s32 offen offset:2048 sc1
buffer_load_dwordx4 v[48:51], v2, s[4:7], s32 offen offset:3072 sc1
buffer_load_dwordx4 v[52:55], v2, s[4:7], s33 offen offset:0 sc1
buffer_load_dwordx4 v[56:59], v2, s[4:7], s33 offen offset:1024 sc1
buffer_load_dwordx4 v[60:63], v2, s[4:7], s33 offen offset:2048 sc1
RU_nopf:
ds_read_b128 v[4:7], v105 offset:0
ds_read_b128 v[8:11], v105 offset:14336
ds_read_b128 v[12:15], v105 offset:1024
ds_read_b128 v[16:19], v105 offset:15360
ds_read_b128 v[20:23], v105 offset:2048
ds_read_b128 v[24:27], v105 offset:16384
s_waitcnt lgkmcnt(4)
v_mfma_f32_16x16x32_bf16 v[64:67], v[4:7], a[0:3], 0
v_mfma_f32_16x16x32_bf16 v[68:71], v[8:11], a[0:3], 0
v_mfma_f32_16x16x32_bf16 v[72:75], v[4:7], a[56:59], 0
v_mfma_f32_16x16x32_bf16 v[76:79], v[8:11], a[56:59], 0
ds_read_b128 v[28:31], v105 offset:3072
ds_read_b128 v[32:35], v105 offset:17408
v_mfma_f32_16x16x32_bf16 v[80:83], v[4:7], a[112:115], 0
v_mfma_f32_16x16x32_bf16 v[84:87], v[8:11], a[112:115], 0
v_mfma_f32_16x16x32_bf16 v[88:91], v[4:7], a[168:171], 0
v_mfma_f32_16x16x32_bf16 v[92:95], v[8:11], a[168:171], 0
s_waitcnt lgkmcnt(4)
v_mfma_f32_16x16x32_bf16 v[64:67], v[12:15], a[4:7], v[64:67]
v_mfma_f32_16x16x32_bf16 v[68:71], v[16:19], a[4:7], v[68:71]
v_mfma_f32_16x16x32_bf16 v[72:75], v[12:15], a[60:63], v[72:75]
v_mfma_f32_16x16x32_bf16 v[76:79], v[16:19], a[60:63], v[76:79]
ds_read_b128 v[4:7], v105 offset:4096
ds_read_b128 v[8:11], v105 offset:18432
v_mfma_f32_16x16x32_bf16 v[80:83], v[12:15], a[116:119], v[80:83]
v_mfma_f32_16x16x32_bf16 v[84:87], v[16:19], a[116:119], v[84:87]
v_mfma_f32_16x16x32_bf16 v[88:91], v[12:15], a[172:175], v[88:91]
v_mfma_f32_16x16x32_bf16 v[92:95], v[16:19], a[172:175], v[92:95]
s_waitcnt lgkmcnt(4)
v_mfma_f32_16x16x32_bf16 v[64:67], v[20:23], a[8:11], v[64:67]
v_mfma_f32_16x16x32_bf16 v[68:71], v[24:27], a[8:11], v[68:71]
v_mfma_f32_16x16x32_bf16 v[72:75], v[20:23], a[64:67], v[72:75]
v_mfma_f32_16x16x32_bf16 v[76:79], v[24:27], a[64:67], v[76:79]
ds_read_b128 v[12:15], v105 offset:5120
ds_read_b128 v[16:19], v105 offset:19456
v_mfma_f32_16x16x32_bf16 v[80:83], v[20:23], a[120:123], v[80:83]
v_mfma_f32_16x16x32_bf16 v[84:87], v[24:27], a[120:123], v[84:87]
v_mfma_f32_16x16x32_bf16 v[88:91], v[20:23], a[176:179], v[88:91]
v_mfma_f32_16x16x32_bf16 v[92:95], v[24:27], a[176:179], v[92:95]
s_waitcnt lgkmcnt(4)
v_mfma_f32_16x16x32_bf16 v[64:67], v[28:31], a[12:15], v[64:67]
v_mfma_f32_16x16x32_bf16 v[68:71], v[32:35], a[12:15], v[68:71]
v_mfma_f32_16x16x32_bf16 v[72:75], v[28:31], a[68:71], v[72:75]
v_mfma_f32_16x16x32_bf16 v[76:79], v[32:35], a[68:71], v[76:79]
ds_read_b128 v[20:23], v105 offset:6144
ds_read_b128 v[24:27], v105 offset:20480
v_mfma_f32_16x16x32_bf16 v[80:83], v[28:31], a[124:127], v[80:83]
v_mfma_f32_16x16x32_bf16 v[84:87], v[32:35], a[124:127], v[84:87]
v_mfma_f32_16x16x32_bf16 v[88:91], v[28:31], a[180:183], v[88:91]
v_mfma_f32_16x16x32_bf16 v[92:95], v[32:35], a[180:183], v[92:95]
s_waitcnt lgkmcnt(4)
v_mfma_f32_16x16x32_bf16 v[64:67], v[4:7], a[16:19], v[64:67]
v_mfma_f32_16x16x32_bf16 v[68:71], v[8:11], a[16:19], v[68:71]
v_mfma_f32_16x16x32_bf16 v[72:75], v[4:7], a[72:75], v[72:75]
v_mfma_f32_16x16x32_bf16 v[76:79], v[8:11], a[72:75], v[76:79]
ds_read_b128 v[28:31], v105 offset:7168
ds_read_b128 v[32:35], v105 offset:21504
v_mfma_f32_16x16x32_bf16 v[80:83], v[4:7], a[128:131], v[80:83]
v_mfma_f32_16x16x32_bf16 v[84:87], v[8:11], a[128:131], v[84:87]
v_mfma_f32_16x16x32_bf16 v[88:91], v[4:7], a[184:187], v[88:91]
v_mfma_f32_16x16x32_bf16 v[92:95], v[8:11], a[184:187], v[92:95]
s_waitcnt lgkmcnt(4)
v_mfma_f32_16x16x32_bf16 v[64:67], v[12:15], a[20:23], v[64:67]
v_mfma_f32_16x16x32_bf16 v[68:71], v[16:19], a[20:23], v[68:71]
v_mfma_f32_16x16x32_bf16 v[72:75], v[12:15], a[76:79], v[72:75]
v_mfma_f32_16x16x32_bf16 v[76:79], v[16:19], a[76:79], v[76:79]
ds_read_b128 v[4:7], v105 offset:8192
ds_read_b128 v[8:11], v105 offset:22528
v_mfma_f32_16x16x32_bf16 v[80:83], v[12:15], a[132:135], v[80:83]
v_mfma_f32_16x16x32_bf16 v[84:87], v[16:19], a[132:135], v[84:87]
v_mfma_f32_16x16x32_bf16 v[88:91], v[12:15], a[188:191], v[88:91]
v_mfma_f32_16x16x32_bf16 v[92:95], v[16:19], a[188:191], v[92:95]
s_waitcnt lgkmcnt(4)
v_mfma_f32_16x16x32_bf16 v[64:67], v[20:23], a[24:27], v[64:67]
v_mfma_f32_16x16x32_bf16 v[68:71], v[24:27], a[24:27], v[68:71]
v_mfma_f32_16x16x32_bf16 v[72:75], v[20:23], a[80:83], v[72:75]
v_mfma_f32_16x16x32_bf16 v[76:79], v[24:27], a[80:83], v[76:79]
ds_read_b128 v[12:15], v105 offset:9216
ds_read_b128 v[16:19], v105 offset:23552
v_mfma_f32_16x16x32_bf16 v[80:83], v[20:23], a[136:139], v[80:83]
v_mfma_f32_16x16x32_bf16 v[84:87], v[24:27], a[136:139], v[84:87]
v_mfma_f32_16x16x32_bf16 v[88:91], v[20:23], a[192:195], v[88:91]
v_mfma_f32_16x16x32_bf16 v[92:95], v[24:27], a[192:195], v[92:95]
s_waitcnt lgkmcnt(4)
v_mfma_f32_16x16x32_bf16 v[64:67], v[28:31], a[28:31], v[64:67]
v_mfma_f32_16x16x32_bf16 v[68:71], v[32:35], a[28:31], v[68:71]
v_mfma_f32_16x16x32_bf16 v[72:75], v[28:31], a[84:87], v[72:75]
v_mfma_f32_16x16x32_bf16 v[76:79], v[32:35], a[84:87], v[76:79]
ds_read_b128 v[20:23], v105 offset:10240
ds_read_b128 v[24:27], v105 offset:24576
v_mfma_f32_16x16x32_bf16 v[80:83], v[28:31], a[140:143], v[80:83]
v_mfma_f32_16x16x32_bf16 v[84:87], v[32:35], a[140:143], v[84:87]
v_mfma_f32_16x16x32_bf16 v[88:91], v[28:31], a[196:199], v[88:91]
v_mfma_f32_16x16x32_bf16 v[92:95], v[32:35], a[196:199], v[92:95]
s_waitcnt lgkmcnt(4)
v_mfma_f32_16x16x32_bf16 v[64:67], v[4:7], a[32:35], v[64:67]
v_mfma_f32_16x16x32_bf16 v[68:71], v[8:11], a[32:35], v[68:71]
v_mfma_f32_16x16x32_bf16 v[72:75], v[4:7], a[88:91], v[72:75]
v_mfma_f32_16x16x32_bf16 v[76:79], v[8:11], a[88:91], v[76:79]
ds_read_b128 v[28:31], v105 offset:11264
ds_read_b128 v[32:35], v105 offset:25600
v_mfma_f32_16x16x32_bf16 v[80:83], v[4:7], a[144:147], v[80:83]
v_mfma_f32_16x16x32_bf16 v[84:87], v[8:11], a[144:147], v[84:87]
v_mfma_f32_16x16x32_bf16 v[88:91], v[4:7], a[200:203], v[88:91]
v_mfma_f32_16x16x32_bf16 v[92:95], v[8:11], a[200:203], v[92:95]
s_waitcnt lgkmcnt(4)
v_mfma_f32_16x16x32_bf16 v[64:67], v[12:15], a[36:39], v[64:67]
v_mfma_f32_16x16x32_bf16 v[68:71], v[16:19], a[36:39], v[68:71]
v_mfma_f32_16x16x32_bf16 v[72:75], v[12:15], a[92:95], v[72:75]
v_mfma_f32_16x16x32_bf16 v[76:79], v[16:19], a[92:95], v[76:79]
ds_read_b128 v[4:7], v105 offset:12288
ds_read_b128 v[8:11], v105 offset:26624
v_mfma_f32_16x16x32_bf16 v[80:83], v[12:15], a[148:151], v[80:83]
v_mfma_f32_16x16x32_bf16 v[84:87], v[16:19], a[148:151], v[84:87]
v_mfma_f32_16x16x32_bf16 v[88:91], v[12:15], a[204:207], v[88:91]
v_mfma_f32_16x16x32_bf16 v[92:95], v[16:19], a[204:207], v[92:95]
s_waitcnt lgkmcnt(4)
v_mfma_f32_16x16x32_bf16 v[64:67], v[20:23], a[40:43], v[64:67]
v_mfma_f32_16x16x32_bf16 v[68:71], v[24:27], a[40:43], v[68:71]
v_mfma_f32_16x16x32_bf16 v[72:75], v[20:23], a[96:99], v[72:75]
v_mfma_f32_16x16x32_bf16 v[76:79], v[24:27], a[96:99], v[76:79]
ds_read_b128 v[12:15], v105 offset:13312
ds_read_b128 v[16:19], v105 offset:27648
v_mfma_f32_16x16x32_bf16 v[80:83], v[20:23], a[152:155], v[80:83]
v_mfma_f32_16x16x32_bf16 v[84:87], v[24:27], a[152:155], v[84:87]
v_mfma_f32_16x16x32_bf16 v[88:91], v[20:23], a[208:211], v[88:91]
v_mfma_f32_16x16x32_bf16 v[92:95], v[24:27], a[208:211], v[92:95]
s_waitcnt lgkmcnt(4)
v_mfma_f32_16x16x32_bf16 v[64:67], v[28:31], a[44:47], v[64:67]
v_mfma_f32_16x16x32_bf16 v[68:71], v[32:35], a[44:47], v[68:71]
v_mfma_f32_16x16x32_bf16 v[72:75], v[28:31], a[100:103], v[72:75]
v_mfma_f32_16x16x32_bf16 v[76:79], v[32:35], a[100:103], v[76:79]
v_mfma_f32_16x16x32_bf16 v[80:83], v[28:31], a[156:159], v[80:83]
v_mfma_f32_16x16x32_bf16 v[84:87], v[32:35], a[156:159], v[84:87]
v_mfma_f32_16x16x32_bf16 v[88:91], v[28:31], a[212:215], v[88:91]
v_mfma_f32_16x16x32_bf16 v[92:95], v[32:35], a[212:215], v[92:95]
s_waitcnt lgkmcnt(2)
v_mfma_f32_16x16x32_bf16 v[64:67], v[4:7], a[48:51], v[64:67]
v_mfma_f32_16x16x32_bf16 v[68:71], v[8:11], a[48:51], v[68:71]
v_mfma_f32_16x16x32_bf16 v[72:75], v[4:7], a[104:107], v[72:75]
v_mfma_f32_16x16x32_bf16 v[76:79], v[8:11], a[104:107], v[76:79]
v_mfma_f32_16x16x32_bf16 v[80:83], v[4:7], a[160:163], v[80:83]
v_mfma_f32_16x16x32_bf16 v[84:87], v[8:11], a[160:163], v[84:87]
v_mfma_f32_16x16x32_bf16 v[88:91], v[4:7], a[216:219], v[88:91]
v_mfma_f32_16x16x32_bf16 v[92:95], v[8:11], a[216:219], v[92:95]
s_waitcnt lgkmcnt(0)
v_mfma_f32_16x16x32_bf16 v[64:67], v[12:15], a[52:55], v[64:67]
v_mfma_f32_16x16x32_bf16 v[68:71], v[16:19], a[52:55], v[68:71]
v_mfma_f32_16x16x32_bf16 v[72:75], v[12:15], a[108:111], v[72:75]
v_mfma_f32_16x16x32_bf16 v[76:79], v[16:19], a[108:111], v[76:79]
v_mfma_f32_16x16x32_bf16 v[80:83], v[12:15], a[164:167], v[80:83]
v_mfma_f32_16x16x32_bf16 v[84:87], v[16:19], a[164:167], v[84:87]
v_mfma_f32_16x16x32_bf16 v[88:91], v[12:15], a[220:223], v[88:91]
v_mfma_f32_16x16x32_bf16 v[92:95], v[16:19], a[220:223], v[92:95]
RU_epi:
v_xor_b32 v105, 0x8000, v105
s_mul_i32 s35, s34, 458752
s_lshl_b32 s36, s30, 10
s_add_u32 s35, s35, s36
s_add_u32 s35, s35, 12845056
s_nop 7
v_cvt_pk_bf16_f32 v96, v64, v65
v_cvt_pk_bf16_f32 v97, v66, v67
v_cvt_pk_bf16_f32 v98, v68, v69
v_cvt_pk_bf16_f32 v99, v70, v71
buffer_store_dwordx4 v[96:99], v2, s[4:7], s35 offen offset:0 sc1
v_cvt_pk_bf16_f32 v100, v72, v73
v_cvt_pk_bf16_f32 v101, v74, v75
v_cvt_pk_bf16_f32 v102, v76, v77
v_cvt_pk_bf16_f32 v103, v78, v79
buffer_store_dwordx4 v[100:103], v2, s[4:7], s35 offen offset:1024 sc1
s_nop 2
v_cvt_pk_bf16_f32 v96, v80, v81
v_cvt_pk_bf16_f32 v97, v82, v83
v_cvt_pk_bf16_f32 v98, v84, v85
v_cvt_pk_bf16_f32 v99, v86, v87
buffer_store_dwordx4 v[96:99], v2, s[4:7], s35 offen offset:2048 sc1
v_cvt_pk_bf16_f32 v100, v88, v89
v_cvt_pk_bf16_f32 v101, v90, v91
v_cvt_pk_bf16_f32 v102, v92, v93
v_cvt_pk_bf16_f32 v103, v94, v95
buffer_store_dwordx4 v[100:103], v2, s[4:7], s35 offen offset:3072 sc1
s_cmp_ge_u32 s25, 64
s_cbranch_scc1 RU_done
s_waitcnt vmcnt(4)
ds_write_b128 v104, v[36:39] offset:0
ds_write_b128 v104, v[40:43] offset:1024
ds_write_b128 v104, v[44:47] offset:2048
ds_write_b128 v104, v[48:51] offset:3072
ds_write_b128 v104, v[52:55] offset:4096
ds_write_b128 v104, v[56:59] offset:5120
ds_write_b128 v104, v[60:63] offset:6144
v_xor_b32 v104, 0x8000, v104
s_waitcnt lgkmcnt(0)
s_barrier
s_cmp_lt_u32 s34, 5
s_cbranch_scc0 RU_lzy
s_waitcnt vmcnt(0)
s_barrier
s_cmp_lg_u32 s24, 0
s_cbranch_scc1 RU_sg0_s
s_lshl_b32 s46, s34, 7
s_add_u32 s46, s46, 75006080
v_mov_b32 v96, s46
v_mov_b32 v97, 1
s_mov_b64 exec, 1
buffer_atomic_add v97, v96, s[4:7], 0 offen
s_mov_b64 exec, -1
RU_sg0_s:
s_branch RU_loop
RU_lzy:
s_cmp_lt_u32 s34, 10
s_cbranch_scc1 RU_loop
s_sub_u32 s37, s34, 5
s_cmp_lg_u32 s24, 0
s_cbranch_scc1 RU_sg1_s
s_lshl_b32 s46, s37, 7
s_add_u32 s46, s46, 75006080
v_mov_b32 v96, s46
v_mov_b32 v97, 1
s_mov_b64 exec, 1
buffer_atomic_add v97, v96, s[4:7], 0 offen
s_mov_b64 exec, -1
RU_sg1_s:
s_branch RU_loop
RU_done:
s_waitcnt vmcnt(0)
s_barrier
s_sub_u32 s37, s34, 5
s_cmp_lg_u32 s24, 0
s_cbranch_scc1 RU_sg2_s
s_lshl_b32 s46, s37, 7
s_add_u32 s46, s46, 75006080
v_mov_b32 v96, s46
v_mov_b32 v97, 1
s_mov_b64 exec, 1
buffer_atomic_add v97, v96, s[4:7], 0 offen
s_mov_b64 exec, -1
RU_sg2_s:
s_cmp_lg_u32 s24, 0
s_cbranch_scc1 RU_sg3_s
s_lshl_b32 s46, s34, 7
s_add_u32 s46, s46, 75006080
v_mov_b32 v96, s46
v_mov_b32 v97, 1
s_mov_b64 exec, 1
buffer_atomic_add v97, v96, s[4:7], 0 offen
s_mov_b64 exec, -1
RU_sg3_s:
L_noU:
s_barrier
s_cmp_lt_u32 s22, 56
s_cbranch_scc1 L_W
s_cmp_lt_u32 s22, 84
s_cbranch_scc1 L_V
s_cmp_lt_u32 s22, 126
s_cbranch_scc1 L_F1
s_cmp_lt_u32 s22, 154
s_cbranch_scc1 L_F2
s_sub_u32 s22, s22, 154
v_lshlrev_b32 v4, 4, v0
v_mov_b32 v8, -1
v_mov_b32 v9, -1
v_mov_b32 v10, -1
v_mov_b32 v11, -1
s_mov_b32 s28, s22
RT_r0:
s_cmp_ge_u32 s28, 48
s_cbranch_scc1 RT_d0
s_lshl_b32 s29, s28, 12
s_add_u32 s29, s29, 64618496
buffer_store_dwordx4 v[8:11], v4, s[4:7], s29 offen sc1
s_add_u32 s28, s28, 6
s_branch RT_r0
RT_d0:
s_mov_b32 s28, s22
RT_r1:
s_cmp_ge_u32 s28, 224
s_cbranch_scc1 RT_d1
s_lshl_b32 s29, s28, 12
s_add_u32 s29, s29, 58916864
buffer_store_dwordx4 v[8:11], v4, s[4:7], s29 offen sc1
s_add_u32 s28, s28, 6
s_branch RT_r1
RT_d1:
s_mov_b32 s28, s22
RT_r2:
s_cmp_ge_u32 s28, 28
s_cbranch_scc1 RT_d2
s_lshl_b32 s29, s28, 12
s_add_u32 s29, s29, 66535424
buffer_store_dwordx4 v[8:11], v4, s[4:7], s29 offen sc1
s_add_u32 s28, s28, 6
s_branch RT_r2
RT_d2:
s_mov_b32 s28, s22
RT_r3:
s_cmp_ge_u32 s28, 8
s_cbranch_scc1 RT_d3
s_lshl_b32 s29, s28, 12
s_add_u32 s29, s29, 74481664
buffer_store_dwordx4 v[8:11], v4, s[4:7], s29 offen sc1
s_add_u32 s28, s28, 6
s_branch RT_r3
RT_d3:
s_mov_b32 s28, s22
RT_r4:
s_cmp_ge_u32 s28, 112
s_cbranch_scc1 RT_d4
s_lshl_b32 s29, s28, 12
s_add_u32 s29, s29, 73531392
buffer_store_dwordx4 v[8:11], v4, s[4:7], s29 offen sc1
s_add_u32 s28, s28, 6
s_branch RT_r4
RT_d4:
s_waitcnt vmcnt(0)
s_barrier
s_cmp_lg_u32 s24, 0
s_cbranch_scc1 RT_sig_s
v_mov_b32 v12, 75019520
v_mov_b32 v13, 1
s_mov_b64 exec, 1
buffer_atomic_add v13, v12, s[4:7], 0 offen
s_mov_b64 exec, -1
RT_sig_s:
s_branch L_exit
L_W:
s_lshl_b32 s64, s30, 9
v_lshrrev_b32 v84, 5, v1
v_lshlrev_b32 v80, 8, v84
v_and_b32 v84, 7, v1
v_lshl_add_u32 v80, v84, 4, v80
v_bfe_u32 v84, v1, 4, 1
v_lshl_add_u32 v80, v84, 3, v80
v_and_b32 v84, 8, v1
v_lshlrev_b32 v84, 26, v84
v_add_u32 v80, v80, v84
s_mov_b32 s25, s29
s_mov_b32 s45, 0
s_mov_b32 s43, 0
RW_loop:
s_cmp_lt_u32 s25, 56
s_cbranch_scc1 RW_tg_g
s_cmp_lg_u32 s43, 0
s_cbranch_scc1 RW_tg_g
s_mov_b32 s43, 1
s_cmp_lg_u32 s24, 0
s_cbranch_scc1 RW_tg_t_w
v_mov_b32 v84, 75019520
s_mov_b32 s47, 0
RW_tg_t_p:
buffer_load_dword v85, v84, s[4:7], 0 offen sc1
s_waitcnt vmcnt(0)
v_readfirstlane_b32 s46, v85
s_add_u32 s47, s47, 1
s_nop 1
s_cmp_ge_u32 s46, 6
s_cbranch_scc1 RW_tg_t_w
s_cmp_gt_u32 s47, 20000
s_cbranch_scc1 RW_tg_t_w
s_sleep 1
s_branch RW_tg_t_p
RW_tg_t_w:
s_barrier
RW_tg_g:
s_mul_i32 s31, s25, 7168
s_add_u32 s31, s31, 74514432
s_add_u32 s32, s31, 4096
s_mov_b32 s47, 0
RW_mp:
buffer_load_dwordx2 v[4:5], v80, s[4:7], s31 offen offset:0 sc1
buffer_load_dwordx2 v[6:7], v80, s[4:7], s31 offen offset:128 sc1
buffer_load_dwordx2 v[8:9], v80, s[4:7], s31 offen offset:512 sc1
buffer_load_dwordx2 v[10:11], v80, s[4:7], s31 offen offset:640 sc1
buffer_load_dwordx2 v[12:13], v80, s[4:7], s31 offen offset:1024 sc1
buffer_load_dwordx2 v[14:15], v80, s[4:7], s31 offen offset:1152 sc1
buffer_load_dwordx2 v[16:17], v80, s[4:7], s31 offen offset:1536 sc1
buffer_load_dwordx2 v[18:19], v80, s[4:7], s31 offen offset:1664 sc1
buffer_load_dwordx2 v[20:21], v80, s[4:7], s31 offen offset:2048 sc1
buffer_load_dwordx2 v[22:23], v80, s[4:7], s31 offen offset:2176 sc1
buffer_load_dwordx2 v[24:25], v80, s[4:7], s31 offen offset:2560 sc1
buffer_load_dwordx2 v[26:27], v80, s[4:7], s31 offen offset:2688 sc1
buffer_load_dwordx2 v[28:29], v80, s[4:7], s31 offen offset:3072 sc1
buffer_load_dwordx2 v[30:31], v80, s[4:7], s31 offen offset:3200 sc1
buffer_load_dwordx2 v[32:33], v80, s[4:7], s31 offen offset:3584 sc1
buffer_load_dwordx2 v[34:35], v80, s[4:7], s31 offen offset:3712 sc1
buffer_load_dwordx2 v[36:37], v80, s[4:7], s32 offen offset:0 sc1
buffer_load_dwordx2 v[38:39], v80, s[4:7], s32 offen offset:128 sc1
buffer_load_dwordx2 v[40:41], v80, s[4:7], s32 offen offset:512 sc1
buffer_load_dwordx2 v[42:43], v80, s[4:7], s32 offen offset:640 sc1
buffer_load_dwordx2 v[44:45], v80, s[4:7], s32 offen offset:1024 sc1
buffer_load_dwordx2 v[46:47], v80, s[4:7], s32 offen offset:1152 sc1
buffer_load_dwordx2 v[48:49], v80, s[4:7], s32 offen offset:1536 sc1
buffer_load_dwordx2 v[50:51], v80, s[4:7], s32 offen offset:1664 sc1
buffer_load_dwordx2 v[52:53], v80, s[4:7], s32 offen offset:2048 sc1
buffer_load_dwordx2 v[54:55], v80, s[4:7], s32 offen offset:2176 sc1
buffer_load_dwordx2 v[56:57], v80, s[4:7], s32 offen offset:2560 sc1
buffer_load_dwordx2 v[58:59], v80, s[4:7], s32 offen offset:2688 sc1
s_waitcnt vmcnt(0)
s_cmp_lg_u32 s47, 0
s_cbranch_scc1 RW_nosig
s_cmp_eq_u32 s45, 0
s_cbranch_scc1 RW_nosig
s_barrier
s_sub_u32 s44, s25, 2
s_cmp_lg_u32 s24, 0
s_cbranch_scc1 RW_lz_s
s_lshl_b32 s46, s44, 7
s_add_u32 s46, s46, 74981504
v_mov_b32 v92, s46
v_mov_b32 v93, 1
s_mov_b64 exec, 1
buffer_atomic_add v93, v92, s[4:7], 0 offen
s_mov_b64 exec, -1
RW_lz_s:
RW_nosig:
v_max3_u32 v84, v4, v5, v6
v_max3_u32 v84, v84, v7, v8
v_max3_u32 v84, v84, v9, v10
v_max3_u32 v84, v84, v11, v12
v_max3_u32 v84, v84, v13, v14
v_max3_u32 v84, v84, v15, v16
v_max3_u32 v84, v84, v17, v18
v_max3_u32 v84, v84, v19, v20
v_max3_u32 v84, v84, v21, v22
v_max3_u32 v84, v84, v23, v24
v_max3_u32 v84, v84, v25, v26
v_max3_u32 v84, v84, v27, v28
v_max3_u32 v84, v84, v29, v30
v_max3_u32 v84, v84, v31, v32
v_max3_u32 v84, v84, v33, v34
v_max3_u32 v84, v84, v35, v36
v_max3_u32 v84, v84, v37, v38
v_max3_u32 v84, v84, v39, v40
v_max3_u32 v84, v84, v41, v42
v_max3_u32 v84, v84, v43, v44
v_max3_u32 v84, v84, v45, v46
v_max3_u32 v84, v84, v47, v48
v_max3_u32 v84, v84, v49, v50
v_max3_u32 v84, v84, v51, v52
v_max3_u32 v84, v84, v53, v54
v_max3_u32 v84, v84, v55, v56
v_max3_u32 v84, v84, v57, v58
v_max_u32 v84, v84, v59
v_cmp_eq_u32 vcc, -1, v84
s_cbranch_vccz RW_mok
s_add_u32 s47, s47, 1
s_cmp_gt_u32 s47, 20000
s_cbranch_scc1 RW_mok
s_sleep 1
s_branch RW_mp
RW_mok:
v_swap_b32 v5, v6
v_swap_b32 v9, v10
v_swap_b32 v13, v14
v_swap_b32 v17, v18
v_swap_b32 v21, v22
v_swap_b32 v25, v26
v_swap_b32 v29, v30
v_swap_b32 v33, v34
v_swap_b32 v37, v38
v_swap_b32 v41, v42
v_swap_b32 v45, v46
v_swap_b32 v49, v50
v_swap_b32 v53, v54
v_swap_b32 v57, v58
s_nop 1
v_mfma_f32_16x16x32_bf16 v[64:67], v[4:7], a[0:3], 0
v_mfma_f32_16x16x32_bf16 v[68:71], v[4:7], a[56:59], 0
v_mfma_f32_16x16x32_bf16 v[72:75], v[4:7], a[112:115], 0
v_mfma_f32_16x16x32_bf16 v[76:79], v[4:7], a[168:171], 0
v_mfma_f32_16x16x32_bf16 v[64:67], v[8:11], a[4:7], v[64:67]
v_mfma_f32_16x16x32_bf16 v[68:71], v[8:11], a[60:63], v[68:71]
v_mfma_f32_16x16x32_bf16 v[72:75], v[8:11], a[116:119], v[72:75]
v_mfma_f32_16x16x32_bf16 v[76:79], v[8:11], a[172:175], v[76:79]
v_mfma_f32_16x16x32_bf16 v[64:67], v[12:15], a[8:11], v[64:67]
v_mfma_f32_16x16x32_bf16 v[68:71], v[12:15], a[64:67], v[68:71]
v_mfma_f32_16x16x32_bf16 v[72:75], v[12:15], a[120:123], v[72:75]
v_mfma_f32_16x16x32_bf16 v[76:79], v[12:15], a[176:179], v[76:79]
v_mfma_f32_16x16x32_bf16 v[64:67], v[16:19], a[12:15], v[64:67]
v_mfma_f32_16x16x32_bf16 v[68:71], v[16:19], a[68:71], v[68:71]
v_mfma_f32_16x16x32_bf16 v[72:75], v[16:19], a[124:127], v[72:75]
v_mfma_f32_16x16x32_bf16 v[76:79], v[16:19], a[180:183], v[76:79]
v_mfma_f32_16x16x32_bf16 v[64:67], v[20:23], a[16:19], v[64:67]
v_mfma_f32_16x16x32_bf16 v[68:71], v[20:23], a[72:75], v[68:71]
v_mfma_f32_16x16x32_bf16 v[72:75], v[20:23], a[128:131], v[72:75]
v_mfma_f32_16x16x32_bf16 v[76:79], v[20:23], a[184:187], v[76:79]
v_mfma_f32_16x16x32_bf16 v[64:67], v[24:27], a[20:23], v[64:67]
v_mfma_f32_16x16x32_bf16 v[68:71], v[24:27], a[76:79], v[68:71]
v_mfma_f32_16x16x32_bf16 v[72:75], v[24:27], a[132:135], v[72:75]
v_mfma_f32_16x16x32_bf16 v[76:79], v[24:27], a[188:191], v[76:79]
v_mfma_f32_16x16x32_bf16 v[64:67], v[28:31], a[24:27], v[64:67]
v_mfma_f32_16x16x32_bf16 v[68:71], v[28:31], a[80:83], v[68:71]
v_mfma_f32_16x16x32_bf16 v[72:75], v[28:31], a[136:139], v[72:75]
v_mfma_f32_16x16x32_bf16 v[76:79], v[28:31], a[192:195], v[76:79]
v_mfma_f32_16x16x32_bf16 v[64:67], v[32:35], a[28:31], v[64:67]
v_mfma_f32_16x16x32_bf16 v[68:71], v[32:35], a[84:87], v[68:71]
v_mfma_f32_16x16x32_bf16 v[72:75], v[32:35], a[140:143], v[72:75]
v_mfma_f32_16x16x32_bf16 v[76:79], v[32:35], a[196:199], v[76:79]
v_mfma_f32_16x16x32_bf16 v[64:67], v[36:39], a[32:35], v[64:67]
v_mfma_f32_16x16x32_bf16 v[68:71], v[36:39], a[88:91], v[68:71]
v_mfma_f32_16x16x32_bf16 v[72:75], v[36:39], a[144:147], v[72:75]
v_mfma_f32_16x16x32_bf16 v[76:79], v[36:39], a[200:203], v[76:79]
v_mfma_f32_16x16x32_bf16 v[64:67], v[40:43], a[36:39], v[64:67]
v_mfma_f32_16x16x32_bf16 v[68:71], v[40:43], a[92:95], v[68:71]
v_mfma_f32_16x16x32_bf16 v[72:75], v[40:43], a[148:151], v[72:75]
v_mfma_f32_16x16x32_bf16 v[76:79], v[40:43], a[204:207], v[76:79]
v_mfma_f32_16x16x32_bf16 v[64:67], v[44:47], a[40:43], v[64:67]
v_mfma_f32_16x16x32_bf16 v[68:71], v[44:47], a[96:99], v[68:71]
v_mfma_f32_16x16x32_bf16 v[72:75], v[44:47], a[152:155], v[72:75]
v_mfma_f32_16x16x32_bf16 v[76:79], v[44:47], a[208:211], v[76:79]
v_mfma_f32_16x16x32_bf16 v[64:67], v[48:51], a[44:47], v[64:67]
v_mfma_f32_16x16x32_bf16 v[68:71], v[48:51], a[100:103], v[68:71]
v_mfma_f32_16x16x32_bf16 v[72:75], v[48:51], a[156:159], v[72:75]
v_mfma_f32_16x16x32_bf16 v[76:79], v[48:51], a[212:215], v[76:79]
v_mfma_f32_16x16x32_bf16 v[64:67], v[52:55], a[48:51], v[64:67]
v_mfma_f32_16x16x32_bf16 v[68:71], v[52:55], a[104:107], v[68:71]
v_mfma_f32_16x16x32_bf16 v[72:75], v[52:55], a[160:163], v[72:75]
v_mfma_f32_16x16x32_bf16 v[76:79], v[52:55], a[216:219], v[76:79]
v_mfma_f32_16x16x32_bf16 v[64:67], v[56:59], a[52:55], v[64:67]
v_mfma_f32_16x16x32_bf16 v[68:71], v[56:59], a[108:111], v[68:71]
v_mfma_f32_16x16x32_bf16 v[72:75], v[56:59], a[164:167], v[72:75]
v_mfma_f32_16x16x32_bf16 v[76:79], v[56:59], a[220:223], v[76:79]
s_mul_i32 s31, s25, 229376
s_add_u32 s31, s31, 45154304
s_nop 7
s_add_u32 s32, s31, s64
v_cvt_pk_bf16_f32 v84, v64, v65
v_cvt_pk_bf16_f32 v85, v66, v67
v_min_u32 v84, 0xfffffffe, v84
v_min_u32 v85, 0xfffffffe, v85
v_cvt_pk_bf16_f32 v86, v68, v69
v_cvt_pk_bf16_f32 v87, v70, v71
v_min_u32 v86, 0xfffffffe, v86
v_min_u32 v87, 0xfffffffe, v87
buffer_store_dwordx4 v[84:87], v2, s[4:7], s32 offen offset:0 sc1
v_cvt_pk_bf16_f32 v88, v72, v73
v_cvt_pk_bf16_f32 v89, v74, v75
v_min_u32 v88, 0xfffffffe, v88
v_min_u32 v89, 0xfffffffe, v89
v_cvt_pk_bf16_f32 v90, v76, v77
v_cvt_pk_bf16_f32 v91, v78, v79
v_min_u32 v90, 0xfffffffe, v90
v_min_u32 v91, 0xfffffffe, v91
buffer_store_dwordx4 v[88:91], v2, s[4:7], s32 offen offset:1024 sc1
s_mov_b32 s45, 1
s_add_u32 s25, s25, 2
s_cmp_lt_u32 s25, 64
s_cbranch_scc1 RW_loop
s_sub_u32 s25, s25, 2
s_waitcnt vmcnt(0)
s_barrier
s_cmp_lg_u32 s24, 0
s_cbranch_scc1 RW_sig_s
s_lshl_b32 s46, s25, 7
s_add_u32 s46, s46, 74981504
v_mov_b32 v92, s46
v_mov_b32 v93, 1
s_mov_b64 exec, 1
buffer_atomic_add v93, v92, s[4:7], 0 offen
s_mov_b64 exec, -1
RW_sig_s:
s_branch L_exit
L_X:
s_and_b32 s28, s22, 15
s_lshr_b32 s25, s22, 4
s_cmp_lg_u32 s24, 0
s_cbranch_scc1 RX_wa_w
s_lshl_b32 s46, s28, 7
s_add_u32 s46, s46, 75015296
v_mov_b32 v4, s46
v_mov_b32 v5, 7
s_lshl_b32 s46, s28, 7
s_add_u32 s46, s46, 75019648
v_cmp_eq_u32 vcc, 16, v2
v_mov_b32 v6, s46
s_nop 0
v_cndmask_b32 v4, v4, v6, vcc
v_mov_b32 v6, 7
v_cndmask_b32 v5, v5, v6, vcc
s_mov_b32 s46, 75019392
v_cmp_eq_u32 vcc, 32, v2
v_mov_b32 v6, s46
s_nop 0
v_cndmask_b32 v4, v4, v6, vcc
v_mov_b32 v6, 256
v_cndmask_b32 v5, v5, v6, vcc
s_mov_b32 s47, 0
RX_wa_p:
buffer_load_dword v6, v4, s[4:7], 0 offen sc1
s_waitcnt vmcnt(0)
v_cmp_lt_u32 vcc, v6, v5
s_cbranch_vccz RX_wa_w
s_add_u32 s47, s47, 1
s_cmp_gt_u32 s47, 20000
s_cbranch_scc1 RX_wa_w
s_branch RX_wa_p
RX_wa_w:
s_barrier
s_mul_i32 s30, s28, 28
s_mul_i32 s31, s24, 7
s_add_u32 s30, s30, s31
s_mul_i32 s30, s30, 14336
s_add_u32 s30, s30, 0
buffer_load_dwordx4 a[0:3], v2, s[4:7], s30 offen offset:0 sc1
buffer_load_dwordx4 a[4:7], v2, s[4:7], s30 offen offset:1024 sc1
buffer_load_dwordx4 a[8:11], v2, s[4:7], s30 offen offset:2048 sc1
buffer_load_dwordx4 a[12:15], v2, s[4:7], s30 offen offset:3072 sc1
s_add_u32 s30, s30, 4096
buffer_load_dwordx4 a[16:19], v2, s[4:7], s30 offen offset:0 sc1
buffer_load_dwordx4 a[20:23], v2, s[4:7], s30 offen offset:1024 sc1
buffer_load_dwordx4 a[24:27], v2, s[4:7], s30 offen offset:2048 sc1
buffer_load_dwordx4 a[28:31], v2, s[4:7], s30 offen offset:3072 sc1
s_add_u32 s30, s30, 4096
buffer_load_dwordx4 a[32:35], v2, s[4:7], s30 offen offset:0 sc1
buffer_load_dwordx4 a[36:39], v2, s[4:7], s30 offen offset:1024 sc1
buffer_load_dwordx4 a[40:43], v2, s[4:7], s30 offen offset:2048 sc1
buffer_load_dwordx4 a[44:47], v2, s[4:7], s30 offen offset:3072 sc1
s_add_u32 s30, s30, 4096
buffer_load_dwordx4 a[48:51], v2, s[4:7], s30 offen offset:0 sc1
buffer_load_dwordx4 a[52:55], v2, s[4:7], s30 offen offset:1024 sc1
buffer_load_dwordx4 a[56:59], v2, s[4:7], s30 offen offset:2048 sc1
buffer_load_dwordx4 a[60:63], v2, s[4:7], s30 offen offset:3072 sc1
s_add_u32 s30, s30, 4096
buffer_load_dwordx4 a[64:67], v2, s[4:7], s30 offen offset:0 sc1
buffer_load_dwordx4 a[68:71], v2, s[4:7], s30 offen offset:1024 sc1
buffer_load_dwordx4 a[72:75], v2, s[4:7], s30 offen offset:2048 sc1
buffer_load_dwordx4 a[76:79], v2, s[4:7], s30 offen offset:3072 sc1
s_add_u32 s30, s30, 4096
buffer_load_dwordx4 a[80:83], v2, s[4:7], s30 offen offset:0 sc1
buffer_load_dwordx4 a[84:87], v2, s[4:7], s30 offen offset:1024 sc1
buffer_load_dwordx4 a[88:91], v2, s[4:7], s30 offen offset:2048 sc1
buffer_load_dwordx4 a[92:95], v2, s[4:7], s30 offen offset:3072 sc1
s_add_u32 s30, s30, 4096
buffer_load_dwordx4 a[96:99], v2, s[4:7], s30 offen offset:0 sc1
buffer_load_dwordx4 a[100:103], v2, s[4:7], s30 offen offset:1024 sc1
buffer_load_dwordx4 a[104:107], v2, s[4:7], s30 offen offset:2048 sc1
buffer_load_dwordx4 a[108:111], v2, s[4:7], s30 offen offset:3072 sc1
s_add_u32 s30, s30, 4096
buffer_load_dwordx4 a[112:115], v2, s[4:7], s30 offen offset:0 sc1
buffer_load_dwordx4 a[116:119], v2, s[4:7], s30 offen offset:1024 sc1
buffer_load_dwordx4 a[120:123], v2, s[4:7], s30 offen offset:2048 sc1
buffer_load_dwordx4 a[124:127], v2, s[4:7], s30 offen offset:3072 sc1
s_waitcnt vmcnt(16)
s_add_u32 s30, s30, 4096
buffer_load_dwordx4 a[128:131], v2, s[4:7], s30 offen offset:0 sc1
buffer_load_dwordx4 a[132:135], v2, s[4:7], s30 offen offset:1024 sc1
buffer_load_dwordx4 a[136:139], v2, s[4:7], s30 offen offset:2048 sc1
buffer_load_dwordx4 a[140:143], v2, s[4:7], s30 offen offset:3072 sc1
s_add_u32 s30, s30, 4096
buffer_load_dwordx4 a[144:147], v2, s[4:7], s30 offen offset:0 sc1
buffer_load_dwordx4 a[148:151], v2, s[4:7], s30 offen offset:1024 sc1
buffer_load_dwordx4 a[152:155], v2, s[4:7], s30 offen offset:2048 sc1
buffer_load_dwordx4 a[156:159], v2, s[4:7], s30 offen offset:3072 sc1
s_add_u32 s30, s30, 4096
buffer_load_dwordx4 a[160:163], v2, s[4:7], s30 offen offset:0 sc1
buffer_load_dwordx4 a[164:167], v2, s[4:7], s30 offen offset:1024 sc1
buffer_load_dwordx4 a[168:171], v2, s[4:7], s30 offen offset:2048 sc1
buffer_load_dwordx4 a[172:175], v2, s[4:7], s30 offen offset:3072 sc1
s_add_u32 s30, s30, 4096
buffer_load_dwordx4 a[176:179], v2, s[4:7], s30 offen offset:0 sc1
buffer_load_dwordx4 a[180:183], v2, s[4:7], s30 offen offset:1024 sc1
buffer_load_dwordx4 a[184:187], v2, s[4:7], s30 offen offset:2048 sc1
buffer_load_dwordx4 a[188:191], v2, s[4:7], s30 offen offset:3072 sc1
s_add_u32 s30, s30, 4096
buffer_load_dwordx4 a[192:195], v2, s[4:7], s30 offen offset:0 sc1
buffer_load_dwordx4 a[196:199], v2, s[4:7], s30 offen offset:1024 sc1
buffer_load_dwordx4 a[200:203], v2, s[4:7], s30 offen offset:2048 sc1
buffer_load_dwordx4 a[204:207], v2, s[4:7], s30 offen offset:3072 sc1
s_add_u32 s30, s30, 4096
buffer_load_dwordx4 a[208:211], v2, s[4:7], s30 offen offset:0 sc1
buffer_load_dwordx4 a[212:215], v2, s[4:7], s30 offen offset:1024 sc1
buffer_load_dwordx4 a[216:219], v2, s[4:7], s30 offen offset:2048 sc1
buffer_load_dwordx4 a[220:223], v2, s[4:7], s30 offen offset:3072 sc1
s_add_u32 s30, s30, 4096
buffer_load_dwordx4 a[224:227], v2, s[4:7], s30 offen offset:0 sc1
buffer_load_dwordx4 a[228:231], v2, s[4:7], s30 offen offset:1024 sc1
buffer_load_dwordx4 a[232:235], v2, s[4:7], s30 offen offset:2048 sc1
buffer_load_dwordx4 a[236:239], v2, s[4:7], s30 offen offset:3072 sc1
s_add_u32 s30, s30, 4096
buffer_load_dwordx4 a[240:243], v2, s[4:7], s30 offen offset:0 sc1
buffer_load_dwordx4 a[244:247], v2, s[4:7], s30 offen offset:1024 sc1
buffer_load_dwordx4 a[248:251], v2, s[4:7], s30 offen offset:2048 sc1
buffer_load_dwordx4 a[252:255], v2, s[4:7], s30 offen offset:3072 sc1
s_waitcnt vmcnt(16)
s_add_u32 s30, s30, 4096
buffer_load_dwordx4 v[120:123], v2, s[4:7], s30 offen offset:0 sc1
buffer_load_dwordx4 v[124:127], v2, s[4:7], s30 offen offset:1024 sc1
buffer_load_dwordx4 v[128:131], v2, s[4:7], s30 offen offset:2048 sc1
buffer_load_dwordx4 v[132:135], v2, s[4:7], s30 offen offset:3072 sc1
s_add_u32 s30, s30, 4096
buffer_load_dwordx4 v[136:139], v2, s[4:7], s30 offen offset:0 sc1
buffer_load_dwordx4 v[140:143], v2, s[4:7], s30 offen offset:1024 sc1
buffer_load_dwordx4 v[144:147], v2, s[4:7], s30 offen offset:2048 sc1
buffer_load_dwordx4 v[148:151], v2, s[4:7], s30 offen offset:3072 sc1
s_add_u32 s30, s30, 4096
buffer_load_dwordx4 v[152:155], v2, s[4:7], s30 offen offset:0 sc1
buffer_load_dwordx4 v[156:159], v2, s[4:7], s30 offen offset:1024 sc1
buffer_load_dwordx4 v[160:163], v2, s[4:7], s30 offen offset:2048 sc1
buffer_load_dwordx4 v[164:167], v2, s[4:7], s30 offen offset:3072 sc1
s_add_u32 s30, s30, 4096
buffer_load_dwordx4 v[168:171], v2, s[4:7], s30 offen offset:0 sc1
buffer_load_dwordx4 v[172:175], v2, s[4:7], s30 offen offset:1024 sc1
buffer_load_dwordx4 v[176:179], v2, s[4:7], s30 offen offset:2048 sc1
buffer_load_dwordx4 v[180:183], v2, s[4:7], s30 offen offset:3072 sc1
s_add_u32 s30, s30, 4096
buffer_load_dwordx4 v[184:187], v2, s[4:7], s30 offen offset:0 sc1
buffer_load_dwordx4 v[188:191], v2, s[4:7], s30 offen offset:1024 sc1
buffer_load_dwordx4 v[192:195], v2, s[4:7], s30 offen offset:2048 sc1
buffer_load_dwordx4 v[196:199], v2, s[4:7], s30 offen offset:3072 sc1
s_add_u32 s30, s30, 4096
buffer_load_dwordx4 v[200:203], v2, s[4:7], s30 offen offset:0 sc1
buffer_load_dwordx4 v[204:207], v2, s[4:7], s30 offen offset:1024 sc1
buffer_load_dwordx4 v[208:211], v2, s[4:7], s30 offen offset:2048 sc1
buffer_load_dwordx4 v[212:215], v2, s[4:7], s30 offen offset:3072 sc1
s_add_u32 s30, s30, 4096
buffer_load_dwordx4 v[216:219], v2, s[4:7], s30 offen offset:0 sc1
buffer_load_dwordx4 v[220:223], v2, s[4:7], s30 offen offset:1024 sc1
buffer_load_dwordx4 v[224:227], v2, s[4:7], s30 offen offset:2048 sc1
buffer_load_dwordx4 v[228:231], v2, s[4:7], s30 offen offset:3072 sc1
s_add_u32 s30, s30, 4096
buffer_load_dwordx4 v[232:235], v2, s[4:7], s30 offen offset:0 sc1
buffer_load_dwordx4 v[236:239], v2, s[4:7], s30 offen offset:1024 sc1
buffer_load_dwordx4 v[240:243], v2, s[4:7], s30 offen offset:2048 sc1
buffer_load_dwordx4 v[244:247], v2, s[4:7], s30 offen offset:3072 sc1
s_waitcnt vmcnt(16)
s_add_u32 s30, s30, 4096
buffer_load_dwordx4 v[248:251], v2, s[4:7], s30 offen offset:0 sc1
buffer_load_dwordx4 v[252:255], v2, s[4:7], s30 offen offset:1024 sc1
v_and_b32 v100, 15, v1
v_lshrrev_b32 v101, 4, v1
v_lshrrev_b32 v103, 3, v100
v_lshlrev_b32 v102, 4, v103
v_bfe_u32 v103, v100, 2, 1
v_lshl_add_u32 v102, v103, 2, v102
v_and_b32 v103, 1, v100
v_add_u32 v102, v102, v103
v_bfe_u32 v103, v100, 1, 1
v_lshl_add_u32 v102, v103, 3, v102
s_mul_i32 s30, s24, 3584
v_and_b32 v105, 1, v101
v_lshl_add_u32 v104, v105, 4, v100
v_lshlrev_b32 v104, 4, v104
v_lshrrev_b32 v103, 1, v101
v_lshl_add_u32 v104, v103, 2, v104
v_add_u32 v92, s30, v104
s_mul_i32 s30, s24, 1792
v_lshlrev_b32 v104, 7, v103
v_and_b32 v106, 7, v100
v_lshl_add_u32 v104, v106, 4, v104
v_lshl_add_u32 v104, v105, 3, v104
v_add_u32 v93, s30, v104
s_mul_i32 s30, s24, 6144
v_add_u32 v94, s30, v2
s_and_b32 s30, s24, 1
s_lshl_b32 s30, s30, 10
v_add_u32 v95, s30, v2
s_and_b32 s30, s24, 1
s_lshl_b32 s30, s30, 1
v_add_u32 v96, s30, v102
v_lshrrev_b32 v103, 1, v101
v_lshlrev_b32 v103, 4, v103
v_and_b32 v104, 1, v101
v_lshl_add_u32 v103, v104, 2, v103
v_add_u32 v104, 0, v103
v_cmp_le_u32 s[48:49], v104, v96
v_add_u32 v104, 1, v103
v_cmp_le_u32 s[50:51], v104, v96
v_add_u32 v104, 8, v103
v_cmp_le_u32 s[52:53], v104, v96
v_add_u32 v104, 9, v103
v_cmp_le_u32 s[54:55], v104, v96
v_add_u32 v104, 2, v103
v_cmp_le_u32 s[56:57], v104, v96
v_add_u32 v104, 3, v103
v_cmp_le_u32 s[58:59], v104, v96
v_add_u32 v104, 10, v103
v_cmp_le_u32 s[60:61], v104, v96
v_add_u32 v104, 11, v103
v_cmp_le_u32 s[62:63], v104, v96
s_waitcnt vmcnt(0)
s_mov_b32 s45, 0
s_mov_b32 s43, 0
RX_loop:
s_cmp_lt_u32 s25, 56
s_cbranch_scc1 RX_tg_g
s_cmp_lg_u32 s43, 0
s_cbranch_scc1 RX_tg_g
s_mov_b32 s43, 1
s_cmp_lg_u32 s24, 0
s_cbranch_scc1 RX_tg_t_w
v_mov_b32 v100, 75019520
s_mov_b32 s47, 0
RX_tg_t_p:
buffer_load_dword v101, v100, s[4:7], 0 offen sc1
s_waitcnt vmcnt(0)
v_readfirstlane_b32 s46, v101
s_add_u32 s47, s47, 1
s_nop 1
s_cmp_ge_u32 s46, 6
s_cbranch_scc1 RX_tg_t_w
s_cmp_gt_u32 s47, 20000
s_cbranch_scc1 RX_tg_t_w
s_sleep 1
s_branch RX_tg_t_p
RX_tg_t_w:
s_barrier
RX_tg_g:
s_mul_i32 s30, s25, 28672
s_add_u32 s30, s30, 59834368
s_mul_i32 s31, s25, 28672
s_add_u32 s31, s31, 42205184
s_mul_i32 s32, s25, 7168
s_add_u32 s32, s32, 74514432
s_add_u32 s33, s30, 0
buffer_load_dwordx4 v[4:7], v2, s[4:7], s33 offen sc1
s_add_u32 s33, s30, 14336
buffer_load_dwordx4 v[8:11], v2, s[4:7], s33 offen sc1
s_add_u32 s33, s30, 1024
buffer_load_dwordx4 v[12:15], v2, s[4:7], s33 offen sc1
s_add_u32 s33, s30, 15360
buffer_load_dwordx4 v[16:19], v2, s[4:7], s33 offen sc1
s_add_u32 s33, s30, 2048
buffer_load_dwordx4 v[20:23], v2, s[4:7], s33 offen sc1
s_add_u32 s33, s30, 16384
buffer_load_dwordx4 v[24:27], v2, s[4:7], s33 offen sc1
s_waitcnt vmcnt(4)
s_cmp_eq_u32 s45, 0
s_cbranch_scc1 RX_nolz
s_barrier
s_sub_u32 s44, s25, 4
s_cmp_lg_u32 s24, 0
s_cbranch_scc1 RX_lz_s
s_lshl_b32 s46, s44, 7
s_add_u32 s46, s46, 74973312
v_mov_b32 v100, s46
v_mov_b32 v101, 1
s_mov_b64 exec, 1
buffer_atomic_add v101, v100, s[4:7], 0 offen
s_mov_b64 exec, -1
RX_lz_s:
RX_nolz:
v_mfma_f32_16x16x32_bf16 v[36:39], a[0:3], v[4:7], 0
v_mfma_f32_16x16x32_bf16 v[40:43], a[0:3], v[8:11], 0
v_mfma_f32_16x16x32_bf16 v[44:47], a[56:59], v[4:7], 0
v_mfma_f32_16x16x32_bf16 v[48:51], a[56:59], v[8:11], 0
v_mfma_f32_16x16x32_bf16 v[52:55], a[112:115], v[4:7], 0
v_mfma_f32_16x16x32_bf16 v[56:59], a[112:115], v[8:11], 0
s_add_u32 s33, s30, 3072
buffer_load_dwordx4 v[28:31], v2, s[4:7], s33 offen sc1
s_add_u32 s33, s30, 17408
buffer_load_dwordx4 v[32:35], v2, s[4:7], s33 offen sc1
v_mfma_f32_16x16x32_bf16 v[60:63], a[168:171], v[4:7], 0
v_mfma_f32_16x16x32_bf16 v[64:67], a[168:171], v[8:11], 0
v_mfma_f32_16x16x32_bf16 v[68:71], a[224:227], v[4:7], 0
v_mfma_f32_16x16x32_bf16 v[72:75], a[224:227], v[8:11], 0
v_mfma_f32_16x16x32_bf16 v[76:79], v[144:147], v[4:7], 0
v_mfma_f32_16x16x32_bf16 v[80:83], v[144:147], v[8:11], 0
v_mfma_f32_16x16x32_bf16 v[84:87], v[200:203], v[4:7], 0
v_mfma_f32_16x16x32_bf16 v[88:91], v[200:203], v[8:11], 0
s_waitcnt vmcnt(4)
v_mfma_f32_16x16x32_bf16 v[36:39], a[4:7], v[12:15], v[36:39]
v_mfma_f32_16x16x32_bf16 v[40:43], a[4:7], v[16:19], v[40:43]
v_mfma_f32_16x16x32_bf16 v[44:47], a[60:63], v[12:15], v[44:47]
v_mfma_f32_16x16x32_bf16 v[48:51], a[60:63], v[16:19], v[48:51]
v_mfma_f32_16x16x32_bf16 v[52:55], a[116:119], v[12:15], v[52:55]
v_mfma_f32_16x16x32_bf16 v[56:59], a[116:119], v[16:19], v[56:59]
s_add_u32 s33, s30, 4096
buffer_load_dwordx4 v[4:7], v2, s[4:7], s33 offen sc1
s_add_u32 s33, s30, 18432
buffer_load_dwordx4 v[8:11], v2, s[4:7], s33 offen sc1
v_mfma_f32_16x16x32_bf16 v[60:63], a[172:175], v[12:15], v[60:63]
v_mfma_f32_16x16x32_bf16 v[64:67], a[172:175], v[16:19], v[64:67]
v_mfma_f32_16x16x32_bf16 v[68:71], a[228:231], v[12:15], v[68:71]
v_mfma_f32_16x16x32_bf16 v[72:75], a[228:231], v[16:19], v[72:75]
v_mfma_f32_16x16x32_bf16 v[76:79], v[148:151], v[12:15], v[76:79]
v_mfma_f32_16x16x32_bf16 v[80:83], v[148:151], v[16:19], v[80:83]
v_mfma_f32_16x16x32_bf16 v[84:87], v[204:207], v[12:15], v[84:87]
v_mfma_f32_16x16x32_bf16 v[88:91], v[204:207], v[16:19], v[88:91]
s_waitcnt vmcnt(4)
v_mfma_f32_16x16x32_bf16 v[36:39], a[8:11], v[20:23], v[36:39]
v_mfma_f32_16x16x32_bf16 v[40:43], a[8:11], v[24:27], v[40:43]
v_mfma_f32_16x16x32_bf16 v[44:47], a[64:67], v[20:23], v[44:47]
v_mfma_f32_16x16x32_bf16 v[48:51], a[64:67], v[24:27], v[48:51]
v_mfma_f32_16x16x32_bf16 v[52:55], a[120:123], v[20:23], v[52:55]
v_mfma_f32_16x16x32_bf16 v[56:59], a[120:123], v[24:27], v[56:59]
s_add_u32 s33, s30, 5120
buffer_load_dwordx4 v[12:15], v2, s[4:7], s33 offen sc1
s_add_u32 s33, s30, 19456
buffer_load_dwordx4 v[16:19], v2, s[4:7], s33 offen sc1
v_mfma_f32_16x16x32_bf16 v[60:63], a[176:179], v[20:23], v[60:63]
v_mfma_f32_16x16x32_bf16 v[64:67], a[176:179], v[24:27], v[64:67]
v_mfma_f32_16x16x32_bf16 v[68:71], a[232:235], v[20:23], v[68:71]
v_mfma_f32_16x16x32_bf16 v[72:75], a[232:235], v[24:27], v[72:75]
v_mfma_f32_16x16x32_bf16 v[76:79], v[152:155], v[20:23], v[76:79]
v_mfma_f32_16x16x32_bf16 v[80:83], v[152:155], v[24:27], v[80:83]
v_mfma_f32_16x16x32_bf16 v[84:87], v[208:211], v[20:23], v[84:87]
v_mfma_f32_16x16x32_bf16 v[88:91], v[208:211], v[24:27], v[88:91]
s_waitcnt vmcnt(4)
v_mfma_f32_16x16x32_bf16 v[36:39], a[12:15], v[28:31], v[36:39]
v_mfma_f32_16x16x32_bf16 v[40:43], a[12:15], v[32:35], v[40:43]
v_mfma_f32_16x16x32_bf16 v[44:47], a[68:71], v[28:31], v[44:47]
v_mfma_f32_16x16x32_bf16 v[48:51], a[68:71], v[32:35], v[48:51]
v_mfma_f32_16x16x32_bf16 v[52:55], a[124:127], v[28:31], v[52:55]
v_mfma_f32_16x16x32_bf16 v[56:59], a[124:127], v[32:35], v[56:59]
s_add_u32 s33, s30, 6144
buffer_load_dwordx4 v[20:23], v2, s[4:7], s33 offen sc1
s_add_u32 s33, s30, 20480
buffer_load_dwordx4 v[24:27], v2, s[4:7], s33 offen sc1
v_mfma_f32_16x16x32_bf16 v[60:63], a[180:183], v[28:31], v[60:63]
v_mfma_f32_16x16x32_bf16 v[64:67], a[180:183], v[32:35], v[64:67]
v_mfma_f32_16x16x32_bf16 v[68:71], a[236:239], v[28:31], v[68:71]
v_mfma_f32_16x16x32_bf16 v[72:75], a[236:239], v[32:35], v[72:75]
v_mfma_f32_16x16x32_bf16 v[76:79], v[156:159], v[28:31], v[76:79]
v_mfma_f32_16x16x32_bf16 v[80:83], v[156:159], v[32:35], v[80:83]
v_mfma_f32_16x16x32_bf16 v[84:87], v[212:215], v[28:31], v[84:87]
v_mfma_f32_16x16x32_bf16 v[88:91], v[212:215], v[32:35], v[88:91]
s_waitcnt vmcnt(4)
v_mfma_f32_16x16x32_bf16 v[36:39], a[16:19], v[4:7], v[36:39]
v_mfma_f32_16x16x32_bf16 v[40:43], a[16:19], v[8:11], v[40:43]
v_mfma_f32_16x16x32_bf16 v[44:47], a[72:75], v[4:7], v[44:47]
v_mfma_f32_16x16x32_bf16 v[48:51], a[72:75], v[8:11], v[48:51]
v_mfma_f32_16x16x32_bf16 v[52:55], a[128:131], v[4:7], v[52:55]
v_mfma_f32_16x16x32_bf16 v[56:59], a[128:131], v[8:11], v[56:59]
s_add_u32 s33, s30, 7168
buffer_load_dwordx4 v[28:31], v2, s[4:7], s33 offen sc1
s_add_u32 s33, s30, 21504
buffer_load_dwordx4 v[32:35], v2, s[4:7], s33 offen sc1
v_mfma_f32_16x16x32_bf16 v[60:63], a[184:187], v[4:7], v[60:63]
v_mfma_f32_16x16x32_bf16 v[64:67], a[184:187], v[8:11], v[64:67]
v_mfma_f32_16x16x32_bf16 v[68:71], a[240:243], v[4:7], v[68:71]
v_mfma_f32_16x16x32_bf16 v[72:75], a[240:243], v[8:11], v[72:75]
v_mfma_f32_16x16x32_bf16 v[76:79], v[160:163], v[4:7], v[76:79]
v_mfma_f32_16x16x32_bf16 v[80:83], v[160:163], v[8:11], v[80:83]
v_mfma_f32_16x16x32_bf16 v[84:87], v[216:219], v[4:7], v[84:87]
v_mfma_f32_16x16x32_bf16 v[88:91], v[216:219], v[8:11], v[88:91]
s_waitcnt vmcnt(4)
v_mfma_f32_16x16x32_bf16 v[36:39], a[20:23], v[12:15], v[36:39]
v_mfma_f32_16x16x32_bf16 v[40:43], a[20:23], v[16:19], v[40:43]
v_mfma_f32_16x16x32_bf16 v[44:47], a[76:79], v[12:15], v[44:47]
v_mfma_f32_16x16x32_bf16 v[48:51], a[76:79], v[16:19], v[48:51]
v_mfma_f32_16x16x32_bf16 v[52:55], a[132:135], v[12:15], v[52:55]
v_mfma_f32_16x16x32_bf16 v[56:59], a[132:135], v[16:19], v[56:59]
s_add_u32 s33, s30, 8192
buffer_load_dwordx4 v[4:7], v2, s[4:7], s33 offen sc1
s_add_u32 s33, s30, 22528
buffer_load_dwordx4 v[8:11], v2, s[4:7], s33 offen sc1
v_mfma_f32_16x16x32_bf16 v[60:63], a[188:191], v[12:15], v[60:63]
v_mfma_f32_16x16x32_bf16 v[64:67], a[188:191], v[16:19], v[64:67]
v_mfma_f32_16x16x32_bf16 v[68:71], a[244:247], v[12:15], v[68:71]
v_mfma_f32_16x16x32_bf16 v[72:75], a[244:247], v[16:19], v[72:75]
v_mfma_f32_16x16x32_bf16 v[76:79], v[164:167], v[12:15], v[76:79]
v_mfma_f32_16x16x32_bf16 v[80:83], v[164:167], v[16:19], v[80:83]
v_mfma_f32_16x16x32_bf16 v[84:87], v[220:223], v[12:15], v[84:87]
v_mfma_f32_16x16x32_bf16 v[88:91], v[220:223], v[16:19], v[88:91]
s_waitcnt vmcnt(4)
v_mfma_f32_16x16x32_bf16 v[36:39], a[24:27], v[20:23], v[36:39]
v_mfma_f32_16x16x32_bf16 v[40:43], a[24:27], v[24:27], v[40:43]
v_mfma_f32_16x16x32_bf16 v[44:47], a[80:83], v[20:23], v[44:47]
v_mfma_f32_16x16x32_bf16 v[48:51], a[80:83], v[24:27], v[48:51]
v_mfma_f32_16x16x32_bf16 v[52:55], a[136:139], v[20:23], v[52:55]
v_mfma_f32_16x16x32_bf16 v[56:59], a[136:139], v[24:27], v[56:59]
s_add_u32 s33, s30, 9216
buffer_load_dwordx4 v[12:15], v2, s[4:7], s33 offen sc1
s_add_u32 s33, s30, 23552
buffer_load_dwordx4 v[16:19], v2, s[4:7], s33 offen sc1
v_mfma_f32_16x16x32_bf16 v[60:63], a[192:195], v[20:23], v[60:63]
v_mfma_f32_16x16x32_bf16 v[64:67], a[192:195], v[24:27], v[64:67]
v_mfma_f32_16x16x32_bf16 v[68:71], a[248:251], v[20:23], v[68:71]
v_mfma_f32_16x16x32_bf16 v[72:75], a[248:251], v[24:27], v[72:75]
v_mfma_f32_16x16x32_bf16 v[76:79], v[168:171], v[20:23], v[76:79]
v_mfma_f32_16x16x32_bf16 v[80:83], v[168:171], v[24:27], v[80:83]
v_mfma_f32_16x16x32_bf16 v[84:87], v[224:227], v[20:23], v[84:87]
v_mfma_f32_16x16x32_bf16 v[88:91], v[224:227], v[24:27], v[88:91]
s_waitcnt vmcnt(4)
v_mfma_f32_16x16x32_bf16 v[36:39], a[28:31], v[28:31], v[36:39]
v_mfma_f32_16x16x32_bf16 v[40:43], a[28:31], v[32:35], v[40:43]
v_mfma_f32_16x16x32_bf16 v[44:47], a[84:87], v[28:31], v[44:47]
v_mfma_f32_16x16x32_bf16 v[48:51], a[84:87], v[32:35], v[48:51]
v_mfma_f32_16x16x32_bf16 v[52:55], a[140:143], v[28:31], v[52:55]
v_mfma_f32_16x16x32_bf16 v[56:59], a[140:143], v[32:35], v[56:59]
s_add_u32 s33, s30, 10240
buffer_load_dwordx4 v[20:23], v2, s[4:7], s33 offen sc1
s_add_u32 s33, s30, 24576
buffer_load_dwordx4 v[24:27], v2, s[4:7], s33 offen sc1
v_mfma_f32_16x16x32_bf16 v[60:63], a[196:199], v[28:31], v[60:63]
v_mfma_f32_16x16x32_bf16 v[64:67], a[196:199], v[32:35], v[64:67]
v_mfma_f32_16x16x32_bf16 v[68:71], a[252:255], v[28:31], v[68:71]
v_mfma_f32_16x16x32_bf16 v[72:75], a[252:255], v[32:35], v[72:75]
v_mfma_f32_16x16x32_bf16 v[76:79], v[172:175], v[28:31], v[76:79]
v_mfma_f32_16x16x32_bf16 v[80:83], v[172:175], v[32:35], v[80:83]
v_mfma_f32_16x16x32_bf16 v[84:87], v[228:231], v[28:31], v[84:87]
v_mfma_f32_16x16x32_bf16 v[88:91], v[228:231], v[32:35], v[88:91]
s_waitcnt vmcnt(4)
v_mfma_f32_16x16x32_bf16 v[36:39], a[32:35], v[4:7], v[36:39]
v_mfma_f32_16x16x32_bf16 v[40:43], a[32:35], v[8:11], v[40:43]
v_mfma_f32_16x16x32_bf16 v[44:47], a[88:91], v[4:7], v[44:47]
v_mfma_f32_16x16x32_bf16 v[48:51], a[88:91], v[8:11], v[48:51]
v_mfma_f32_16x16x32_bf16 v[52:55], a[144:147], v[4:7], v[52:55]
v_mfma_f32_16x16x32_bf16 v[56:59], a[144:147], v[8:11], v[56:59]
s_add_u32 s33, s30, 11264
buffer_load_dwordx4 v[28:31], v2, s[4:7], s33 offen sc1
s_add_u32 s33, s30, 25600
buffer_load_dwordx4 v[32:35], v2, s[4:7], s33 offen sc1
v_mfma_f32_16x16x32_bf16 v[60:63], a[200:203], v[4:7], v[60:63]
v_mfma_f32_16x16x32_bf16 v[64:67], a[200:203], v[8:11], v[64:67]
v_mfma_f32_16x16x32_bf16 v[68:71], v[120:123], v[4:7], v[68:71]
v_mfma_f32_16x16x32_bf16 v[72:75], v[120:123], v[8:11], v[72:75]
v_mfma_f32_16x16x32_bf16 v[76:79], v[176:179], v[4:7], v[76:79]
v_mfma_f32_16x16x32_bf16 v[80:83], v[176:179], v[8:11], v[80:83]
v_mfma_f32_16x16x32_bf16 v[84:87], v[232:235], v[4:7], v[84:87]
v_mfma_f32_16x16x32_bf16 v[88:91], v[232:235], v[8:11], v[88:91]
s_waitcnt vmcnt(4)
v_mfma_f32_16x16x32_bf16 v[36:39], a[36:39], v[12:15], v[36:39]
v_mfma_f32_16x16x32_bf16 v[40:43], a[36:39], v[16:19], v[40:43]
v_mfma_f32_16x16x32_bf16 v[44:47], a[92:95], v[12:15], v[44:47]
v_mfma_f32_16x16x32_bf16 v[48:51], a[92:95], v[16:19], v[48:51]
v_mfma_f32_16x16x32_bf16 v[52:55], a[148:151], v[12:15], v[52:55]
v_mfma_f32_16x16x32_bf16 v[56:59], a[148:151], v[16:19], v[56:59]
s_add_u32 s33, s30, 12288
buffer_load_dwordx4 v[4:7], v2, s[4:7], s33 offen sc1
s_add_u32 s33, s30, 26624
buffer_load_dwordx4 v[8:11], v2, s[4:7], s33 offen sc1
v_mfma_f32_16x16x32_bf16 v[60:63], a[204:207], v[12:15], v[60:63]
v_mfma_f32_16x16x32_bf16 v[64:67], a[204:207], v[16:19], v[64:67]
v_mfma_f32_16x16x32_bf16 v[68:71], v[124:127], v[12:15], v[68:71]
v_mfma_f32_16x16x32_bf16 v[72:75], v[124:127], v[16:19], v[72:75]
v_mfma_f32_16x16x32_bf16 v[76:79], v[180:183], v[12:15], v[76:79]
v_mfma_f32_16x16x32_bf16 v[80:83], v[180:183], v[16:19], v[80:83]
v_mfma_f32_16x16x32_bf16 v[84:87], v[236:239], v[12:15], v[84:87]
v_mfma_f32_16x16x32_bf16 v[88:91], v[236:239], v[16:19], v[88:91]
s_waitcnt vmcnt(4)
v_mfma_f32_16x16x32_bf16 v[36:39], a[40:43], v[20:23], v[36:39]
v_mfma_f32_16x16x32_bf16 v[40:43], a[40:43], v[24:27], v[40:43]
v_mfma_f32_16x16x32_bf16 v[44:47], a[96:99], v[20:23], v[44:47]
v_mfma_f32_16x16x32_bf16 v[48:51], a[96:99], v[24:27], v[48:51]
v_mfma_f32_16x16x32_bf16 v[52:55], a[152:155], v[20:23], v[52:55]
v_mfma_f32_16x16x32_bf16 v[56:59], a[152:155], v[24:27], v[56:59]
s_add_u32 s33, s30, 13312
buffer_load_dwordx4 v[12:15], v2, s[4:7], s33 offen sc1
s_add_u32 s33, s30, 27648
buffer_load_dwordx4 v[16:19], v2, s[4:7], s33 offen sc1
v_mfma_f32_16x16x32_bf16 v[60:63], a[208:211], v[20:23], v[60:63]
v_mfma_f32_16x16x32_bf16 v[64:67], a[208:211], v[24:27], v[64:67]
v_mfma_f32_16x16x32_bf16 v[68:71], v[128:131], v[20:23], v[68:71]
v_mfma_f32_16x16x32_bf16 v[72:75], v[128:131], v[24:27], v[72:75]
v_mfma_f32_16x16x32_bf16 v[76:79], v[184:187], v[20:23], v[76:79]
v_mfma_f32_16x16x32_bf16 v[80:83], v[184:187], v[24:27], v[80:83]
v_mfma_f32_16x16x32_bf16 v[84:87], v[240:243], v[20:23], v[84:87]
v_mfma_f32_16x16x32_bf16 v[88:91], v[240:243], v[24:27], v[88:91]
s_waitcnt vmcnt(4)
v_mfma_f32_16x16x32_bf16 v[36:39], a[44:47], v[28:31], v[36:39]
v_mfma_f32_16x16x32_bf16 v[40:43], a[44:47], v[32:35], v[40:43]
v_mfma_f32_16x16x32_bf16 v[44:47], a[100:103], v[28:31], v[44:47]
v_mfma_f32_16x16x32_bf16 v[48:51], a[100:103], v[32:35], v[48:51]
v_mfma_f32_16x16x32_bf16 v[52:55], a[156:159], v[28:31], v[52:55]
v_mfma_f32_16x16x32_bf16 v[56:59], a[156:159], v[32:35], v[56:59]
v_mfma_f32_16x16x32_bf16 v[60:63], a[212:215], v[28:31], v[60:63]
v_mfma_f32_16x16x32_bf16 v[64:67], a[212:215], v[32:35], v[64:67]
v_mfma_f32_16x16x32_bf16 v[68:71], v[132:135], v[28:31], v[68:71]
v_mfma_f32_16x16x32_bf16 v[72:75], v[132:135], v[32:35], v[72:75]
v_mfma_f32_16x16x32_bf16 v[76:79], v[188:191], v[28:31], v[76:79]
v_mfma_f32_16x16x32_bf16 v[80:83], v[188:191], v[32:35], v[80:83]
v_mfma_f32_16x16x32_bf16 v[84:87], v[244:247], v[28:31], v[84:87]
v_mfma_f32_16x16x32_bf16 v[88:91], v[244:247], v[32:35], v[88:91]
s_waitcnt vmcnt(2)
v_mfma_f32_16x16x32_bf16 v[36:39], a[48:51], v[4:7], v[36:39]
v_mfma_f32_16x16x32_bf16 v[40:43], a[48:51], v[8:11], v[40:43]
v_mfma_f32_16x16x32_bf16 v[44:47], a[104:107], v[4:7], v[44:47]
v_mfma_f32_16x16x32_bf16 v[48:51], a[104:107], v[8:11], v[48:51]
v_mfma_f32_16x16x32_bf16 v[52:55], a[160:163], v[4:7], v[52:55]
v_mfma_f32_16x16x32_bf16 v[56:59], a[160:163], v[8:11], v[56:59]
v_mfma_f32_16x16x32_bf16 v[60:63], a[216:219], v[4:7], v[60:63]
v_mfma_f32_16x16x32_bf16 v[64:67], a[216:219], v[8:11], v[64:67]
v_mfma_f32_16x16x32_bf16 v[68:71], v[136:139], v[4:7], v[68:71]
v_mfma_f32_16x16x32_bf16 v[72:75], v[136:139], v[8:11], v[72:75]
v_mfma_f32_16x16x32_bf16 v[76:79], v[192:195], v[4:7], v[76:79]
v_mfma_f32_16x16x32_bf16 v[80:83], v[192:195], v[8:11], v[80:83]
v_mfma_f32_16x16x32_bf16 v[84:87], v[248:251], v[4:7], v[84:87]
v_mfma_f32_16x16x32_bf16 v[88:91], v[248:251], v[8:11], v[88:91]
s_waitcnt vmcnt(0)
v_mfma_f32_16x16x32_bf16 v[36:39], a[52:55], v[12:15], v[36:39]
v_mfma_f32_16x16x32_bf16 v[40:43], a[52:55], v[16:19], v[40:43]
v_mfma_f32_16x16x32_bf16 v[44:47], a[108:111], v[12:15], v[44:47]
v_mfma_f32_16x16x32_bf16 v[48:51], a[108:111], v[16:19], v[48:51]
v_mfma_f32_16x16x32_bf16 v[52:55], a[164:167], v[12:15], v[52:55]
v_mfma_f32_16x16x32_bf16 v[56:59], a[164:167], v[16:19], v[56:59]
v_mfma_f32_16x16x32_bf16 v[60:63], a[220:223], v[12:15], v[60:63]
v_mfma_f32_16x16x32_bf16 v[64:67], a[220:223], v[16:19], v[64:67]
v_mfma_f32_16x16x32_bf16 v[68:71], v[140:143], v[12:15], v[68:71]
v_mfma_f32_16x16x32_bf16 v[72:75], v[140:143], v[16:19], v[72:75]
v_mfma_f32_16x16x32_bf16 v[76:79], v[196:199], v[12:15], v[76:79]
v_mfma_f32_16x16x32_bf16 v[80:83], v[196:199], v[16:19], v[80:83]
v_mfma_f32_16x16x32_bf16 v[84:87], v[252:255], v[12:15], v[84:87]
v_mfma_f32_16x16x32_bf16 v[88:91], v[252:255], v[16:19], v[88:91]
s_nop 7
v_cvt_pk_bf16_f32 v4, v36, v37
v_cvt_pk_bf16_f32 v5, v38, v39
v_cvt_pk_bf16_f32 v6, v44, v45
v_cvt_pk_bf16_f32 v7, v46, v47
v_cvt_pk_bf16_f32 v8, v52, v53
v_cvt_pk_bf16_f32 v9, v54, v55
v_cvt_pk_bf16_f32 v10, v60, v61
v_cvt_pk_bf16_f32 v11, v62, v63
v_cvt_pk_bf16_f32 v12, v68, v69
v_cvt_pk_bf16_f32 v13, v70, v71
v_cvt_pk_bf16_f32 v14, v76, v77
v_cvt_pk_bf16_f32 v15, v78, v79
v_cvt_pk_bf16_f32 v16, v84, v85
v_cvt_pk_bf16_f32 v17, v86, v87
v_cvt_pk_bf16_f32 v18, v40, v41
v_cvt_pk_bf16_f32 v19, v42, v43
v_cvt_pk_bf16_f32 v20, v48, v49
v_cvt_pk_bf16_f32 v21, v50, v51
v_cvt_pk_bf16_f32 v22, v56, v57
v_cvt_pk_bf16_f32 v23, v58, v59
v_cvt_pk_bf16_f32 v24, v64, v65
v_cvt_pk_bf16_f32 v25, v66, v67
v_cvt_pk_bf16_f32 v26, v72, v73
v_cvt_pk_bf16_f32 v27, v74, v75
v_cvt_pk_bf16_f32 v28, v80, v81
v_cvt_pk_bf16_f32 v29, v82, v83
v_cvt_pk_bf16_f32 v30, v88, v89
v_cvt_pk_bf16_f32 v31, v90, v91
s_add_u32 s33, s30, 0
buffer_load_dword v36, v92, s[4:7], s33 offen offset:0 sc1
buffer_load_dword v37, v92, s[4:7], s33 offen offset:8 sc1
buffer_load_dword v38, v92, s[4:7], s33 offen offset:512 sc1
buffer_load_dword v39, v92, s[4:7], s33 offen offset:520 sc1
s_add_u32 s33, s30, 14336
buffer_load_dword v40, v92, s[4:7], s33 offen offset:0 sc1
buffer_load_dword v41, v92, s[4:7], s33 offen offset:8 sc1
buffer_load_dword v42, v92, s[4:7], s33 offen offset:512 sc1
buffer_load_dword v43, v92, s[4:7], s33 offen offset:520 sc1
s_add_u32 s33, s30, 1024
buffer_load_dword v44, v92, s[4:7], s33 offen offset:0 sc1
buffer_load_dword v45, v92, s[4:7], s33 offen offset:8 sc1
buffer_load_dword v46, v92, s[4:7], s33 offen offset:512 sc1
buffer_load_dword v47, v92, s[4:7], s33 offen offset:520 sc1
s_add_u32 s33, s30, 15360
buffer_load_dword v48, v92, s[4:7], s33 offen offset:0 sc1
buffer_load_dword v49, v92, s[4:7], s33 offen offset:8 sc1
buffer_load_dword v50, v92, s[4:7], s33 offen offset:512 sc1
buffer_load_dword v51, v92, s[4:7], s33 offen offset:520 sc1
s_add_u32 s33, s30, 3072
buffer_load_dword v52, v92, s[4:7], s33 offen offset:0 sc1
buffer_load_dword v53, v92, s[4:7], s33 offen offset:8 sc1
s_add_u32 s33, s30, 17408
buffer_load_dword v54, v92, s[4:7], s33 offen offset:0 sc1
buffer_load_dword v55, v92, s[4:7], s33 offen offset:8 sc1
s_waitcnt vmcnt(12)
v_mfma_f32_16x16x32_bf16 v[68:71], v[36:39], v[4:7], 0
v_mfma_f32_16x16x32_bf16 v[72:75], v[36:39], v[18:21], 0
v_mfma_f32_16x16x32_bf16 v[76:79], v[40:43], v[4:7], 0
v_mfma_f32_16x16x32_bf16 v[80:83], v[40:43], v[18:21], 0
s_add_u32 s33, s30, 2048
buffer_load_dword v36, v92, s[4:7], s33 offen offset:0 sc1
buffer_load_dword v37, v92, s[4:7], s33 offen offset:8 sc1
buffer_load_dword v38, v92, s[4:7], s33 offen offset:512 sc1
buffer_load_dword v39, v92, s[4:7], s33 offen offset:520 sc1
s_add_u32 s33, s30, 16384
buffer_load_dword v40, v92, s[4:7], s33 offen offset:0 sc1
buffer_load_dword v41, v92, s[4:7], s33 offen offset:8 sc1
buffer_load_dword v42, v92, s[4:7], s33 offen offset:512 sc1
buffer_load_dword v43, v92, s[4:7], s33 offen offset:520 sc1
s_waitcnt vmcnt(12)
v_mfma_f32_16x16x32_bf16 v[68:71], v[44:47], v[8:11], v[68:71]
v_mfma_f32_16x16x32_bf16 v[72:75], v[44:47], v[22:25], v[72:75]
v_mfma_f32_16x16x32_bf16 v[76:79], v[48:51], v[8:11], v[76:79]
v_mfma_f32_16x16x32_bf16 v[80:83], v[48:51], v[22:25], v[80:83]
s_waitcnt vmcnt(0)
v_mfma_f32_16x16x32_bf16 v[68:71], v[36:39], v[12:15], v[68:71]
v_mfma_f32_16x16x32_bf16 v[72:75], v[36:39], v[26:29], v[72:75]
v_mfma_f32_16x16x32_bf16 v[76:79], v[40:43], v[12:15], v[76:79]
v_mfma_f32_16x16x32_bf16 v[80:83], v[40:43], v[26:29], v[80:83]
s_nop 5
v_mfma_f32_16x16x16_bf16 v[68:71], v[52:53], v[16:17], v[68:71]
v_mfma_f32_16x16x16_bf16 v[72:75], v[52:53], v[30:31], v[72:75]
v_mfma_f32_16x16x16_bf16 v[76:79], v[54:55], v[16:17], v[76:79]
v_mfma_f32_16x16x16_bf16 v[80:83], v[54:55], v[30:31], v[80:83]
s_mov_b32 s47, 0
RX_mp:
buffer_load_dwordx2 v[100:101], v93, s[4:7], s32 offen offset:0 sc1
buffer_load_dwordx2 v[102:103], v93, s[4:7], s32 offen offset:256 sc1
buffer_load_dwordx2 v[104:105], v93, s[4:7], s32 offen offset:512 sc1
buffer_load_dwordx2 v[106:107], v93, s[4:7], s32 offen offset:768 sc1
buffer_load_dwordx2 v[108:109], v93, s[4:7], s32 offen offset:1024 sc1
buffer_load_dwordx2 v[110:111], v93, s[4:7], s32 offen offset:1280 sc1
buffer_load_dwordx2 v[112:113], v93, s[4:7], s32 offen offset:1536 sc1
s_waitcnt vmcnt(0)
v_max3_u32 v114, v100, v101, v102
v_max3_u32 v114, v114, v103, v104
v_max3_u32 v114, v114, v105, v106
v_max3_u32 v114, v114, v107, v108
v_max3_u32 v114, v114, v109, v110
v_max3_u32 v114, v114, v111, v112
v_max_u32 v114, v114, v113
v_cmp_eq_u32 vcc, -1, v114
s_cbranch_vccz RX_mok
s_add_u32 s47, s47, 1
s_cmp_gt_u32 s47, 20000
s_cbranch_scc1 RX_mok
s_sleep 1
s_branch RX_mp
RX_mok:
v_mfma_f32_16x16x32_bf16 v[84:87], v[100:103], v[4:7], 0
v_mfma_f32_16x16x32_bf16 v[88:91], v[100:103], v[18:21], 0
v_mfma_f32_16x16x32_bf16 v[84:87], v[104:107], v[8:11], v[84:87]
v_mfma_f32_16x16x32_bf16 v[88:91], v[104:107], v[22:25], v[88:91]
v_mfma_f32_16x16x32_bf16 v[84:87], v[108:111], v[12:15], v[84:87]
v_mfma_f32_16x16x32_bf16 v[88:91], v[108:111], v[26:29], v[88:91]
s_nop 5
v_mfma_f32_16x16x16_bf16 v[84:87], v[112:113], v[16:17], v[84:87]
v_mfma_f32_16x16x16_bf16 v[88:91], v[112:113], v[30:31], v[88:91]
s_nop 7
ds_write_b128 v94, v[68:71] offset:0
ds_write_b128 v94, v[72:75] offset:1024
ds_write_b128 v94, v[76:79] offset:2048
ds_write_b128 v94, v[80:83] offset:3072
ds_write_b128 v94, v[84:87] offset:4096
ds_write_b128 v94, v[88:91] offset:5120
v_xor_b32 v94, 0x8000, v94
s_waitcnt lgkmcnt(0)
s_barrier
s_cmp_ge_u32 s24, 2
s_cbranch_scc1 RX_next
ds_read_b128 v[36:39], v95 offset:0
ds_read_b128 v[40:43], v95 offset:2048
ds_read_b128 v[44:47], v95 offset:4096
ds_read_b128 v[48:51], v95 offset:6144
ds_read_b128 v[52:55], v95 offset:8192
ds_read_b128 v[56:59], v95 offset:10240
ds_read_b128 v[60:63], v95 offset:12288
ds_read_b128 v[64:67], v95 offset:14336
ds_read_b128 v[68:71], v95 offset:16384
ds_read_b128 v[72:75], v95 offset:18432
ds_read_b128 v[76:79], v95 offset:20480
ds_read_b128 v[80:83], v95 offset:22528
s_waitcnt lgkmcnt(0)
v_add_f32 v36, v36, v48
v_add_f32 v60, v60, v72
v_add_f32 v37, v37, v49
v_add_f32 v61, v61, v73
v_add_f32 v38, v38, v50
v_add_f32 v62, v62, v74
v_add_f32 v39, v39, v51
v_add_f32 v63, v63, v75
v_add_f32 v40, v40, v52
v_add_f32 v64, v64, v76
v_add_f32 v41, v41, v53
v_add_f32 v65, v65, v77
v_add_f32 v42, v42, v54
v_add_f32 v66, v66, v78
v_add_f32 v43, v43, v55
v_add_f32 v67, v67, v79
v_add_f32 v44, v44, v56
v_add_f32 v68, v68, v80
v_add_f32 v45, v45, v57
v_add_f32 v69, v69, v81
v_add_f32 v46, v46, v58
v_add_f32 v70, v70, v82
v_add_f32 v47, v47, v59
v_add_f32 v71, v71, v83
v_add_f32 v36, v36, v60
v_add_f32 v37, v37, v61
v_add_f32 v38, v38, v62
v_add_f32 v39, v39, v63
v_add_f32 v40, v40, v64
v_add_f32 v41, v41, v65
v_add_f32 v42, v42, v66
v_add_f32 v43, v43, v67
v_add_f32 v44, v44, v68
v_add_f32 v45, v45, v69
v_add_f32 v46, v46, v70
v_add_f32 v47, v47, v71
v_mov_b32 v100, 0xff800000
v_cndmask_b32 v36, v100, v36, s[48:49]
v_cndmask_b32 v37, v100, v37, s[50:51]
v_cndmask_b32 v38, v100, v38, s[52:53]
v_cndmask_b32 v39, v100, v39, s[54:55]
v_cndmask_b32 v40, v100, v40, s[56:57]
v_cndmask_b32 v41, v100, v41, s[58:59]
v_cndmask_b32 v42, v100, v42, s[60:61]
v_cndmask_b32 v43, v100, v43, s[62:63]
v_max3_f32 v101, v36, v37, v38
v_max3_f32 v101, v101, v39, v40
v_max3_f32 v101, v101, v41, v42
v_max3_f32 v101, v101, v43, v44
v_max3_f32 v101, v101, v45, v46
v_max_f32 v101, v101, v47
v_mov_b32 v103, v101
s_nop 1
v_permlane16_swap_b32 v101, v103
v_max_f32 v101, v101, v103
v_mov_b32 v103, v101
s_nop 1
v_permlane32_swap_b32 v101, v103
v_max_f32 v101, v101, v103
v_sub_f32 v36, v36, v101
v_sub_f32 v37, v37, v101
v_sub_f32 v38, v38, v101
v_sub_f32 v39, v39, v101
v_sub_f32 v40, v40, v101
v_sub_f32 v41, v41, v101
v_sub_f32 v42, v42, v101
v_sub_f32 v43, v43, v101
v_sub_f32 v44, v44, v101
v_sub_f32 v45, v45, v101
v_sub_f32 v46, v46, v101
v_sub_f32 v47, v47, v101
v_exp_f32 v36, v36
v_exp_f32 v37, v37
v_exp_f32 v38, v38
v_exp_f32 v39, v39
v_exp_f32 v40, v40
v_exp_f32 v41, v41
v_exp_f32 v42, v42
v_exp_f32 v43, v43
v_exp_f32 v44, v44
v_exp_f32 v45, v45
v_exp_f32 v46, v46
v_exp_f32 v47, v47
s_nop 0
v_add_f32 v102, v44, v45
v_add_f32 v103, v46, v47
v_add_f32 v102, v102, v103
v_mov_b32 v103, 0
v_cmp_gt_u32 vcc, 32, v1
s_nop 1
v_cndmask_b32 v102, v103, v102, vcc
v_add_f32 v102, v102, v36
v_add_f32 v102, v102, v37
v_add_f32 v102, v102, v38
v_add_f32 v102, v102, v39
v_add_f32 v102, v102, v40
v_add_f32 v102, v102, v41
v_add_f32 v102, v102, v42
v_add_f32 v102, v102, v43
v_mov_b32 v103, v102
s_nop 1
v_permlane16_swap_b32 v102, v103
v_add_f32 v102, v102, v103
v_mov_b32 v103, v102
s_nop 1
v_permlane32_swap_b32 v102, v103
v_add_f32 v102, v102, v103
v_rcp_f32 v102, v102
s_nop 0
v_mul_f32 v36, v36, v102
v_mul_f32 v37, v37, v102
v_mul_f32 v38, v38, v102
v_mul_f32 v39, v39, v102
v_mul_f32 v40, v40, v102
v_mul_f32 v41, v41, v102
v_mul_f32 v42, v42, v102
v_mul_f32 v43, v43, v102
v_mul_f32 v44, v44, v102
v_mul_f32 v45, v45, v102
v_mul_f32 v46, v46, v102
v_mul_f32 v47, v47, v102
v_cvt_pk_bf16_f32 v48, |v36|, |v37|
v_cvt_pk_bf16_f32 v49, |v38|, |v39|
v_cvt_pk_bf16_f32 v50, |v40|, |v41|
v_cvt_pk_bf16_f32 v51, |v42|, |v43|
v_cvt_pk_bf16_f32 v52, |v44|, |v45|
v_cvt_pk_bf16_f32 v53, |v46|, |v47|
s_mul_i32 s33, s25, 49152
s_add_u32 s33, s33, 61669376
s_lshl_b32 s34, s28, 1
s_add_u32 s34, s34, s24
s_lshl_b32 s34, s34, 10
s_add_u32 s34, s34, s33
buffer_store_dwordx4 v[48:51], v2, s[4:7], s34 offen sc1
s_lshl_b32 s34, s28, 1
s_add_u32 s34, s34, s24
s_lshl_b32 s34, s34, 9
s_add_u32 s34, s34, s33
s_add_u32 s34, s34, 32768
v_lshrrev_b32 v103, 1, v2
buffer_store_dwordx2 v[52:53], v103, s[4:7], s34 offen sc1
RX_next:
v_xor_b32 v95, 0x8000, v95
s_mov_b32 s45, 1
s_add_u32 s25, s25, 4
s_cmp_lt_u32 s25, 64
s_cbranch_scc1 RX_loop
s_sub_u32 s25, s25, 4
s_waitcnt vmcnt(0)
s_barrier
s_cmp_lg_u32 s24, 0
s_cbranch_scc1 RX_sig_s
s_lshl_b32 s46, s25, 7
s_add_u32 s46, s46, 74973312
v_mov_b32 v100, s46
v_mov_b32 v101, 1
s_mov_b64 exec, 1
buffer_atomic_add v101, v100, s[4:7], 0 offen
s_mov_b64 exec, -1
RX_sig_s:
s_branch L_exit
L_V:
s_sub_u32 s22, s22, 56
s_load_dwordx2 s[8:9], s[0:1], 0
s_mul_i32 s25, s22, 4682
s_lshr_b32 s25, s25, 16
s_mul_i32 s28, s25, 14
s_sub_u32 s28, s22, s28
s_waitcnt lgkmcnt(0)
s_and_b32 s9, s9, 0xffff
s_mov_b32 s10, 1835008
s_mov_b32 s11, 0x20000
s_mov_b32 s43, 0
s_mov_b32 s45, 0
RV_loop:
s_cmp_lg_u32 s24, 0
s_cbranch_scc1 RV_wm_d
s_lshl_b32 s46, s25, 7
v_mov_b32 v4, 74973312
v_mov_b32 v5, 16
v_cmp_eq_u32 vcc, 16, v2
v_mov_b32 v6, 74981504
s_nop 0
v_cndmask_b32 v4, v4, v6, vcc
v_mov_b32 v6, 28
v_cndmask_b32 v5, v5, v6, vcc
v_cmp_eq_u32 vcc, 32, v2
v_mov_b32 v6, 75006080
s_nop 0
v_cndmask_b32 v4, v4, v6, vcc
v_mov_b32 v6, 28
v_cndmask_b32 v5, v5, v6, vcc
v_add_u32 v4, s46, v4
buffer_load_dword v6, v4, s[4:7], 0 offen sc1
RV_wm_d:
s_waitcnt vmcnt(0)
s_barrier
s_cmp_lg_u32 s24, 0
s_cbranch_scc1 RV_wm_w
s_cmp_eq_u32 s45, 0
s_cbranch_scc1 RV_wm_c
s_sub_u32 s44, s25, 2
s_lshl_b32 s44, s44, 7
s_add_u32 s44, s44, 74989696
v_mov_b32 v7, s44
v_mov_b32 v8, 1
s_mov_b64 exec, 1
buffer_atomic_add v8, v7, s[4:7], 0 offen
s_mov_b64 exec, -1
RV_wm_c:
s_cmp_ge_u32 s25, 60
s_cbranch_scc1 RV_wm_w
s_mov_b32 s47, 0
RV_wm_p:
v_cmp_lt_u32 vcc, v6, v5
s_cbranch_vccz RV_wm_w
s_add_u32 s47, s47, 1
s_cmp_gt_u32 s47, 20000
s_cbranch_scc1 RV_wm_w
s_sleep 1
buffer_load_dword v6, v4, s[4:7], 0 offen sc1
s_waitcnt vmcnt(0)
s_branch RV_wm_p
RV_wm_w:
s_barrier
s_cmp_lt_u32 s25, 56
s_cbranch_scc1 RV_tg_g
s_cmp_lg_u32 s43, 0
s_cbranch_scc1 RV_tg_g
s_mov_b32 s43, 1
s_cmp_lg_u32 s24, 0
s_cbranch_scc1 RV_tg_t_w
v_mov_b32 v4, 75019520
s_mov_b32 s47, 0
RV_tg_t_p:
buffer_load_dword v5, v4, s[4:7], 0 offen sc1
s_waitcnt vmcnt(0)
v_readfirstlane_b32 s46, v5
s_add_u32 s47, s47, 1
s_nop 1
s_cmp_ge_u32 s46, 6
s_cbranch_scc1 RV_tg_t_w
s_cmp_gt_u32 s47, 20000
s_cbranch_scc1 RV_tg_t_w
s_sleep 1
s_branch RV_tg_t_p
RV_tg_t_w:
s_barrier
s_mov_b32 s42, 0
s_cmp_lg_u32 s24, 0
s_cbranch_scc1 RV_tg_u_w
s_lshl_b32 s46, s42, 7
v_mov_b32 v4, 75013760
v_mov_b32 v5, 28
v_cmp_eq_u32 vcc, 16, v2
v_mov_b32 v6, 75013888
s_nop 0
v_cndmask_b32 v4, v4, v6, vcc
v_mov_b32 v6, 28
v_cndmask_b32 v5, v5, v6, vcc
v_cmp_eq_u32 vcc, 32, v2
v_mov_b32 v6, 75014016
s_nop 0
v_cndmask_b32 v4, v4, v6, vcc
v_mov_b32 v6, 28
v_cndmask_b32 v5, v5, v6, vcc
v_cmp_eq_u32 vcc, 48, v2
v_mov_b32 v6, 75014144
s_nop 0
v_cndmask_b32 v4, v4, v6, vcc
v_mov_b32 v6, 28
v_cndmask_b32 v5, v5, v6, vcc
v_add_u32 v4, s46, v4
s_mov_b32 s47, 0
RV_tg_u_p:
buffer_load_dword v6, v4, s[4:7], 0 offen sc1
s_waitcnt vmcnt(0)
v_cmp_lt_u32 vcc, v6, v5
s_cbranch_vccz RV_tg_u_w
s_add_u32 s47, s47, 1
s_cmp_gt_u32 s47, 20000
s_cbranch_scc1 RV_tg_u_w
s_sleep 1
s_branch RV_tg_u_p
RV_tg_u_w:
s_barrier
RV_tg_g:
v_lshrrev_b32 v124, 1, v2
s_mul_i32 s29, s25, 458752
s_lshl_b32 s30, s24, 2
s_mul_i32 s30, s30, 28
s_lshl_b32 s31, s28, 1
s_add_u32 s30, s30, s31
s_lshl_b32 s30, s30, 10
s_add_u32 s29, s29, s30
s_add_u32 s29, s29, 12845056
s_add_u32 s30, s29, 0
buffer_load_dwordx4 v[4:7], v2, s[4:7], s30 offen offset:0 sc1
buffer_load_dwordx4 v[8:11], v2, s[4:7], s30 offen offset:1024 sc1
s_add_u32 s30, s29, 28672
buffer_load_dwordx4 v[12:15], v2, s[4:7], s30 offen offset:0 sc1
buffer_load_dwordx4 v[16:19], v2, s[4:7], s30 offen offset:1024 sc1
s_add_u32 s30, s29, 57344
buffer_load_dwordx4 v[20:23], v2, s[4:7], s30 offen offset:0 sc1
buffer_load_dwordx4 v[24:27], v2, s[4:7], s30 offen offset:1024 sc1
s_add_u32 s30, s29, 86016
buffer_load_dwordx4 v[28:31], v2, s[4:7], s30 offen offset:0 sc1
buffer_load_dwordx4 v[32:35], v2, s[4:7], s30 offen offset:1024 sc1
s_mul_i32 s29, s25, 229376
s_lshl_b32 s30, s24, 2
s_mul_i32 s30, s30, 14
s_add_u32 s30, s30, s28
s_lshl_b32 s30, s30, 10
s_add_u32 s29, s29, s30
s_add_u32 s29, s29, 45154304
s_add_u32 s30, s29, 0
buffer_load_dwordx4 v[36:39], v2, s[4:7], s30 offen sc1
s_add_u32 s30, s29, 14336
buffer_load_dwordx4 v[40:43], v2, s[4:7], s30 offen sc1
s_add_u32 s30, s29, 28672
buffer_load_dwordx4 v[44:47], v2, s[4:7], s30 offen sc1
s_add_u32 s30, s29, 43008
buffer_load_dwordx4 v[48:51], v2, s[4:7], s30 offen sc1
s_mul_i32 s29, s25, 49152
s_add_u32 s29, s29, 61669376
s_lshl_b32 s30, s24, 13
s_add_u32 s30, s30, s29
s_add_u32 s31, s30, 4096
buffer_load_dwordx4 v[52:55], v2, s[4:7], s30 offen offset:0 sc1
buffer_load_dwordx4 v[56:59], v2, s[4:7], s30 offen offset:1024 sc1
buffer_load_dwordx4 v[60:63], v2, s[4:7], s30 offen offset:2048 sc1
buffer_load_dwordx4 v[64:67], v2, s[4:7], s30 offen offset:3072 sc1
buffer_load_dwordx4 v[68:71], v2, s[4:7], s31 offen offset:0 sc1
buffer_load_dwordx4 v[72:75], v2, s[4:7], s31 offen offset:1024 sc1
buffer_load_dwordx4 v[76:79], v2, s[4:7], s31 offen offset:2048 sc1
buffer_load_dwordx4 v[80:83], v2, s[4:7], s31 offen offset:3072 sc1
s_lshl_b32 s30, s24, 12
s_add_u32 s30, s30, s29
s_add_u32 s30, s30, 32768
buffer_load_dwordx2 v[84:85], v124, s[4:7], s30 offen offset:0 sc1
buffer_load_dwordx2 v[86:87], v124, s[4:7], s30 offen offset:512 sc1
buffer_load_dwordx2 v[88:89], v124, s[4:7], s30 offen offset:1024 sc1
buffer_load_dwordx2 v[90:91], v124, s[4:7], s30 offen offset:1536 sc1
buffer_load_dwordx2 v[92:93], v124, s[4:7], s30 offen offset:2048 sc1
buffer_load_dwordx2 v[94:95], v124, s[4:7], s30 offen offset:2560 sc1
buffer_load_dwordx2 v[96:97], v124, s[4:7], s30 offen offset:3072 sc1
buffer_load_dwordx2 v[98:99], v124, s[4:7], s30 offen offset:3584 sc1
v_and_b32 v120, 15, v1
v_lshrrev_b32 v121, 3, v120
v_lshlrev_b32 v116, 4, v121
v_bfe_u32 v121, v120, 2, 1
v_lshl_add_u32 v116, v121, 2, v116
v_and_b32 v121, 1, v120
v_add_u32 v116, v116, v121
v_bfe_u32 v121, v120, 1, 1
v_lshl_add_u32 v116, v121, 3, v116
s_and_b32 s32, s24, 1
s_lshl_b32 s32, s32, 1
v_add_u32 v116, s32, v116
s_lshr_b32 s33, s24, 1
s_lshl_b32 s34, s28, 1
s_add_u32 s34, s34, s33
v_lshrrev_b32 v120, 4, v1
v_mul_u32_u24 v117, 896, v116
v_lshl_add_u32 v117, v120, 3, v117
s_lshl_b32 s35, s34, 5
s_mul_i32 s36, s25, 28672
s_add_u32 s35, s35, s36
buffer_load_dwordx2 v[122:123], v117, s[8:11], s35 offen
v_lshrrev_b32 v121, 1, v120
v_lshlrev_b32 v118, 9, v121
v_lshl_add_u32 v118, v116, 4, v118
v_and_b32 v121, 1, v120
v_lshl_add_u32 v118, v121, 3, v118
s_cmp_lt_u32 s25, 60
s_cbranch_scc1 RV_go
s_mov_b32 s47, 0
RV_chk:
s_waitcnt vmcnt(0)
v_or_b32 v100, v52, v53
v_or3_b32 v100, v100, v54, v55
v_or3_b32 v100, v100, v56, v57
v_or3_b32 v100, v100, v58, v59
v_or3_b32 v100, v100, v60, v61
v_or3_b32 v100, v100, v62, v63
v_or3_b32 v100, v100, v64, v65
v_or3_b32 v100, v100, v66, v67
v_or3_b32 v100, v100, v68, v69
v_or3_b32 v100, v100, v70, v71
v_or3_b32 v100, v100, v72, v73
v_or3_b32 v100, v100, v74, v75
v_or3_b32 v100, v100, v76, v77
v_or3_b32 v100, v100, v78, v79
v_or3_b32 v100, v100, v80, v81
v_or3_b32 v100, v100, v82, v83
v_or3_b32 v100, v100, v84, v85
v_or3_b32 v100, v100, v86, v87
v_or3_b32 v100, v100, v88, v89
v_or3_b32 v100, v100, v90, v91
v_or3_b32 v100, v100, v92, v93
v_or3_b32 v100, v100, v94, v95
v_or3_b32 v100, v100, v96, v97
v_or3_b32 v100, v100, v98, v99
v_and_b32 v100, 0x80008000, v100
v_max_u32 v101, v36, v37
v_max3_u32 v101, v101, v38, v39
v_max3_u32 v101, v101, v40, v41
v_max3_u32 v101, v101, v42, v43
v_max3_u32 v101, v101, v44, v45
v_max3_u32 v101, v101, v46, v47
v_max3_u32 v101, v101, v48, v49
v_max3_u32 v101, v101, v50, v51
v_cmp_ne_u32 vcc, 0, v100
v_cmp_eq_u32 s[40:41], -1, v101
s_nop 1
s_or_b64 vcc, vcc, s[40:41]
s_cbranch_vccz RV_go
s_add_u32 s47, s47, 1
s_cmp_gt_u32 s47, 20000
s_cbranch_scc1 RV_go
s_mul_i32 s29, s25, 229376
s_lshl_b32 s30, s24, 2
s_mul_i32 s30, s30, 14
s_add_u32 s30, s30, s28
s_lshl_b32 s30, s30, 10
s_add_u32 s29, s29, s30
s_add_u32 s29, s29, 45154304
s_add_u32 s30, s29, 0
buffer_load_dwordx4 v[36:39], v2, s[4:7], s30 offen sc1
s_add_u32 s30, s29, 14336
buffer_load_dwordx4 v[40:43], v2, s[4:7], s30 offen sc1
s_add_u32 s30, s29, 28672
buffer_load_dwordx4 v[44:47], v2, s[4:7], s30 offen sc1
s_add_u32 s30, s29, 43008
buffer_load_dwordx4 v[48:51], v2, s[4:7], s30 offen sc1
s_mul_i32 s29, s25, 49152
s_add_u32 s29, s29, 61669376
s_lshl_b32 s30, s24, 13
s_add_u32 s30, s30, s29
s_add_u32 s31, s30, 4096
buffer_load_dwordx4 v[52:55], v2, s[4:7], s30 offen offset:0 sc1
buffer_load_dwordx4 v[56:59], v2, s[4:7], s30 offen offset:1024 sc1
buffer_load_dwordx4 v[60:63], v2, s[4:7], s30 offen offset:2048 sc1
buffer_load_dwordx4 v[64:67], v2, s[4:7], s30 offen offset:3072 sc1
buffer_load_dwordx4 v[68:71], v2, s[4:7], s31 offen offset:0 sc1
buffer_load_dwordx4 v[72:75], v2, s[4:7], s31 offen offset:1024 sc1
buffer_load_dwordx4 v[76:79], v2, s[4:7], s31 offen offset:2048 sc1
buffer_load_dwordx4 v[80:83], v2, s[4:7], s31 offen offset:3072 sc1
s_lshl_b32 s30, s24, 12
s_add_u32 s30, s30, s29
s_add_u32 s30, s30, 32768
buffer_load_dwordx2 v[84:85], v124, s[4:7], s30 offen offset:0 sc1
buffer_load_dwordx2 v[86:87], v124, s[4:7], s30 offen offset:512 sc1
buffer_load_dwordx2 v[88:89], v124, s[4:7], s30 offen offset:1024 sc1
buffer_load_dwordx2 v[90:91], v124, s[4:7], s30 offen offset:1536 sc1
buffer_load_dwordx2 v[92:93], v124, s[4:7], s30 offen offset:2048 sc1
buffer_load_dwordx2 v[94:95], v124, s[4:7], s30 offen offset:2560 sc1
buffer_load_dwordx2 v[96:97], v124, s[4:7], s30 offen offset:3072 sc1
buffer_load_dwordx2 v[98:99], v124, s[4:7], s30 offen offset:3584 sc1
s_branch RV_chk
RV_go:
s_waitcnt vmcnt(1)
v_mfma_f32_16x16x32_bf16 v[100:103], v[4:7], v[52:55], 0
v_mfma_f32_16x16x32_bf16 v[100:103], v[12:15], v[60:63], v[100:103]
v_mfma_f32_16x16x32_bf16 v[100:103], v[20:23], v[68:71], v[100:103]
v_mfma_f32_16x16x32_bf16 v[100:103], v[28:31], v[76:79], v[100:103]
v_mfma_f32_16x16x32_bf16 v[104:107], v[4:7], v[56:59], 0
v_mfma_f32_16x16x32_bf16 v[104:107], v[12:15], v[64:67], v[104:107]
v_mfma_f32_16x16x32_bf16 v[104:107], v[20:23], v[72:75], v[104:107]
v_mfma_f32_16x16x32_bf16 v[104:107], v[28:31], v[80:83], v[104:107]
v_mfma_f32_16x16x32_bf16 v[108:111], v[8:11], v[52:55], 0
v_mfma_f32_16x16x32_bf16 v[108:111], v[16:19], v[60:63], v[108:111]
v_mfma_f32_16x16x32_bf16 v[108:111], v[24:27], v[68:71], v[108:111]
v_mfma_f32_16x16x32_bf16 v[108:111], v[32:35], v[76:79], v[108:111]
v_mfma_f32_16x16x32_bf16 v[112:115], v[8:11], v[56:59], 0
v_mfma_f32_16x16x32_bf16 v[112:115], v[16:19], v[64:67], v[112:115]
v_mfma_f32_16x16x32_bf16 v[112:115], v[24:27], v[72:75], v[112:115]
v_mfma_f32_16x16x32_bf16 v[112:115], v[32:35], v[80:83], v[112:115]
v_mfma_f32_16x16x16_bf16 v[100:103], v[36:37], v[84:85], v[100:103]
v_mfma_f32_16x16x16_bf16 v[104:107], v[36:37], v[86:87], v[104:107]
v_mfma_f32_16x16x16_bf16 v[108:111], v[38:39], v[84:85], v[108:111]
v_mfma_f32_16x16x16_bf16 v[112:115], v[38:39], v[86:87], v[112:115]
v_mfma_f32_16x16x16_bf16 v[100:103], v[40:41], v[88:89], v[100:103]
v_mfma_f32_16x16x16_bf16 v[104:107], v[40:41], v[90:91], v[104:107]
v_mfma_f32_16x16x16_bf16 v[108:111], v[42:43], v[88:89], v[108:111]
v_mfma_f32_16x16x16_bf16 v[112:115], v[42:43], v[90:91], v[112:115]
v_mfma_f32_16x16x16_bf16 v[100:103], v[44:45], v[92:93], v[100:103]
v_mfma_f32_16x16x16_bf16 v[104:107], v[44:45], v[94:95], v[104:107]
v_mfma_f32_16x16x16_bf16 v[108:111], v[46:47], v[92:93], v[108:111]
v_mfma_f32_16x16x16_bf16 v[112:115], v[46:47], v[94:95], v[112:115]
v_mfma_f32_16x16x16_bf16 v[100:103], v[48:49], v[96:97], v[100:103]
v_mfma_f32_16x16x16_bf16 v[104:107], v[48:49], v[98:99], v[104:107]
v_mfma_f32_16x16x16_bf16 v[108:111], v[50:51], v[96:97], v[108:111]
v_mfma_f32_16x16x16_bf16 v[112:115], v[50:51], v[98:99], v[112:115]
s_nop 7
s_lshl_b32 s37, s24, 12
v_add_u32 v4, s37, v2
ds_write_b128 v4, v[100:103] offset:0
ds_write_b128 v4, v[104:107] offset:1024
ds_write_b128 v4, v[108:111] offset:2048
ds_write_b128 v4, v[112:115] offset:3072
s_waitcnt lgkmcnt(0)
s_barrier
s_lshl_b32 s37, s24, 10
v_add_u32 v4, s37, v2
ds_read_b128 v[8:11], v4 offset:0
ds_read_b128 v[12:15], v4 offset:4096
ds_read_b128 v[16:19], v4 offset:8192
ds_read_b128 v[20:23], v4 offset:12288
s_waitcnt lgkmcnt(0)
v_add_f32 v8, v8, v12
v_add_f32 v16, v16, v20
v_add_f32 v9, v9, v13
v_add_f32 v17, v17, v21
v_add_f32 v10, v10, v14
v_add_f32 v18, v18, v22
v_add_f32 v11, v11, v15
v_add_f32 v19, v19, v23
v_add_f32 v8, v8, v16
v_add_f32 v9, v9, v17
v_add_f32 v10, v10, v18
v_add_f32 v11, v11, v19
s_waitcnt vmcnt(0)
v_lshlrev_b32 v24, 16, v122
v_and_b32 v25, 0xffff0000, v122
v_lshlrev_b32 v26, 16, v123
v_and_b32 v27, 0xffff0000, v123
v_add_f32 v8, v8, v24
v_add_f32 v9, v9, v25
v_add_f32 v10, v10, v26
v_add_f32 v11, v11, v27
v_cvt_pk_bf16_f32 v28, v8, v9
v_cvt_pk_bf16_f32 v29, v10, v11
v_min_u32 v28, 0xfffffffe, v28
v_min_u32 v29, 0xfffffffe, v29
s_lshl_b32 s38, s33, 10
v_add_u32 v33, s38, v118
ds_write_b64 v33, v[28:29] offset:16384
v_lshlrev_b32 v24, 16, v28
v_and_b32 v25, 0xffff0000, v28
v_lshlrev_b32 v26, 16, v29
v_and_b32 v27, 0xffff0000, v29
v_add_f32 v30, v24, v25
v_add_f32 v31, v26, v27
v_add_f32 v30, v30, v31
v_mul_f32 v31, v24, v24
v_fmac_f32 v31, v25, v25
v_fmac_f32 v31, v26, v26
v_fmac_f32 v31, v27, v27
v_mov_b32 v32, v30
s_nop 1
v_permlane16_swap_b32 v30, v32
v_add_f32 v30, v30, v32
v_mov_b32 v32, v30
s_nop 1
v_permlane32_swap_b32 v30, v32
v_add_f32 v30, v30, v32
v_mov_b32 v32, v31
s_nop 1
v_permlane16_swap_b32 v31, v32
v_add_f32 v31, v31, v32
v_mov_b32 v32, v31
s_nop 1
v_permlane32_swap_b32 v31, v32
v_add_f32 v31, v31, v32
v_min_u32 v30, 0xfffffffe, v30
v_min_u32 v31, 0xfffffffe, v31
v_lshlrev_b32 v32, 4, v116
s_lshl_b32 s38, s33, 3
v_add_u32 v32, s38, v32
v_cmp_gt_u32 vcc, 16, v1
s_and_saveexec_b64 s[40:41], vcc
ds_write_b64 v32, v[30:31] offset:18432
s_mov_b64 exec, s[40:41]
s_waitcnt lgkmcnt(0)
s_barrier
s_cmp_ge_u32 s24, 3
s_cbranch_scc1 RV_nost
s_lshl_b32 s38, s24, 10
v_add_u32 v33, s38, v2
ds_read_b128 v[36:39], v33 offset:16384
s_cmp_eq_u32 s24, 2
s_cbranch_scc1 RV_st
s_mul_i32 s37, s25, 28672
s_lshl_b32 s39, s28, 11
s_add_u32 s37, s37, s39
s_add_u32 s37, s37, s38
s_add_u32 s37, s37, 64815104
s_waitcnt lgkmcnt(0)
buffer_store_dwordx4 v[36:39], v2, s[4:7], s37 offen sc1
s_branch RV_nost
RV_st:
s_mul_i32 s37, s25, 8192
s_lshl_b32 s39, s28, 9
s_add_u32 s37, s37, s39
s_add_u32 s37, s37, 73990144
s_waitcnt lgkmcnt(0)
v_cmp_gt_u32 vcc, 32, v1
s_and_saveexec_b64 s[40:41], vcc
buffer_store_dwordx4 v[36:39], v2, s[4:7], s37 offen sc1
s_mov_b64 exec, s[40:41]
RV_nost:
s_mov_b32 s45, 1
s_add_u32 s25, s25, 2
s_cmp_lt_u32 s25, 64
s_cbranch_scc1 RV_loop
s_sub_u32 s25, s25, 2
s_waitcnt vmcnt(0)
s_barrier
s_cmp_lg_u32 s24, 0
s_cbranch_scc1 RV_sig_s
s_lshl_b32 s46, s25, 7
s_add_u32 s46, s46, 74989696
v_mov_b32 v4, s46
v_mov_b32 v5, 1
s_mov_b64 exec, 1
buffer_atomic_add v5, v4, s[4:7], 0 offen
s_mov_b64 exec, -1
RV_sig_s:
s_branch L_exit
L_F1:
s_sub_u32 s22, s22, 84
s_load_dwordx2 s[8:9], s[0:1], 64
s_load_dwordx2 s[12:13], s[0:1], 72
s_mul_i32 s25, s22, 4682
s_lshr_b32 s25, s25, 16
s_mul_i32 s28, s25, 14
s_sub_u32 s28, s22, s28
s_waitcnt lgkmcnt(0)
s_and_b32 s9, s9, 0xffff
s_mov_b32 s10, 1605632
s_mov_b32 s11, 0x20000
s_and_b32 s13, s13, 0xffff
s_mov_b32 s14, 1605632
s_mov_b32 s15, 0x20000
v_lshrrev_b32 v3, 2, v1
v_mul_u32_u24 v3, 3584, v3
v_and_b32 v6, 3, v1
v_lshl_add_u32 v3, v6, 4, v3
s_mul_i32 s29, s24, 28672
v_add_u32 v4, s29, v2
v_lshrrev_b32 v6, 4, v1
v_lshlrev_b32 v6, 3, v6
v_bfe_u32 v7, v1, 2, 2
v_add_u32 v6, v6, v7
v_lshlrev_b32 v6, 6, v6
v_and_b32 v7, 3, v1
v_lshl_add_u32 v6, v7, 3, v6
v_add_u32 v5, s29, v6
s_lshl_b32 s30, s28, 8
s_lshl_b32 s31, s24, 6
s_add_u32 s30, s30, s31
s_add_u32 s31, s30, 0
buffer_load_dwordx4 v[8:11], v3, s[8:11], s31 offen
s_add_u32 s31, s30, 57344
buffer_load_dwordx4 v[12:15], v3, s[8:11], s31 offen
s_add_u32 s31, s30, 114688
buffer_load_dwordx4 v[16:19], v3, s[8:11], s31 offen
s_add_u32 s31, s30, 172032
buffer_load_dwordx4 v[20:23], v3, s[8:11], s31 offen
s_add_u32 s31, s30, 229376
buffer_load_dwordx4 v[24:27], v3, s[8:11], s31 offen
s_add_u32 s31, s30, 286720
buffer_load_dwordx4 v[28:31], v3, s[8:11], s31 offen
s_add_u32 s31, s30, 344064
buffer_load_dwordx4 v[32:35], v3, s[8:11], s31 offen
s_add_u32 s31, s30, 401408
buffer_load_dwordx4 v[36:39], v3, s[8:11], s31 offen
s_add_u32 s31, s30, 458752
buffer_load_dwordx4 v[40:43], v3, s[8:11], s31 offen
s_add_u32 s31, s30, 516096
buffer_load_dwordx4 v[44:47], v3, s[8:11], s31 offen
s_add_u32 s31, s30, 573440
buffer_load_dwordx4 v[48:51], v3, s[8:11], s31 offen
s_add_u32 s31, s30, 630784
buffer_load_dwordx4 v[52:55], v3, s[8:11], s31 offen
s_add_u32 s31, s30, 688128
buffer_load_dwordx4 v[56:59], v3, s[8:11], s31 offen
s_add_u32 s31, s30, 745472
buffer_load_dwordx4 v[60:63], v3, s[8:11], s31 offen
s_add_u32 s31, s30, 802816
buffer_load_dwordx4 v[64:67], v3, s[8:11], s31 offen
s_add_u32 s31, s30, 860160
buffer_load_dwordx4 v[68:71], v3, s[8:11], s31 offen
s_add_u32 s31, s30, 917504
buffer_load_dwordx4 v[72:75], v3, s[8:11], s31 offen
s_add_u32 s31, s30, 974848
buffer_load_dwordx4 v[76:79], v3, s[8:11], s31 offen
s_add_u32 s31, s30, 1032192
buffer_load_dwordx4 v[80:83], v3, s[8:11], s31 offen
s_add_u32 s31, s30, 1089536
buffer_load_dwordx4 v[84:87], v3, s[8:11], s31 offen
s_add_u32 s31, s30, 1146880
buffer_load_dwordx4 v[88:91], v3, s[8:11], s31 offen
s_add_u32 s31, s30, 1204224
buffer_load_dwordx4 v[92:95], v3, s[8:11], s31 offen
s_add_u32 s31, s30, 1261568
buffer_load_dwordx4 v[96:99], v3, s[8:11], s31 offen
s_add_u32 s31, s30, 1318912
buffer_load_dwordx4 v[100:103], v3, s[8:11], s31 offen
s_add_u32 s31, s30, 1376256
buffer_load_dwordx4 v[104:107], v3, s[8:11], s31 offen
s_add_u32 s31, s30, 1433600
buffer_load_dwordx4 v[108:111], v3, s[8:11], s31 offen
s_add_u32 s31, s30, 1490944
buffer_load_dwordx4 v[112:115], v3, s[8:11], s31 offen
s_add_u32 s31, s30, 1548288
buffer_load_dwordx4 v[116:119], v3, s[8:11], s31 offen
s_waitcnt vmcnt(0)
ds_write_b128 v4, v[8:11] offset:0
ds_write_b128 v4, v[12:15] offset:1024
ds_write_b128 v4, v[16:19] offset:2048
ds_write_b128 v4, v[20:23] offset:3072
ds_write_b128 v4, v[24:27] offset:4096
ds_write_b128 v4, v[28:31] offset:5120
ds_write_b128 v4, v[32:35] offset:6144
ds_write_b128 v4, v[36:39] offset:7168
ds_write_b128 v4, v[40:43] offset:8192
ds_write_b128 v4, v[44:47] offset:9216
ds_write_b128 v4, v[48:51] offset:10240
ds_write_b128 v4, v[52:55] offset:11264
ds_write_b128 v4, v[56:59] offset:12288
ds_write_b128 v4, v[60:63] offset:13312
ds_write_b128 v4, v[64:67] offset:14336
ds_write_b128 v4, v[68:71] offset:15360
ds_write_b128 v4, v[72:75] offset:16384
ds_write_b128 v4, v[76:79] offset:17408
ds_write_b128 v4, v[80:83] offset:18432
ds_write_b128 v4, v[84:87] offset:19456
ds_write_b128 v4, v[88:91] offset:20480
ds_write_b128 v4, v[92:95] offset:21504
ds_write_b128 v4, v[96:99] offset:22528
ds_write_b128 v4, v[100:103] offset:23552
ds_write_b128 v4, v[104:107] offset:24576
ds_write_b128 v4, v[108:111] offset:25600
ds_write_b128 v4, v[112:115] offset:26624
ds_write_b128 v4, v[116:119] offset:27648
s_waitcnt lgkmcnt(0)
ds_read_b64_tr_b16 a[0:1], v5 offset:0
ds_read_b64_tr_b16 a[2:3], v5 offset:256
ds_read_b64_tr_b16 a[4:5], v5 offset:2048
ds_read_b64_tr_b16 a[6:7], v5 offset:2304
ds_read_b64_tr_b16 a[8:9], v5 offset:4096
ds_read_b64_tr_b16 a[10:11], v5 offset:4352
ds_read_b64_tr_b16 a[12:13], v5 offset:6144
ds_read_b64_tr_b16 a[14:15], v5 offset:6400
ds_read_b64_tr_b16 a[16:17], v5 offset:8192
ds_read_b64_tr_b16 a[18:19], v5 offset:8448
ds_read_b64_tr_b16 a[20:21], v5 offset:10240
ds_read_b64_tr_b16 a[22:23], v5 offset:10496
ds_read_b64_tr_b16 a[24:25], v5 offset:12288
ds_read_b64_tr_b16 a[26:27], v5 offset:12544
ds_read_b64_tr_b16 a[28:29], v5 offset:14336
ds_read_b64_tr_b16 a[30:31], v5 offset:14592
ds_read_b64_tr_b16 a[32:33], v5 offset:16384
ds_read_b64_tr_b16 a[34:35], v5 offset:16640
ds_read_b64_tr_b16 a[36:37], v5 offset:18432
ds_read_b64_tr_b16 a[38:39], v5 offset:18688
ds_read_b64_tr_b16 a[40:41], v5 offset:20480
ds_read_b64_tr_b16 a[42:43], v5 offset:20736
ds_read_b64_tr_b16 a[44:45], v5 offset:22528
ds_read_b64_tr_b16 a[46:47], v5 offset:22784
ds_read_b64_tr_b16 a[48:49], v5 offset:24576
ds_read_b64_tr_b16 a[50:51], v5 offset:24832
ds_read_b64_tr_b16 a[52:53], v5 offset:26624
ds_read_b64_tr_b16 a[54:55], v5 offset:26880
s_waitcnt lgkmcnt(0)
ds_read_b64_tr_b16 a[56:57], v5 offset:32
ds_read_b64_tr_b16 a[58:59], v5 offset:288
ds_read_b64_tr_b16 a[60:61], v5 offset:2080
ds_read_b64_tr_b16 a[62:63], v5 offset:2336
ds_read_b64_tr_b16 a[64:65], v5 offset:4128
ds_read_b64_tr_b16 a[66:67], v5 offset:4384
ds_read_b64_tr_b16 a[68:69], v5 offset:6176
ds_read_b64_tr_b16 a[70:71], v5 offset:6432
ds_read_b64_tr_b16 a[72:73], v5 offset:8224
ds_read_b64_tr_b16 a[74:75], v5 offset:8480
ds_read_b64_tr_b16 a[76:77], v5 offset:10272
ds_read_b64_tr_b16 a[78:79], v5 offset:10528
ds_read_b64_tr_b16 a[80:81], v5 offset:12320
ds_read_b64_tr_b16 a[82:83], v5 offset:12576
ds_read_b64_tr_b16 a[84:85], v5 offset:14368
ds_read_b64_tr_b16 a[86:87], v5 offset:14624
ds_read_b64_tr_b16 a[88:89], v5 offset:16416
ds_read_b64_tr_b16 a[90:91], v5 offset:16672
ds_read_b64_tr_b16 a[92:93], v5 offset:18464
ds_read_b64_tr_b16 a[94:95], v5 offset:18720
ds_read_b64_tr_b16 a[96:97], v5 offset:20512
ds_read_b64_tr_b16 a[98:99], v5 offset:20768
ds_read_b64_tr_b16 a[100:101], v5 offset:22560
ds_read_b64_tr_b16 a[102:103], v5 offset:22816
ds_read_b64_tr_b16 a[104:105], v5 offset:24608
ds_read_b64_tr_b16 a[106:107], v5 offset:24864
ds_read_b64_tr_b16 a[108:109], v5 offset:26656
ds_read_b64_tr_b16 a[110:111], v5 offset:26912
s_waitcnt lgkmcnt(0)
s_add_u32 s31, s30, 0
buffer_load_dwordx4 v[8:11], v3, s[12:15], s31 offen
s_add_u32 s31, s30, 57344
buffer_load_dwordx4 v[12:15], v3, s[12:15], s31 offen
s_add_u32 s31, s30, 114688
buffer_load_dwordx4 v[16:19], v3, s[12:15], s31 offen
s_add_u32 s31, s30, 172032
buffer_load_dwordx4 v[20:23], v3, s[12:15], s31 offen
s_add_u32 s31, s30, 229376
buffer_load_dwordx4 v[24:27], v3, s[12:15], s31 offen
s_add_u32 s31, s30, 286720
buffer_load_dwordx4 v[28:31], v3, s[12:15], s31 offen
s_add_u32 s31, s30, 344064
buffer_load_dwordx4 v[32:35], v3, s[12:15], s31 offen
s_add_u32 s31, s30, 401408
buffer_load_dwordx4 v[36:39], v3, s[12:15], s31 offen
s_add_u32 s31, s30, 458752
buffer_load_dwordx4 v[40:43], v3, s[12:15], s31 offen
s_add_u32 s31, s30, 516096
buffer_load_dwordx4 v[44:47], v3, s[12:15], s31 offen
s_add_u32 s31, s30, 573440
buffer_load_dwordx4 v[48:51], v3, s[12:15], s31 offen
s_add_u32 s31, s30, 630784
buffer_load_dwordx4 v[52:55], v3, s[12:15], s31 offen
s_add_u32 s31, s30, 688128
buffer_load_dwordx4 v[56:59], v3, s[12:15], s31 offen
s_add_u32 s31, s30, 745472
buffer_load_dwordx4 v[60:63], v3, s[12:15], s31 offen
s_add_u32 s31, s30, 802816
buffer_load_dwordx4 v[64:67], v3, s[12:15], s31 offen
s_add_u32 s31, s30, 860160
buffer_load_dwordx4 v[68:71], v3, s[12:15], s31 offen
s_add_u32 s31, s30, 917504
buffer_load_dwordx4 v[72:75], v3, s[12:15], s31 offen
s_add_u32 s31, s30, 974848
buffer_load_dwordx4 v[76:79], v3, s[12:15], s31 offen
s_add_u32 s31, s30, 1032192
buffer_load_dwordx4 v[80:83], v3, s[12:15], s31 offen
s_add_u32 s31, s30, 1089536
buffer_load_dwordx4 v[84:87], v3, s[12:15], s31 offen
s_add_u32 s31, s30, 1146880
buffer_load_dwordx4 v[88:91], v3, s[12:15], s31 offen
s_add_u32 s31, s30, 1204224
buffer_load_dwordx4 v[92:95], v3, s[12:15], s31 offen
s_add_u32 s31, s30, 1261568
buffer_load_dwordx4 v[96:99], v3, s[12:15], s31 offen
s_add_u32 s31, s30, 1318912
buffer_load_dwordx4 v[100:103], v3, s[12:15], s31 offen
s_add_u32 s31, s30, 1376256
buffer_load_dwordx4 v[104:107], v3, s[12:15], s31 offen
s_add_u32 s31, s30, 1433600
buffer_load_dwordx4 v[108:111], v3, s[12:15], s31 offen
s_add_u32 s31, s30, 1490944
buffer_load_dwordx4 v[112:115], v3, s[12:15], s31 offen
s_add_u32 s31, s30, 1548288
buffer_load_dwordx4 v[116:119], v3, s[12:15], s31 offen
s_waitcnt vmcnt(0)
ds_write_b128 v4, v[8:11] offset:0
ds_write_b128 v4, v[12:15] offset:1024
ds_write_b128 v4, v[16:19] offset:2048
ds_write_b128 v4, v[20:23] offset:3072
ds_write_b128 v4, v[24:27] offset:4096
ds_write_b128 v4, v[28:31] offset:5120
ds_write_b128 v4, v[32:35] offset:6144
ds_write_b128 v4, v[36:39] offset:7168
ds_write_b128 v4, v[40:43] offset:8192
ds_write_b128 v4, v[44:47] offset:9216
ds_write_b128 v4, v[48:51] offset:10240
ds_write_b128 v4, v[52:55] offset:11264
ds_write_b128 v4, v[56:59] offset:12288
ds_write_b128 v4, v[60:63] offset:13312
ds_write_b128 v4, v[64:67] offset:14336
ds_write_b128 v4, v[68:71] offset:15360
ds_write_b128 v4, v[72:75] offset:16384
ds_write_b128 v4, v[76:79] offset:17408
ds_write_b128 v4, v[80:83] offset:18432
ds_write_b128 v4, v[84:87] offset:19456
ds_write_b128 v4, v[88:91] offset:20480
ds_write_b128 v4, v[92:95] offset:21504
ds_write_b128 v4, v[96:99] offset:22528
ds_write_b128 v4, v[100:103] offset:23552
ds_write_b128 v4, v[104:107] offset:24576
ds_write_b128 v4, v[108:111] offset:25600
ds_write_b128 v4, v[112:115] offset:26624
ds_write_b128 v4, v[116:119] offset:27648
s_waitcnt lgkmcnt(0)
ds_read_b64_tr_b16 a[112:113], v5 offset:0
ds_read_b64_tr_b16 a[114:115], v5 offset:256
ds_read_b64_tr_b16 a[116:117], v5 offset:2048
ds_read_b64_tr_b16 a[118:119], v5 offset:2304
ds_read_b64_tr_b16 a[120:121], v5 offset:4096
ds_read_b64_tr_b16 a[122:123], v5 offset:4352
ds_read_b64_tr_b16 a[124:125], v5 offset:6144
ds_read_b64_tr_b16 a[126:127], v5 offset:6400
ds_read_b64_tr_b16 a[128:129], v5 offset:8192
ds_read_b64_tr_b16 a[130:131], v5 offset:8448
ds_read_b64_tr_b16 a[132:133], v5 offset:10240
ds_read_b64_tr_b16 a[134:135], v5 offset:10496
ds_read_b64_tr_b16 a[136:137], v5 offset:12288
ds_read_b64_tr_b16 a[138:139], v5 offset:12544
ds_read_b64_tr_b16 a[140:141], v5 offset:14336
ds_read_b64_tr_b16 a[142:143], v5 offset:14592
ds_read_b64_tr_b16 a[144:145], v5 offset:16384
ds_read_b64_tr_b16 a[146:147], v5 offset:16640
ds_read_b64_tr_b16 a[148:149], v5 offset:18432
ds_read_b64_tr_b16 a[150:151], v5 offset:18688
ds_read_b64_tr_b16 a[152:153], v5 offset:20480
ds_read_b64_tr_b16 a[154:155], v5 offset:20736
ds_read_b64_tr_b16 a[156:157], v5 offset:22528
ds_read_b64_tr_b16 a[158:159], v5 offset:22784
ds_read_b64_tr_b16 a[160:161], v5 offset:24576
ds_read_b64_tr_b16 a[162:163], v5 offset:24832
ds_read_b64_tr_b16 a[164:165], v5 offset:26624
ds_read_b64_tr_b16 a[166:167], v5 offset:26880
s_waitcnt lgkmcnt(0)
ds_read_b64_tr_b16 a[168:169], v5 offset:32
ds_read_b64_tr_b16 a[170:171], v5 offset:288
ds_read_b64_tr_b16 a[172:173], v5 offset:2080
ds_read_b64_tr_b16 a[174:175], v5 offset:2336
ds_read_b64_tr_b16 a[176:177], v5 offset:4128
ds_read_b64_tr_b16 a[178:179], v5 offset:4384
ds_read_b64_tr_b16 a[180:181], v5 offset:6176
ds_read_b64_tr_b16 a[182:183], v5 offset:6432
ds_read_b64_tr_b16 a[184:185], v5 offset:8224
ds_read_b64_tr_b16 a[186:187], v5 offset:8480
ds_read_b64_tr_b16 a[188:189], v5 offset:10272
ds_read_b64_tr_b16 a[190:191], v5 offset:10528
ds_read_b64_tr_b16 a[192:193], v5 offset:12320
ds_read_b64_tr_b16 a[194:195], v5 offset:12576
ds_read_b64_tr_b16 a[196:197], v5 offset:14368
ds_read_b64_tr_b16 a[198:199], v5 offset:14624
ds_read_b64_tr_b16 a[200:201], v5 offset:16416
ds_read_b64_tr_b16 a[202:203], v5 offset:16672
ds_read_b64_tr_b16 a[204:205], v5 offset:18464
ds_read_b64_tr_b16 a[206:207], v5 offset:18720
ds_read_b64_tr_b16 a[208:209], v5 offset:20512
ds_read_b64_tr_b16 a[210:211], v5 offset:20768
ds_read_b64_tr_b16 a[212:213], v5 offset:22560
ds_read_b64_tr_b16 a[214:215], v5 offset:22816
ds_read_b64_tr_b16 a[216:217], v5 offset:24608
ds_read_b64_tr_b16 a[218:219], v5 offset:24864
ds_read_b64_tr_b16 a[220:221], v5 offset:26656
ds_read_b64_tr_b16 a[222:223], v5 offset:26912
s_waitcnt lgkmcnt(0)
v_mov_b32 v8, 0x3f803f80
v_mov_b32 v9, 0x3f803f80
v_mov_b32 v10, 0x3f803f80
v_mov_b32 v11, 0x3f803f80
s_nop 1
v_mfma_f32_16x16x32_bf16 v[96:99], a[0:3], v[8:11], 0
v_mfma_f32_16x16x32_bf16 v[96:99], a[4:7], v[8:11], v[96:99]
v_mfma_f32_16x16x32_bf16 v[96:99], a[8:11], v[8:11], v[96:99]
v_mfma_f32_16x16x32_bf16 v[96:99], a[12:15], v[8:11], v[96:99]
v_mfma_f32_16x16x32_bf16 v[96:99], a[16:19], v[8:11], v[96:99]
v_mfma_f32_16x16x32_bf16 v[96:99], a[20:23], v[8:11], v[96:99]
v_mfma_f32_16x16x32_bf16 v[96:99], a[24:27], v[8:11], v[96:99]
v_mfma_f32_16x16x32_bf16 v[96:99], a[28:31], v[8:11], v[96:99]
v_mfma_f32_16x16x32_bf16 v[96:99], a[32:35], v[8:11], v[96:99]
v_mfma_f32_16x16x32_bf16 v[96:99], a[36:39], v[8:11], v[96:99]
v_mfma_f32_16x16x32_bf16 v[96:99], a[40:43], v[8:11], v[96:99]
v_mfma_f32_16x16x32_bf16 v[96:99], a[44:47], v[8:11], v[96:99]
v_mfma_f32_16x16x32_bf16 v[96:99], a[48:51], v[8:11], v[96:99]
v_mfma_f32_16x16x32_bf16 v[96:99], a[52:55], v[8:11], v[96:99]
v_mfma_f32_16x16x32_bf16 v[100:103], a[56:59], v[8:11], 0
v_mfma_f32_16x16x32_bf16 v[100:103], a[60:63], v[8:11], v[100:103]
v_mfma_f32_16x16x32_bf16 v[100:103], a[64:67], v[8:11], v[100:103]
v_mfma_f32_16x16x32_bf16 v[100:103], a[68:71], v[8:11], v[100:103]
v_mfma_f32_16x16x32_bf16 v[100:103], a[72:75], v[8:11], v[100:103]
v_mfma_f32_16x16x32_bf16 v[100:103], a[76:79], v[8:11], v[100:103]
v_mfma_f32_16x16x32_bf16 v[100:103], a[80:83], v[8:11], v[100:103]
v_mfma_f32_16x16x32_bf16 v[100:103], a[84:87], v[8:11], v[100:103]
v_mfma_f32_16x16x32_bf16 v[100:103], a[88:91], v[8:11], v[100:103]
v_mfma_f32_16x16x32_bf16 v[100:103], a[92:95], v[8:11], v[100:103]
v_mfma_f32_16x16x32_bf16 v[100:103], a[96:99], v[8:11], v[100:103]
v_mfma_f32_16x16x32_bf16 v[100:103], a[100:103], v[8:11], v[100:103]
v_mfma_f32_16x16x32_bf16 v[100:103], a[104:107], v[8:11], v[100:103]
v_mfma_f32_16x16x32_bf16 v[100:103], a[108:111], v[8:11], v[100:103]
v_mfma_f32_16x16x32_bf16 v[104:107], a[112:115], v[8:11], 0
v_mfma_f32_16x16x32_bf16 v[104:107], a[116:119], v[8:11], v[104:107]
v_mfma_f32_16x16x32_bf16 v[104:107], a[120:123], v[8:11], v[104:107]
v_mfma_f32_16x16x32_bf16 v[104:107], a[124:127], v[8:11], v[104:107]
v_mfma_f32_16x16x32_bf16 v[104:107], a[128:131], v[8:11], v[104:107]
v_mfma_f32_16x16x32_bf16 v[104:107], a[132:135], v[8:11], v[104:107]
v_mfma_f32_16x16x32_bf16 v[104:107], a[136:139], v[8:11], v[104:107]
v_mfma_f32_16x16x32_bf16 v[104:107], a[140:143], v[8:11], v[104:107]
v_mfma_f32_16x16x32_bf16 v[104:107], a[144:147], v[8:11], v[104:107]
v_mfma_f32_16x16x32_bf16 v[104:107], a[148:151], v[8:11], v[104:107]
v_mfma_f32_16x16x32_bf16 v[104:107], a[152:155], v[8:11], v[104:107]
v_mfma_f32_16x16x32_bf16 v[104:107], a[156:159], v[8:11], v[104:107]
v_mfma_f32_16x16x32_bf16 v[104:107], a[160:163], v[8:11], v[104:107]
v_mfma_f32_16x16x32_bf16 v[104:107], a[164:167], v[8:11], v[104:107]
v_mfma_f32_16x16x32_bf16 v[108:111], a[168:171], v[8:11], 0
v_mfma_f32_16x16x32_bf16 v[108:111], a[172:175], v[8:11], v[108:111]
v_mfma_f32_16x16x32_bf16 v[108:111], a[176:179], v[8:11], v[108:111]
v_mfma_f32_16x16x32_bf16 v[108:111], a[180:183], v[8:11], v[108:111]
v_mfma_f32_16x16x32_bf16 v[108:111], a[184:187], v[8:11], v[108:111]
v_mfma_f32_16x16x32_bf16 v[108:111], a[188:191], v[8:11], v[108:111]
v_mfma_f32_16x16x32_bf16 v[108:111], a[192:195], v[8:11], v[108:111]
v_mfma_f32_16x16x32_bf16 v[108:111], a[196:199], v[8:11], v[108:111]
v_mfma_f32_16x16x32_bf16 v[108:111], a[200:203], v[8:11], v[108:111]
v_mfma_f32_16x16x32_bf16 v[108:111], a[204:207], v[8:11], v[108:111]
v_mfma_f32_16x16x32_bf16 v[108:111], a[208:211], v[8:11], v[108:111]
v_mfma_f32_16x16x32_bf16 v[108:111], a[212:215], v[8:11], v[108:111]
v_mfma_f32_16x16x32_bf16 v[108:111], a[216:219], v[8:11], v[108:111]
v_mfma_f32_16x16x32_bf16 v[108:111], a[220:223], v[8:11], v[108:111]
s_barrier
s_mul_i32 s29, s24, 7168
v_add_u32 v124, s29, v2
v_mov_b32 v125, v2
v_lshrrev_b32 v160, 4, v1
v_and_b32 v161, 15, v1
v_lshlrev_b32 v126, 9, v160
v_lshl_add_u32 v126, v161, 4, v126
v_lshlrev_b32 v127, 4, v161
v_lshl_add_u32 v127, v160, 9, v127
v_lshrrev_b32 v123, 1, v160
v_lshlrev_b32 v123, 29, v123
v_add_u32 v123, v123, v127
s_mul_i32 s29, s24, 7
s_add_u32 s29, s29, 0
s_cmp_ge_u32 s29, 14
s_cselect_b32 s30, 1, 0
s_mul_i32 s31, s30, 14
s_sub_u32 s29, s29, s31
s_lshl_b32 s29, s29, 11
s_lshl_b32 s30, s30, 8
s_add_u32 s64, s29, s30
s_mul_i32 s29, s24, 7
s_add_u32 s29, s29, 1
s_cmp_ge_u32 s29, 14
s_cselect_b32 s30, 1, 0
s_mul_i32 s31, s30, 14
s_sub_u32 s29, s29, s31
s_lshl_b32 s29, s29, 11
s_lshl_b32 s30, s30, 8
s_add_u32 s65, s29, s30
s_mul_i32 s29, s24, 7
s_add_u32 s29, s29, 2
s_cmp_ge_u32 s29, 14
s_cselect_b32 s30, 1, 0
s_mul_i32 s31, s30, 14
s_sub_u32 s29, s29, s31
s_lshl_b32 s29, s29, 11
s_lshl_b32 s30, s30, 8
s_add_u32 s66, s29, s30
s_mul_i32 s29, s24, 7
s_add_u32 s29, s29, 3
s_cmp_ge_u32 s29, 14
s_cselect_b32 s30, 1, 0
s_mul_i32 s31, s30, 14
s_sub_u32 s29, s29, s31
s_lshl_b32 s29, s29, 11
s_lshl_b32 s30, s30, 8
s_add_u32 s67, s29, s30
s_mul_i32 s29, s24, 7
s_add_u32 s29, s29, 4
s_cmp_ge_u32 s29, 14
s_cselect_b32 s30, 1, 0
s_mul_i32 s31, s30, 14
s_sub_u32 s29, s29, s31
s_lshl_b32 s29, s29, 11
s_lshl_b32 s30, s30, 8
s_add_u32 s68, s29, s30
s_mul_i32 s29, s24, 7
s_add_u32 s29, s29, 5
s_cmp_ge_u32 s29, 14
s_cselect_b32 s30, 1, 0
s_mul_i32 s31, s30, 14
s_sub_u32 s29, s29, s31
s_lshl_b32 s29, s29, 11
s_lshl_b32 s30, s30, 8
s_add_u32 s69, s29, s30
s_mul_i32 s29, s24, 7
s_add_u32 s29, s29, 6
s_cmp_ge_u32 s29, 14
s_cselect_b32 s30, 1, 0
s_mul_i32 s31, s30, 14
s_sub_u32 s29, s29, s31
s_lshl_b32 s29, s29, 11
s_lshl_b32 s30, s30, 8
s_add_u32 s70, s29, s30
s_mov_b32 s43, 0
s_mov_b32 s45, 0
RF_loop:
s_cmp_lg_u32 s24, 0
s_cbranch_scc1 RF_wh_d
s_lshl_b32 s46, s25, 7
v_mov_b32 v160, 74989696
v_mov_b32 v161, 14
v_add_u32 v160, s46, v160
buffer_load_dword v162, v160, s[4:7], 0 offen sc1
RF_wh_d:
s_waitcnt vmcnt(0)
s_barrier
s_cmp_lg_u32 s24, 0
s_cbranch_scc1 RF_wh_w
s_cmp_eq_u32 s45, 0
s_cbranch_scc1 RF_wh_c
s_sub_u32 s44, s25, 3
s_lshl_b32 s44, s44, 7
s_add_u32 s44, s44, 74997888
v_mov_b32 v163, s44
v_mov_b32 v164, 1
s_mov_b64 exec, 1
buffer_atomic_add v164, v163, s[4:7], 0 offen
s_mov_b64 exec, -1
RF_wh_c:
s_cmp_ge_u32 s25, 60
s_cbranch_scc1 RF_wh_w
s_mov_b32 s47, 0
RF_wh_p:
v_cmp_lt_u32 vcc, v162, v161
s_cbranch_vccz RF_wh_w
s_add_u32 s47, s47, 1
s_cmp_gt_u32 s47, 20000
s_cbranch_scc1 RF_wh_w
s_sleep 1
buffer_load_dword v162, v160, s[4:7], 0 offen sc1
s_waitcnt vmcnt(0)
s_branch RF_wh_p
RF_wh_w:
s_barrier
s_cmp_lt_u32 s25, 56
s_cbranch_scc1 RF_tg_g
s_cmp_lg_u32 s43, 0
s_cbranch_scc1 RF_tg_g
s_mov_b32 s43, 1
s_cmp_lg_u32 s24, 0
s_cbranch_scc1 RF_tg_t_w
v_mov_b32 v160, 75019520
s_mov_b32 s47, 0
RF_tg_t_p:
buffer_load_dword v161, v160, s[4:7], 0 offen sc1
s_waitcnt vmcnt(0)
v_readfirstlane_b32 s46, v161
s_add_u32 s47, s47, 1
s_nop 1
s_cmp_ge_u32 s46, 6
s_cbranch_scc1 RF_tg_t_w
s_cmp_gt_u32 s47, 20000
s_cbranch_scc1 RF_tg_t_w
s_sleep 1
s_branch RF_tg_t_p
RF_tg_t_w:
s_barrier
RF_tg_g:
s_mov_b32 s47, 0
RF_ld:
s_mul_i32 s32, s25, 8192
s_add_u32 s32, s32, 73990144
s_add_u32 s33, s32, 0
buffer_load_dwordx4 v[128:131], v127, s[4:7], s33 offen offset:0 sc1
buffer_load_dwordx4 v[144:147], v127, s[4:7], s33 offen offset:256 sc1
s_add_u32 s33, s32, 2048
buffer_load_dwordx4 v[132:135], v127, s[4:7], s33 offen offset:0 sc1
buffer_load_dwordx4 v[148:151], v127, s[4:7], s33 offen offset:256 sc1
s_add_u32 s33, s32, 4096
buffer_load_dwordx4 v[136:139], v127, s[4:7], s33 offen offset:0 sc1
buffer_load_dwordx4 v[152:155], v127, s[4:7], s33 offen offset:256 sc1
s_add_u32 s33, s32, 6144
buffer_load_dwordx4 v[140:143], v123, s[4:7], s33 offen offset:0 sc1
buffer_load_dwordx4 v[156:159], v123, s[4:7], s33 offen offset:256 sc1
s_mul_i32 s32, s25, 28672
s_add_u32 s32, s32, 64815104
s_add_u32 s33, s32, s64
buffer_load_dwordx4 v[36:39], v126, s[4:7], s33 offen sc1
s_add_u32 s33, s32, s65
buffer_load_dwordx4 v[40:43], v126, s[4:7], s33 offen sc1
s_add_u32 s33, s32, s66
buffer_load_dwordx4 v[44:47], v126, s[4:7], s33 offen sc1
s_add_u32 s33, s32, s67
buffer_load_dwordx4 v[48:51], v126, s[4:7], s33 offen sc1
s_add_u32 s33, s32, s68
buffer_load_dwordx4 v[52:55], v126, s[4:7], s33 offen sc1
s_add_u32 s33, s32, s69
buffer_load_dwordx4 v[56:59], v126, s[4:7], s33 offen sc1
s_add_u32 s33, s32, s70
buffer_load_dwordx4 v[60:63], v126, s[4:7], s33 offen sc1
s_waitcnt vmcnt(0)
s_cmp_lt_u32 s25, 60
s_cbranch_scc1 RF_go
v_max_u32 v160, v36, v37
v_max3_u32 v160, v160, v38, v39
v_max3_u32 v160, v160, v40, v41
v_max3_u32 v160, v160, v42, v43
v_max3_u32 v160, v160, v44, v45
v_max3_u32 v160, v160, v46, v47
v_max3_u32 v160, v160, v48, v49
v_max3_u32 v160, v160, v50, v51
v_max3_u32 v160, v160, v52, v53
v_max3_u32 v160, v160, v54, v55
v_max3_u32 v160, v160, v56, v57
v_max3_u32 v160, v160, v58, v59
v_max3_u32 v160, v160, v60, v61
v_max3_u32 v160, v160, v62, v63
v_max3_u32 v160, v160, v128, v129
v_max3_u32 v160, v160, v130, v131
v_max3_u32 v160, v160, v132, v133
v_max3_u32 v160, v160, v134, v135
v_max3_u32 v160, v160, v136, v137
v_max3_u32 v160, v160, v138, v139
v_max3_u32 v160, v160, v140, v141
v_max3_u32 v160, v160, v142, v143
v_max3_u32 v160, v160, v144, v145
v_max3_u32 v160, v160, v146, v147
v_max3_u32 v160, v160, v148, v149
v_max3_u32 v160, v160, v150, v151
v_max3_u32 v160, v160, v152, v153
v_max3_u32 v160, v160, v154, v155
v_max3_u32 v160, v160, v156, v157
v_max3_u32 v160, v160, v158, v159
v_cmp_eq_u32 vcc, -1, v160
s_cbranch_vccz RF_go
s_add_u32 s47, s47, 1
s_cmp_lt_u32 s47, 20000
s_cbranch_scc1 RF_ld
RF_go:
ds_write_b128 v124, v[36:39] offset:0
ds_write_b128 v124, v[40:43] offset:1024
ds_write_b128 v124, v[44:47] offset:2048
ds_write_b128 v124, v[48:51] offset:3072
ds_write_b128 v124, v[52:55] offset:4096
ds_write_b128 v124, v[56:59] offset:5120
ds_write_b128 v124, v[60:63] offset:6144
v_xor_b32 v124, 0x8000, v124
s_waitcnt lgkmcnt(0)
s_barrier
s_mov_b32 s34, s25
ds_read_b128 v[4:7], v125 offset:0
ds_read_b128 v[8:11], v125 offset:14336
ds_read_b128 v[12:15], v125 offset:1024
ds_read_b128 v[16:19], v125 offset:15360
ds_read_b128 v[20:23], v125 offset:2048
ds_read_b128 v[24:27], v125 offset:16384
s_waitcnt lgkmcnt(4)
v_mfma_f32_16x16x32_bf16 v[64:67], a[0:3], v[4:7], 0
v_mfma_f32_16x16x32_bf16 v[68:71], a[0:3], v[8:11], 0
v_mfma_f32_16x16x32_bf16 v[72:75], a[56:59], v[4:7], 0
v_mfma_f32_16x16x32_bf16 v[76:79], a[56:59], v[8:11], 0
ds_read_b128 v[28:31], v125 offset:3072
ds_read_b128 v[32:35], v125 offset:17408
v_mfma_f32_16x16x32_bf16 v[80:83], a[112:115], v[4:7], 0
v_mfma_f32_16x16x32_bf16 v[84:87], a[112:115], v[8:11], 0
v_mfma_f32_16x16x32_bf16 v[88:91], a[168:171], v[4:7], 0
v_mfma_f32_16x16x32_bf16 v[92:95], a[168:171], v[8:11], 0
s_waitcnt lgkmcnt(4)
v_mfma_f32_16x16x32_bf16 v[64:67], a[4:7], v[12:15], v[64:67]
v_mfma_f32_16x16x32_bf16 v[68:71], a[4:7], v[16:19], v[68:71]
v_mfma_f32_16x16x32_bf16 v[72:75], a[60:63], v[12:15], v[72:75]
v_mfma_f32_16x16x32_bf16 v[76:79], a[60:63], v[16:19], v[76:79]
ds_read_b128 v[4:7], v125 offset:4096
ds_read_b128 v[8:11], v125 offset:18432
v_mfma_f32_16x16x32_bf16 v[80:83], a[116:119], v[12:15], v[80:83]
v_mfma_f32_16x16x32_bf16 v[84:87], a[116:119], v[16:19], v[84:87]
v_mfma_f32_16x16x32_bf16 v[88:91], a[172:175], v[12:15], v[88:91]
v_mfma_f32_16x16x32_bf16 v[92:95], a[172:175], v[16:19], v[92:95]
s_waitcnt lgkmcnt(4)
v_mfma_f32_16x16x32_bf16 v[64:67], a[8:11], v[20:23], v[64:67]
v_mfma_f32_16x16x32_bf16 v[68:71], a[8:11], v[24:27], v[68:71]
v_mfma_f32_16x16x32_bf16 v[72:75], a[64:67], v[20:23], v[72:75]
v_mfma_f32_16x16x32_bf16 v[76:79], a[64:67], v[24:27], v[76:79]
ds_read_b128 v[12:15], v125 offset:5120
ds_read_b128 v[16:19], v125 offset:19456
v_mfma_f32_16x16x32_bf16 v[80:83], a[120:123], v[20:23], v[80:83]
v_mfma_f32_16x16x32_bf16 v[84:87], a[120:123], v[24:27], v[84:87]
v_mfma_f32_16x16x32_bf16 v[88:91], a[176:179], v[20:23], v[88:91]
v_mfma_f32_16x16x32_bf16 v[92:95], a[176:179], v[24:27], v[92:95]
s_waitcnt lgkmcnt(4)
v_mfma_f32_16x16x32_bf16 v[64:67], a[12:15], v[28:31], v[64:67]
v_mfma_f32_16x16x32_bf16 v[68:71], a[12:15], v[32:35], v[68:71]
v_mfma_f32_16x16x32_bf16 v[72:75], a[68:71], v[28:31], v[72:75]
v_mfma_f32_16x16x32_bf16 v[76:79], a[68:71], v[32:35], v[76:79]
ds_read_b128 v[20:23], v125 offset:6144
ds_read_b128 v[24:27], v125 offset:20480
v_mfma_f32_16x16x32_bf16 v[80:83], a[124:127], v[28:31], v[80:83]
v_mfma_f32_16x16x32_bf16 v[84:87], a[124:127], v[32:35], v[84:87]
v_mfma_f32_16x16x32_bf16 v[88:91], a[180:183], v[28:31], v[88:91]
v_mfma_f32_16x16x32_bf16 v[92:95], a[180:183], v[32:35], v[92:95]
s_waitcnt lgkmcnt(4)
v_mfma_f32_16x16x32_bf16 v[64:67], a[16:19], v[4:7], v[64:67]
v_mfma_f32_16x16x32_bf16 v[68:71], a[16:19], v[8:11], v[68:71]
v_mfma_f32_16x16x32_bf16 v[72:75], a[72:75], v[4:7], v[72:75]
v_mfma_f32_16x16x32_bf16 v[76:79], a[72:75], v[8:11], v[76:79]
ds_read_b128 v[28:31], v125 offset:7168
ds_read_b128 v[32:35], v125 offset:21504
v_mfma_f32_16x16x32_bf16 v[80:83], a[128:131], v[4:7], v[80:83]
v_mfma_f32_16x16x32_bf16 v[84:87], a[128:131], v[8:11], v[84:87]
v_mfma_f32_16x16x32_bf16 v[88:91], a[184:187], v[4:7], v[88:91]
v_mfma_f32_16x16x32_bf16 v[92:95], a[184:187], v[8:11], v[92:95]
s_waitcnt lgkmcnt(4)
v_mfma_f32_16x16x32_bf16 v[64:67], a[20:23], v[12:15], v[64:67]
v_mfma_f32_16x16x32_bf16 v[68:71], a[20:23], v[16:19], v[68:71]
v_mfma_f32_16x16x32_bf16 v[72:75], a[76:79], v[12:15], v[72:75]
v_mfma_f32_16x16x32_bf16 v[76:79], a[76:79], v[16:19], v[76:79]
ds_read_b128 v[4:7], v125 offset:8192
ds_read_b128 v[8:11], v125 offset:22528
v_mfma_f32_16x16x32_bf16 v[80:83], a[132:135], v[12:15], v[80:83]
v_mfma_f32_16x16x32_bf16 v[84:87], a[132:135], v[16:19], v[84:87]
v_mfma_f32_16x16x32_bf16 v[88:91], a[188:191], v[12:15], v[88:91]
v_mfma_f32_16x16x32_bf16 v[92:95], a[188:191], v[16:19], v[92:95]
s_waitcnt lgkmcnt(4)
v_mfma_f32_16x16x32_bf16 v[64:67], a[24:27], v[20:23], v[64:67]
v_mfma_f32_16x16x32_bf16 v[68:71], a[24:27], v[24:27], v[68:71]
v_mfma_f32_16x16x32_bf16 v[72:75], a[80:83], v[20:23], v[72:75]
v_mfma_f32_16x16x32_bf16 v[76:79], a[80:83], v[24:27], v[76:79]
ds_read_b128 v[12:15], v125 offset:9216
ds_read_b128 v[16:19], v125 offset:23552
v_mfma_f32_16x16x32_bf16 v[80:83], a[136:139], v[20:23], v[80:83]
v_mfma_f32_16x16x32_bf16 v[84:87], a[136:139], v[24:27], v[84:87]
v_mfma_f32_16x16x32_bf16 v[88:91], a[192:195], v[20:23], v[88:91]
v_mfma_f32_16x16x32_bf16 v[92:95], a[192:195], v[24:27], v[92:95]
s_waitcnt lgkmcnt(4)
v_mfma_f32_16x16x32_bf16 v[64:67], a[28:31], v[28:31], v[64:67]
v_mfma_f32_16x16x32_bf16 v[68:71], a[28:31], v[32:35], v[68:71]
v_mfma_f32_16x16x32_bf16 v[72:75], a[84:87], v[28:31], v[72:75]
v_mfma_f32_16x16x32_bf16 v[76:79], a[84:87], v[32:35], v[76:79]
ds_read_b128 v[20:23], v125 offset:10240
ds_read_b128 v[24:27], v125 offset:24576
v_mfma_f32_16x16x32_bf16 v[80:83], a[140:143], v[28:31], v[80:83]
v_mfma_f32_16x16x32_bf16 v[84:87], a[140:143], v[32:35], v[84:87]
v_mfma_f32_16x16x32_bf16 v[88:91], a[196:199], v[28:31], v[88:91]
v_mfma_f32_16x16x32_bf16 v[92:95], a[196:199], v[32:35], v[92:95]
s_waitcnt lgkmcnt(4)
v_mfma_f32_16x16x32_bf16 v[64:67], a[32:35], v[4:7], v[64:67]
v_mfma_f32_16x16x32_bf16 v[68:71], a[32:35], v[8:11], v[68:71]
v_mfma_f32_16x16x32_bf16 v[72:75], a[88:91], v[4:7], v[72:75]
v_mfma_f32_16x16x32_bf16 v[76:79], a[88:91], v[8:11], v[76:79]
ds_read_b128 v[28:31], v125 offset:11264
ds_read_b128 v[32:35], v125 offset:25600
v_mfma_f32_16x16x32_bf16 v[80:83], a[144:147], v[4:7], v[80:83]
v_mfma_f32_16x16x32_bf16 v[84:87], a[144:147], v[8:11], v[84:87]
v_mfma_f32_16x16x32_bf16 v[88:91], a[200:203], v[4:7], v[88:91]
v_mfma_f32_16x16x32_bf16 v[92:95], a[200:203], v[8:11], v[92:95]
s_waitcnt lgkmcnt(4)
v_mfma_f32_16x16x32_bf16 v[64:67], a[36:39], v[12:15], v[64:67]
v_mfma_f32_16x16x32_bf16 v[68:71], a[36:39], v[16:19], v[68:71]
v_mfma_f32_16x16x32_bf16 v[72:75], a[92:95], v[12:15], v[72:75]
v_mfma_f32_16x16x32_bf16 v[76:79], a[92:95], v[16:19], v[76:79]
ds_read_b128 v[4:7], v125 offset:12288
ds_read_b128 v[8:11], v125 offset:26624
v_mfma_f32_16x16x32_bf16 v[80:83], a[148:151], v[12:15], v[80:83]
v_mfma_f32_16x16x32_bf16 v[84:87], a[148:151], v[16:19], v[84:87]
v_mfma_f32_16x16x32_bf16 v[88:91], a[204:207], v[12:15], v[88:91]
v_mfma_f32_16x16x32_bf16 v[92:95], a[204:207], v[16:19], v[92:95]
s_waitcnt lgkmcnt(4)
v_mfma_f32_16x16x32_bf16 v[64:67], a[40:43], v[20:23], v[64:67]
v_mfma_f32_16x16x32_bf16 v[68:71], a[40:43], v[24:27], v[68:71]
v_mfma_f32_16x16x32_bf16 v[72:75], a[96:99], v[20:23], v[72:75]
v_mfma_f32_16x16x32_bf16 v[76:79], a[96:99], v[24:27], v[76:79]
ds_read_b128 v[12:15], v125 offset:13312
ds_read_b128 v[16:19], v125 offset:27648
v_mfma_f32_16x16x32_bf16 v[80:83], a[152:155], v[20:23], v[80:83]
v_mfma_f32_16x16x32_bf16 v[84:87], a[152:155], v[24:27], v[84:87]
v_mfma_f32_16x16x32_bf16 v[88:91], a[208:211], v[20:23], v[88:91]
v_mfma_f32_16x16x32_bf16 v[92:95], a[208:211], v[24:27], v[92:95]
s_waitcnt lgkmcnt(4)
v_mfma_f32_16x16x32_bf16 v[64:67], a[44:47], v[28:31], v[64:67]
v_mfma_f32_16x16x32_bf16 v[68:71], a[44:47], v[32:35], v[68:71]
v_mfma_f32_16x16x32_bf16 v[72:75], a[100:103], v[28:31], v[72:75]
v_mfma_f32_16x16x32_bf16 v[76:79], a[100:103], v[32:35], v[76:79]
v_mfma_f32_16x16x32_bf16 v[80:83], a[156:159], v[28:31], v[80:83]
v_mfma_f32_16x16x32_bf16 v[84:87], a[156:159], v[32:35], v[84:87]
v_mfma_f32_16x16x32_bf16 v[88:91], a[212:215], v[28:31], v[88:91]
v_mfma_f32_16x16x32_bf16 v[92:95], a[212:215], v[32:35], v[92:95]
s_waitcnt lgkmcnt(2)
v_mfma_f32_16x16x32_bf16 v[64:67], a[48:51], v[4:7], v[64:67]
v_mfma_f32_16x16x32_bf16 v[68:71], a[48:51], v[8:11], v[68:71]
v_mfma_f32_16x16x32_bf16 v[72:75], a[104:107], v[4:7], v[72:75]
v_mfma_f32_16x16x32_bf16 v[76:79], a[104:107], v[8:11], v[76:79]
v_mfma_f32_16x16x32_bf16 v[80:83], a[160:163], v[4:7], v[80:83]
v_mfma_f32_16x16x32_bf16 v[84:87], a[160:163], v[8:11], v[84:87]
v_mfma_f32_16x16x32_bf16 v[88:91], a[216:219], v[4:7], v[88:91]
v_mfma_f32_16x16x32_bf16 v[92:95], a[216:219], v[8:11], v[92:95]
s_waitcnt lgkmcnt(0)
v_mfma_f32_16x16x32_bf16 v[64:67], a[52:55], v[12:15], v[64:67]
v_mfma_f32_16x16x32_bf16 v[68:71], a[52:55], v[16:19], v[68:71]
v_mfma_f32_16x16x32_bf16 v[72:75], a[108:111], v[12:15], v[72:75]
v_mfma_f32_16x16x32_bf16 v[76:79], a[108:111], v[16:19], v[76:79]
v_mfma_f32_16x16x32_bf16 v[80:83], a[164:167], v[12:15], v[80:83]
v_mfma_f32_16x16x32_bf16 v[84:87], a[164:167], v[16:19], v[84:87]
v_mfma_f32_16x16x32_bf16 v[88:91], a[220:223], v[12:15], v[88:91]
v_mfma_f32_16x16x32_bf16 v[92:95], a[220:223], v[16:19], v[92:95]
v_xor_b32 v125, 0x8000, v125
v_add_f32 v128, v128, v130
v_add_f32 v129, v129, v131
v_add_f32 v132, v132, v134
v_add_f32 v133, v133, v135
v_add_f32 v136, v136, v138
v_add_f32 v137, v137, v139
v_add_f32 v140, v140, v142
v_add_f32 v141, v141, v143
v_add_f32 v128, v128, v132
v_add_f32 v129, v129, v133
v_add_f32 v128, v128, v136
v_add_f32 v129, v129, v137
v_add_f32 v128, v128, v140
v_add_f32 v129, v129, v141
v_mov_b32 v160, v128
s_nop 1
v_permlane16_swap_b32 v128, v160
v_add_f32 v128, v128, v160
v_mov_b32 v160, v128
s_nop 1
v_permlane32_swap_b32 v128, v160
v_add_f32 v128, v128, v160
v_mov_b32 v160, v129
s_nop 1
v_permlane16_swap_b32 v129, v160
v_add_f32 v129, v129, v160
v_mov_b32 v160, v129
s_nop 1
v_permlane32_swap_b32 v129, v160
v_add_f32 v129, v129, v160
v_mul_f32 v128, 0x3b124925, v128
v_mul_f32 v129, 0x3b124925, v129
v_fma_f32 v129, -v128, v128, v129
v_max_f32 v129, 0, v129
v_add_f32 v129, 0x3727c5ac, v129
v_rsq_f32 v112, v129
s_nop 0
v_mul_f32 v113, v112, v128
v_add_f32 v144, v144, v146
v_add_f32 v145, v145, v147
v_add_f32 v148, v148, v150
v_add_f32 v149, v149, v151
v_add_f32 v152, v152, v154
v_add_f32 v153, v153, v155
v_add_f32 v156, v156, v158
v_add_f32 v157, v157, v159
v_add_f32 v144, v144, v148
v_add_f32 v145, v145, v149
v_add_f32 v144, v144, v152
v_add_f32 v145, v145, v153
v_add_f32 v144, v144, v156
v_add_f32 v145, v145, v157
v_mov_b32 v160, v144
s_nop 1
v_permlane16_swap_b32 v144, v160
v_add_f32 v144, v144, v160
v_mov_b32 v160, v144
s_nop 1
v_permlane32_swap_b32 v144, v160
v_add_f32 v144, v144, v160
v_mov_b32 v160, v145
s_nop 1
v_permlane16_swap_b32 v145, v160
v_add_f32 v145, v145, v160
v_mov_b32 v160, v145
s_nop 1
v_permlane32_swap_b32 v145, v160
v_add_f32 v145, v145, v160
v_mul_f32 v144, 0x3b124925, v144
v_mul_f32 v145, 0x3b124925, v145
v_fma_f32 v145, -v144, v144, v145
v_max_f32 v145, 0, v145
v_add_f32 v145, 0x3727c5ac, v145
v_rsq_f32 v114, v145
s_nop 0
v_mul_f32 v115, v114, v144
s_mul_i32 s35, s34, 114688
s_lshl_b32 s36, s28, 2
s_add_u32 s36, s36, s24
s_lshl_b32 s36, s36, 10
s_add_u32 s35, s35, s36
s_add_u32 s35, s35, 66650112
v_mul_f32 v162, v113, v96
v_fma_f32 v64, v112, v64, -v162
v_mul_f32 v162, v113, v104
v_fma_f32 v80, v112, v80, -v162
v_mul_f32 v163, v113, v97
v_fma_f32 v65, v112, v65, -v163
v_mul_f32 v163, v113, v105
v_fma_f32 v81, v112, v81, -v163
v_mul_f32 v164, v113, v98
v_fma_f32 v66, v112, v66, -v164
v_mul_f32 v164, v113, v106
v_fma_f32 v82, v112, v82, -v164
v_mul_f32 v165, v113, v99
v_fma_f32 v67, v112, v67, -v165
v_mul_f32 v165, v113, v107
v_fma_f32 v83, v112, v83, -v165
v_mul_f32 v162, 0xbfb8aa3b, v64
v_mul_f32 v163, 0xbfb8aa3b, v65
v_mul_f32 v164, 0xbfb8aa3b, v66
v_mul_f32 v165, 0xbfb8aa3b, v67
v_exp_f32 v162, v162
v_exp_f32 v163, v163
v_exp_f32 v164, v164
v_exp_f32 v165, v165
s_nop 0
v_add_f32 v162, 1.0, v162
v_add_f32 v163, 1.0, v163
v_add_f32 v164, 1.0, v164
v_add_f32 v165, 1.0, v165
v_rcp_f32 v162, v162
v_rcp_f32 v163, v163
v_rcp_f32 v164, v164
v_rcp_f32 v165, v165
v_mul_f32 v64, v64, v80
v_mul_f32 v65, v65, v81
v_mul_f32 v66, v66, v82
v_mul_f32 v67, v67, v83
v_mul_f32 v64, v64, v162
v_mul_f32 v65, v65, v163
v_mul_f32 v66, v66, v164
v_mul_f32 v67, v67, v165
v_cvt_pk_bf16_f32 v168, v64, v65
v_cvt_pk_bf16_f32 v169, v66, v67
v_mul_f32 v162, v113, v100
v_fma_f32 v72, v112, v72, -v162
v_mul_f32 v162, v113, v108
v_fma_f32 v88, v112, v88, -v162
v_mul_f32 v163, v113, v101
v_fma_f32 v73, v112, v73, -v163
v_mul_f32 v163, v113, v109
v_fma_f32 v89, v112, v89, -v163
v_mul_f32 v164, v113, v102
v_fma_f32 v74, v112, v74, -v164
v_mul_f32 v164, v113, v110
v_fma_f32 v90, v112, v90, -v164
v_mul_f32 v165, v113, v103
v_fma_f32 v75, v112, v75, -v165
v_mul_f32 v165, v113, v111
v_fma_f32 v91, v112, v91, -v165
v_mul_f32 v162, 0xbfb8aa3b, v72
v_mul_f32 v163, 0xbfb8aa3b, v73
v_mul_f32 v164, 0xbfb8aa3b, v74
v_mul_f32 v165, 0xbfb8aa3b, v75
v_exp_f32 v162, v162
v_exp_f32 v163, v163
v_exp_f32 v164, v164
v_exp_f32 v165, v165
s_nop 0
v_add_f32 v162, 1.0, v162
v_add_f32 v163, 1.0, v163
v_add_f32 v164, 1.0, v164
v_add_f32 v165, 1.0, v165
v_rcp_f32 v162, v162
v_rcp_f32 v163, v163
v_rcp_f32 v164, v164
v_rcp_f32 v165, v165
v_mul_f32 v72, v72, v88
v_mul_f32 v73, v73, v89
v_mul_f32 v74, v74, v90
v_mul_f32 v75, v75, v91
v_mul_f32 v72, v72, v162
v_mul_f32 v73, v73, v163
v_mul_f32 v74, v74, v164
v_mul_f32 v75, v75, v165
v_cvt_pk_bf16_f32 v170, v72, v73
v_cvt_pk_bf16_f32 v171, v74, v75
v_min_u32 v168, 0xfffffffe, v168
v_min_u32 v169, 0xfffffffe, v169
v_min_u32 v170, 0xfffffffe, v170
v_min_u32 v171, 0xfffffffe, v171
buffer_store_dwordx4 v[168:171], v2, s[4:7], s35 offen sc1
v_mul_f32 v162, v115, v96
v_fma_f32 v68, v114, v68, -v162
v_mul_f32 v162, v115, v104
v_fma_f32 v84, v114, v84, -v162
v_mul_f32 v163, v115, v97
v_fma_f32 v69, v114, v69, -v163
v_mul_f32 v163, v115, v105
v_fma_f32 v85, v114, v85, -v163
v_mul_f32 v164, v115, v98
v_fma_f32 v70, v114, v70, -v164
v_mul_f32 v164, v115, v106
v_fma_f32 v86, v114, v86, -v164
v_mul_f32 v165, v115, v99
v_fma_f32 v71, v114, v71, -v165
v_mul_f32 v165, v115, v107
v_fma_f32 v87, v114, v87, -v165
v_mul_f32 v162, 0xbfb8aa3b, v68
v_mul_f32 v163, 0xbfb8aa3b, v69
v_mul_f32 v164, 0xbfb8aa3b, v70
v_mul_f32 v165, 0xbfb8aa3b, v71
v_exp_f32 v162, v162
v_exp_f32 v163, v163
v_exp_f32 v164, v164
v_exp_f32 v165, v165
s_nop 0
v_add_f32 v162, 1.0, v162
v_add_f32 v163, 1.0, v163
v_add_f32 v164, 1.0, v164
v_add_f32 v165, 1.0, v165
v_rcp_f32 v162, v162
v_rcp_f32 v163, v163
v_rcp_f32 v164, v164
v_rcp_f32 v165, v165
v_mul_f32 v68, v68, v84
v_mul_f32 v69, v69, v85
v_mul_f32 v70, v70, v86
v_mul_f32 v71, v71, v87
v_mul_f32 v68, v68, v162
v_mul_f32 v69, v69, v163
v_mul_f32 v70, v70, v164
v_mul_f32 v71, v71, v165
v_cvt_pk_bf16_f32 v172, v68, v69
v_cvt_pk_bf16_f32 v173, v70, v71
v_mul_f32 v162, v115, v100
v_fma_f32 v76, v114, v76, -v162
v_mul_f32 v162, v115, v108
v_fma_f32 v92, v114, v92, -v162
v_mul_f32 v163, v115, v101
v_fma_f32 v77, v114, v77, -v163
v_mul_f32 v163, v115, v109
v_fma_f32 v93, v114, v93, -v163
v_mul_f32 v164, v115, v102
v_fma_f32 v78, v114, v78, -v164
v_mul_f32 v164, v115, v110
v_fma_f32 v94, v114, v94, -v164
v_mul_f32 v165, v115, v103
v_fma_f32 v79, v114, v79, -v165
v_mul_f32 v165, v115, v111
v_fma_f32 v95, v114, v95, -v165
v_mul_f32 v162, 0xbfb8aa3b, v76
v_mul_f32 v163, 0xbfb8aa3b, v77
v_mul_f32 v164, 0xbfb8aa3b, v78
v_mul_f32 v165, 0xbfb8aa3b, v79
v_exp_f32 v162, v162
v_exp_f32 v163, v163
v_exp_f32 v164, v164
v_exp_f32 v165, v165
s_nop 0
v_add_f32 v162, 1.0, v162
v_add_f32 v163, 1.0, v163
v_add_f32 v164, 1.0, v164
v_add_f32 v165, 1.0, v165
v_rcp_f32 v162, v162
v_rcp_f32 v163, v163
v_rcp_f32 v164, v164
v_rcp_f32 v165, v165
v_mul_f32 v76, v76, v92
v_mul_f32 v77, v77, v93
v_mul_f32 v78, v78, v94
v_mul_f32 v79, v79, v95
v_mul_f32 v76, v76, v162
v_mul_f32 v77, v77, v163
v_mul_f32 v78, v78, v164
v_mul_f32 v79, v79, v165
v_cvt_pk_bf16_f32 v174, v76, v77
v_cvt_pk_bf16_f32 v175, v78, v79
v_min_u32 v172, 0xfffffffe, v172
v_min_u32 v173, 0xfffffffe, v173
v_min_u32 v174, 0xfffffffe, v174
v_min_u32 v175, 0xfffffffe, v175
s_add_u32 s35, s35, 57344
buffer_store_dwordx4 v[172:175], v2, s[4:7], s35 offen sc1
s_mov_b32 s45, 1
s_add_u32 s25, s25, 3
s_cmp_lt_u32 s25, 60
s_cbranch_scc1 RF_loop
s_waitcnt vmcnt(0)
s_barrier
s_cmp_lg_u32 s24, 0
s_cbranch_scc1 RF_sig_s
s_lshl_b32 s46, s34, 7
s_add_u32 s46, s46, 74997888
v_mov_b32 v160, s46
v_mov_b32 v161, 1
s_mov_b64 exec, 1
buffer_atomic_add v161, v160, s[4:7], 0 offen
s_mov_b64 exec, -1
RF_sig_s:
s_sub_u32 s37, s25, 3
s_mul_i32 s29, s37, 21846
s_lshr_b32 s29, s29, 16
s_mul_i32 s30, s29, 3
s_sub_u32 s30, s37, s30
s_mov_b32 s37, s30
v_mov_b32 v48, 0
v_mov_b32 v49, 0
v_mov_b32 v50, 0
v_mov_b32 v51, 0
RF_tl:
s_lshr_b32 s25, s37, 1
s_add_u32 s25, s25, 60
s_and_b32 s38, s37, 1
s_mov_b32 s47, 0
RF_tld:
s_mul_i32 s32, s25, 8192
s_lshl_b32 s33, s38, 8
s_add_u32 s32, s32, s33
s_add_u32 s32, s32, 73990144
s_add_u32 s31, s32, 0
buffer_load_dwordx4 v[128:131], v127, s[4:7], s31 offen sc1
s_add_u32 s31, s32, 2048
buffer_load_dwordx4 v[132:135], v127, s[4:7], s31 offen sc1
s_add_u32 s31, s32, 4096
buffer_load_dwordx4 v[136:139], v127, s[4:7], s31 offen sc1
s_add_u32 s31, s32, 6144
buffer_load_dwordx4 v[140:143], v123, s[4:7], s31 offen sc1
s_mul_i32 s32, s25, 28672
s_add_u32 s32, s32, s33
s_lshl_b32 s33, s24, 11
s_add_u32 s32, s32, s33
s_add_u32 s32, s32, 64815104
s_add_u32 s31, s32, 0
buffer_load_dwordx4 v[36:39], v126, s[4:7], s31 offen sc1
s_add_u32 s31, s32, 8192
buffer_load_dwordx4 v[40:43], v126, s[4:7], s31 offen sc1
s_add_u32 s31, s32, 16384
buffer_load_dwordx4 v[44:47], v126, s[4:7], s31 offen sc1
s_cmp_lt_u32 s24, 2
s_cbranch_scc0 RF_t3
s_add_u32 s31, s32, 24576
buffer_load_dwordx4 v[48:51], v126, s[4:7], s31 offen sc1
RF_t3:
s_waitcnt vmcnt(0)
v_max_u32 v160, v36, v37
v_max3_u32 v160, v160, v38, v39
v_max3_u32 v160, v160, v40, v41
v_max3_u32 v160, v160, v42, v43
v_max3_u32 v160, v160, v44, v45
v_max3_u32 v160, v160, v46, v47
v_max3_u32 v160, v160, v48, v49
v_max3_u32 v160, v160, v50, v51
v_max3_u32 v160, v160, v128, v129
v_max3_u32 v160, v160, v130, v131
v_max3_u32 v160, v160, v132, v133
v_max3_u32 v160, v160, v134, v135
v_max3_u32 v160, v160, v136, v137
v_max3_u32 v160, v160, v138, v139
v_max3_u32 v160, v160, v140, v141
v_max3_u32 v160, v160, v142, v143
v_cmp_eq_u32 vcc, -1, v160
s_cbranch_vccz RF_tgo
s_add_u32 s47, s47, 1
s_cmp_lt_u32 s47, 20000
s_cbranch_scc1 RF_tld
RF_tgo:
s_and_b32 s31, s37, 1
s_lshl_b32 s31, s31, 14
s_add_u32 s31, s31, 65536
v_add_u32 v161, s31, v2
s_lshl_b32 s33, s24, 10
v_add_u32 v160, s33, v161
ds_write_b128 v160, v[36:39] offset:0
ds_write_b128 v160, v[40:43] offset:4096
ds_write_b128 v160, v[44:47] offset:8192
ds_write_b128 v160, v[48:51] offset:12288
s_waitcnt lgkmcnt(0)
s_barrier
ds_read_b128 v[176:179], v161 offset:0
ds_read_b128 v[180:183], v161 offset:1024
ds_read_b128 v[184:187], v161 offset:2048
ds_read_b128 v[188:191], v161 offset:3072
ds_read_b128 v[192:195], v161 offset:4096
ds_read_b128 v[196:199], v161 offset:5120
ds_read_b128 v[200:203], v161 offset:6144
ds_read_b128 v[204:207], v161 offset:7168
ds_read_b128 v[208:211], v161 offset:8192
ds_read_b128 v[212:215], v161 offset:9216
ds_read_b128 v[216:219], v161 offset:10240
ds_read_b128 v[220:223], v161 offset:11264
ds_read_b128 v[224:227], v161 offset:12288
ds_read_b128 v[228:231], v161 offset:13312
s_waitcnt lgkmcnt(13)
v_mfma_f32_16x16x32_bf16 v[64:67], a[0:3], v[176:179], 0
v_mfma_f32_16x16x32_bf16 v[68:71], a[56:59], v[176:179], 0
v_mfma_f32_16x16x32_bf16 v[72:75], a[112:115], v[176:179], 0
v_mfma_f32_16x16x32_bf16 v[76:79], a[168:171], v[176:179], 0
s_waitcnt lgkmcnt(12)
v_mfma_f32_16x16x32_bf16 v[64:67], a[4:7], v[180:183], v[64:67]
v_mfma_f32_16x16x32_bf16 v[68:71], a[60:63], v[180:183], v[68:71]
v_mfma_f32_16x16x32_bf16 v[72:75], a[116:119], v[180:183], v[72:75]
v_mfma_f32_16x16x32_bf16 v[76:79], a[172:175], v[180:183], v[76:79]
s_waitcnt lgkmcnt(11)
v_mfma_f32_16x16x32_bf16 v[64:67], a[8:11], v[184:187], v[64:67]
v_mfma_f32_16x16x32_bf16 v[68:71], a[64:67], v[184:187], v[68:71]
v_mfma_f32_16x16x32_bf16 v[72:75], a[120:123], v[184:187], v[72:75]
v_mfma_f32_16x16x32_bf16 v[76:79], a[176:179], v[184:187], v[76:79]
s_waitcnt lgkmcnt(10)
v_mfma_f32_16x16x32_bf16 v[64:67], a[12:15], v[188:191], v[64:67]
v_mfma_f32_16x16x32_bf16 v[68:71], a[68:71], v[188:191], v[68:71]
v_mfma_f32_16x16x32_bf16 v[72:75], a[124:127], v[188:191], v[72:75]
v_mfma_f32_16x16x32_bf16 v[76:79], a[180:183], v[188:191], v[76:79]
s_waitcnt lgkmcnt(9)
v_mfma_f32_16x16x32_bf16 v[64:67], a[16:19], v[192:195], v[64:67]
v_mfma_f32_16x16x32_bf16 v[68:71], a[72:75], v[192:195], v[68:71]
v_mfma_f32_16x16x32_bf16 v[72:75], a[128:131], v[192:195], v[72:75]
v_mfma_f32_16x16x32_bf16 v[76:79], a[184:187], v[192:195], v[76:79]
s_waitcnt lgkmcnt(8)
v_mfma_f32_16x16x32_bf16 v[64:67], a[20:23], v[196:199], v[64:67]
v_mfma_f32_16x16x32_bf16 v[68:71], a[76:79], v[196:199], v[68:71]
v_mfma_f32_16x16x32_bf16 v[72:75], a[132:135], v[196:199], v[72:75]
v_mfma_f32_16x16x32_bf16 v[76:79], a[188:191], v[196:199], v[76:79]
s_waitcnt lgkmcnt(7)
v_mfma_f32_16x16x32_bf16 v[64:67], a[24:27], v[200:203], v[64:67]
v_mfma_f32_16x16x32_bf16 v[68:71], a[80:83], v[200:203], v[68:71]
v_mfma_f32_16x16x32_bf16 v[72:75], a[136:139], v[200:203], v[72:75]
v_mfma_f32_16x16x32_bf16 v[76:79], a[192:195], v[200:203], v[76:79]
s_waitcnt lgkmcnt(6)
v_mfma_f32_16x16x32_bf16 v[64:67], a[28:31], v[204:207], v[64:67]
v_mfma_f32_16x16x32_bf16 v[68:71], a[84:87], v[204:207], v[68:71]
v_mfma_f32_16x16x32_bf16 v[72:75], a[140:143], v[204:207], v[72:75]
v_mfma_f32_16x16x32_bf16 v[76:79], a[196:199], v[204:207], v[76:79]
s_waitcnt lgkmcnt(5)
v_mfma_f32_16x16x32_bf16 v[64:67], a[32:35], v[208:211], v[64:67]
v_mfma_f32_16x16x32_bf16 v[68:71], a[88:91], v[208:211], v[68:71]
v_mfma_f32_16x16x32_bf16 v[72:75], a[144:147], v[208:211], v[72:75]
v_mfma_f32_16x16x32_bf16 v[76:79], a[200:203], v[208:211], v[76:79]
s_waitcnt lgkmcnt(4)
v_mfma_f32_16x16x32_bf16 v[64:67], a[36:39], v[212:215], v[64:67]
v_mfma_f32_16x16x32_bf16 v[68:71], a[92:95], v[212:215], v[68:71]
v_mfma_f32_16x16x32_bf16 v[72:75], a[148:151], v[212:215], v[72:75]
v_mfma_f32_16x16x32_bf16 v[76:79], a[204:207], v[212:215], v[76:79]
s_waitcnt lgkmcnt(3)
v_mfma_f32_16x16x32_bf16 v[64:67], a[40:43], v[216:219], v[64:67]
v_mfma_f32_16x16x32_bf16 v[68:71], a[96:99], v[216:219], v[68:71]
v_mfma_f32_16x16x32_bf16 v[72:75], a[152:155], v[216:219], v[72:75]
v_mfma_f32_16x16x32_bf16 v[76:79], a[208:211], v[216:219], v[76:79]
s_waitcnt lgkmcnt(2)
v_mfma_f32_16x16x32_bf16 v[64:67], a[44:47], v[220:223], v[64:67]
v_mfma_f32_16x16x32_bf16 v[68:71], a[100:103], v[220:223], v[68:71]
v_mfma_f32_16x16x32_bf16 v[72:75], a[156:159], v[220:223], v[72:75]
v_mfma_f32_16x16x32_bf16 v[76:79], a[212:215], v[220:223], v[76:79]
s_waitcnt lgkmcnt(1)
v_mfma_f32_16x16x32_bf16 v[64:67], a[48:51], v[224:227], v[64:67]
v_mfma_f32_16x16x32_bf16 v[68:71], a[104:107], v[224:227], v[68:71]
v_mfma_f32_16x16x32_bf16 v[72:75], a[160:163], v[224:227], v[72:75]
v_mfma_f32_16x16x32_bf16 v[76:79], a[216:219], v[224:227], v[76:79]
s_waitcnt lgkmcnt(0)
v_mfma_f32_16x16x32_bf16 v[64:67], a[52:55], v[228:231], v[64:67]
v_mfma_f32_16x16x32_bf16 v[68:71], a[108:111], v[228:231], v[68:71]
v_mfma_f32_16x16x32_bf16 v[72:75], a[164:167], v[228:231], v[72:75]
v_mfma_f32_16x16x32_bf16 v[76:79], a[220:223], v[228:231], v[76:79]
v_add_f32 v128, v128, v130
v_add_f32 v129, v129, v131
v_add_f32 v132, v132, v134
v_add_f32 v133, v133, v135
v_add_f32 v136, v136, v138
v_add_f32 v137, v137, v139
v_add_f32 v140, v140, v142
v_add_f32 v141, v141, v143
v_add_f32 v128, v128, v132
v_add_f32 v129, v129, v133
v_add_f32 v128, v128, v136
v_add_f32 v129, v129, v137
v_add_f32 v128, v128, v140
v_add_f32 v129, v129, v141
v_mov_b32 v160, v128
s_nop 1
v_permlane16_swap_b32 v128, v160
v_add_f32 v128, v128, v160
v_mov_b32 v160, v128
s_nop 1
v_permlane32_swap_b32 v128, v160
v_add_f32 v128, v128, v160
v_mov_b32 v160, v129
s_nop 1
v_permlane16_swap_b32 v129, v160
v_add_f32 v129, v129, v160
v_mov_b32 v160, v129
s_nop 1
v_permlane32_swap_b32 v129, v160
v_add_f32 v129, v129, v160
v_mul_f32 v128, 0x3b124925, v128
v_mul_f32 v129, 0x3b124925, v129
v_fma_f32 v129, -v128, v128, v129
v_max_f32 v129, 0, v129
v_add_f32 v129, 0x3727c5ac, v129
v_rsq_f32 v112, v129
s_nop 0
v_mul_f32 v113, v112, v128
v_mul_f32 v162, v113, v96
v_fma_f32 v64, v112, v64, -v162
v_mul_f32 v162, v113, v104
v_fma_f32 v72, v112, v72, -v162
v_mul_f32 v163, v113, v97
v_fma_f32 v65, v112, v65, -v163
v_mul_f32 v163, v113, v105
v_fma_f32 v73, v112, v73, -v163
v_mul_f32 v164, v113, v98
v_fma_f32 v66, v112, v66, -v164
v_mul_f32 v164, v113, v106
v_fma_f32 v74, v112, v74, -v164
v_mul_f32 v165, v113, v99
v_fma_f32 v67, v112, v67, -v165
v_mul_f32 v165, v113, v107
v_fma_f32 v75, v112, v75, -v165
v_mul_f32 v162, 0xbfb8aa3b, v64
v_mul_f32 v163, 0xbfb8aa3b, v65
v_mul_f32 v164, 0xbfb8aa3b, v66
v_mul_f32 v165, 0xbfb8aa3b, v67
v_exp_f32 v162, v162
v_exp_f32 v163, v163
v_exp_f32 v164, v164
v_exp_f32 v165, v165
s_nop 0
v_add_f32 v162, 1.0, v162
v_add_f32 v163, 1.0, v163
v_add_f32 v164, 1.0, v164
v_add_f32 v165, 1.0, v165
v_rcp_f32 v162, v162
v_rcp_f32 v163, v163
v_rcp_f32 v164, v164
v_rcp_f32 v165, v165
v_mul_f32 v64, v64, v72
v_mul_f32 v65, v65, v73
v_mul_f32 v66, v66, v74
v_mul_f32 v67, v67, v75
v_mul_f32 v64, v64, v162
v_mul_f32 v65, v65, v163
v_mul_f32 v66, v66, v164
v_mul_f32 v67, v67, v165
v_cvt_pk_bf16_f32 v168, v64, v65
v_cvt_pk_bf16_f32 v169, v66, v67
v_mul_f32 v162, v113, v100
v_fma_f32 v68, v112, v68, -v162
v_mul_f32 v162, v113, v108
v_fma_f32 v76, v112, v76, -v162
v_mul_f32 v163, v113, v101
v_fma_f32 v69, v112, v69, -v163
v_mul_f32 v163, v113, v109
v_fma_f32 v77, v112, v77, -v163
v_mul_f32 v164, v113, v102
v_fma_f32 v70, v112, v70, -v164
v_mul_f32 v164, v113, v110
v_fma_f32 v78, v112, v78, -v164
v_mul_f32 v165, v113, v103
v_fma_f32 v71, v112, v71, -v165
v_mul_f32 v165, v113, v111
v_fma_f32 v79, v112, v79, -v165
v_mul_f32 v162, 0xbfb8aa3b, v68
v_mul_f32 v163, 0xbfb8aa3b, v69
v_mul_f32 v164, 0xbfb8aa3b, v70
v_mul_f32 v165, 0xbfb8aa3b, v71
v_exp_f32 v162, v162
v_exp_f32 v163, v163
v_exp_f32 v164, v164
v_exp_f32 v165, v165
s_nop 0
v_add_f32 v162, 1.0, v162
v_add_f32 v163, 1.0, v163
v_add_f32 v164, 1.0, v164
v_add_f32 v165, 1.0, v165
v_rcp_f32 v162, v162
v_rcp_f32 v163, v163
v_rcp_f32 v164, v164
v_rcp_f32 v165, v165
v_mul_f32 v68, v68, v76
v_mul_f32 v69, v69, v77
v_mul_f32 v70, v70, v78
v_mul_f32 v71, v71, v79
v_mul_f32 v68, v68, v162
v_mul_f32 v69, v69, v163
v_mul_f32 v70, v70, v164
v_mul_f32 v71, v71, v165
v_cvt_pk_bf16_f32 v170, v68, v69
v_cvt_pk_bf16_f32 v171, v70, v71
v_min_u32 v168, 0xfffffffe, v168
v_min_u32 v169, 0xfffffffe, v169
v_min_u32 v170, 0xfffffffe, v170
v_min_u32 v171, 0xfffffffe, v171
s_mul_i32 s35, s25, 114688
s_lshl_b32 s36, s28, 2
s_add_u32 s36, s36, s24
s_lshl_b32 s36, s36, 10
s_add_u32 s35, s35, s36
s_mul_i32 s36, s38, 57344
s_add_u32 s35, s35, s36
s_add_u32 s35, s35, 66650112
buffer_store_dwordx4 v[168:171], v2, s[4:7], s35 offen sc1
s_add_u32 s37, s37, 3
s_cmp_lt_u32 s37, 8
s_cbranch_scc1 RF_tl
s_branch L_exit
L_F2:
s_sub_u32 s22, s22, 126
s_load_dwordx2 s[8:9], s[0:1], 80
s_load_dwordx2 s[12:13], s[0:1], 88
s_mul_i32 s25, s22, 9363
s_lshr_b32 s25, s25, 16
s_mul_i32 s28, s25, 7
s_sub_u32 s28, s22, s28
s_waitcnt lgkmcnt(0)
s_and_b32 s9, s9, 0xffff
s_mov_b32 s10, 1605632
s_mov_b32 s11, 0x20000
s_and_b32 s13, s13, 0xffff
s_mov_b32 s14, 1835008
s_mov_b32 s15, 0x20000
v_lshrrev_b32 v3, 3, v1
v_mul_u32_u24 v3, 896, v3
v_and_b32 v6, 7, v1
v_lshl_add_u32 v3, v6, 4, v3
s_mul_i32 s29, s24, 28672
v_add_u32 v4, s29, v2
v_lshrrev_b32 v6, 4, v1
v_lshlrev_b32 v6, 2, v6
v_bfe_u32 v7, v1, 2, 2
v_add_u32 v6, v6, v7
v_lshlrev_b32 v6, 7, v6
v_and_b32 v7, 3, v1
v_lshl_add_u32 v6, v7, 3, v6
v_add_u32 v5, s29, v6
s_mul_i32 s30, s24, 401408
s_lshl_b32 s31, s28, 7
s_add_u32 s30, s30, s31
s_add_u32 s31, s30, 0
buffer_load_dwordx4 v[8:11], v3, s[8:11], s31 offen
s_add_u32 s31, s30, 7168
buffer_load_dwordx4 v[12:15], v3, s[8:11], s31 offen
s_add_u32 s31, s30, 14336
buffer_load_dwordx4 v[16:19], v3, s[8:11], s31 offen
s_add_u32 s31, s30, 21504
buffer_load_dwordx4 v[20:23], v3, s[8:11], s31 offen
s_add_u32 s31, s30, 28672
buffer_load_dwordx4 v[24:27], v3, s[8:11], s31 offen
s_add_u32 s31, s30, 35840
buffer_load_dwordx4 v[28:31], v3, s[8:11], s31 offen
s_add_u32 s31, s30, 43008
buffer_load_dwordx4 v[32:35], v3, s[8:11], s31 offen
s_add_u32 s31, s30, 50176
buffer_load_dwordx4 v[36:39], v3, s[8:11], s31 offen
s_add_u32 s31, s30, 57344
buffer_load_dwordx4 v[40:43], v3, s[8:11], s31 offen
s_add_u32 s31, s30, 64512
buffer_load_dwordx4 v[44:47], v3, s[8:11], s31 offen
s_add_u32 s31, s30, 71680
buffer_load_dwordx4 v[48:51], v3, s[8:11], s31 offen
s_add_u32 s31, s30, 78848
buffer_load_dwordx4 v[52:55], v3, s[8:11], s31 offen
s_add_u32 s31, s30, 86016
buffer_load_dwordx4 v[56:59], v3, s[8:11], s31 offen
s_add_u32 s31, s30, 93184
buffer_load_dwordx4 v[60:63], v3, s[8:11], s31 offen
s_add_u32 s31, s30, 100352
buffer_load_dwordx4 v[64:67], v3, s[8:11], s31 offen
s_add_u32 s31, s30, 107520
buffer_load_dwordx4 v[68:71], v3, s[8:11], s31 offen
s_add_u32 s31, s30, 114688
buffer_load_dwordx4 v[72:75], v3, s[8:11], s31 offen
s_add_u32 s31, s30, 121856
buffer_load_dwordx4 v[76:79], v3, s[8:11], s31 offen
s_add_u32 s31, s30, 129024
buffer_load_dwordx4 v[80:83], v3, s[8:11], s31 offen
s_add_u32 s31, s30, 136192
buffer_load_dwordx4 v[84:87], v3, s[8:11], s31 offen
s_add_u32 s31, s30, 143360
buffer_load_dwordx4 v[88:91], v3, s[8:11], s31 offen
s_add_u32 s31, s30, 150528
buffer_load_dwordx4 v[92:95], v3, s[8:11], s31 offen
s_add_u32 s31, s30, 157696
buffer_load_dwordx4 v[96:99], v3, s[8:11], s31 offen
s_add_u32 s31, s30, 164864
buffer_load_dwordx4 v[100:103], v3, s[8:11], s31 offen
s_add_u32 s31, s30, 172032
buffer_load_dwordx4 v[104:107], v3, s[8:11], s31 offen
s_add_u32 s31, s30, 179200
buffer_load_dwordx4 v[108:111], v3, s[8:11], s31 offen
s_add_u32 s31, s30, 186368
buffer_load_dwordx4 v[112:115], v3, s[8:11], s31 offen
s_add_u32 s31, s30, 193536
buffer_load_dwordx4 v[116:119], v3, s[8:11], s31 offen
s_waitcnt vmcnt(0)
ds_write_b128 v4, v[8:11] offset:0
ds_write_b128 v4, v[12:15] offset:1024
ds_write_b128 v4, v[16:19] offset:2048
ds_write_b128 v4, v[20:23] offset:3072
ds_write_b128 v4, v[24:27] offset:4096
ds_write_b128 v4, v[28:31] offset:5120
ds_write_b128 v4, v[32:35] offset:6144
ds_write_b128 v4, v[36:39] offset:7168
ds_write_b128 v4, v[40:43] offset:8192
ds_write_b128 v4, v[44:47] offset:9216
ds_write_b128 v4, v[48:51] offset:10240
ds_write_b128 v4, v[52:55] offset:11264
ds_write_b128 v4, v[56:59] offset:12288
ds_write_b128 v4, v[60:63] offset:13312
ds_write_b128 v4, v[64:67] offset:14336
ds_write_b128 v4, v[68:71] offset:15360
ds_write_b128 v4, v[72:75] offset:16384
ds_write_b128 v4, v[76:79] offset:17408
ds_write_b128 v4, v[80:83] offset:18432
ds_write_b128 v4, v[84:87] offset:19456
ds_write_b128 v4, v[88:91] offset:20480
ds_write_b128 v4, v[92:95] offset:21504
ds_write_b128 v4, v[96:99] offset:22528
ds_write_b128 v4, v[100:103] offset:23552
ds_write_b128 v4, v[104:107] offset:24576
ds_write_b128 v4, v[108:111] offset:25600
ds_write_b128 v4, v[112:115] offset:26624
ds_write_b128 v4, v[116:119] offset:27648
s_waitcnt lgkmcnt(0)
ds_read_b64_tr_b16 a[0:1], v5 offset:0
ds_read_b64_tr_b16 a[2:3], v5 offset:2048
ds_read_b64_tr_b16 a[4:5], v5 offset:4096
ds_read_b64_tr_b16 a[6:7], v5 offset:6144
ds_read_b64_tr_b16 a[8:9], v5 offset:8192
ds_read_b64_tr_b16 a[10:11], v5 offset:10240
ds_read_b64_tr_b16 a[12:13], v5 offset:12288
ds_read_b64_tr_b16 a[14:15], v5 offset:14336
ds_read_b64_tr_b16 a[16:17], v5 offset:16384
ds_read_b64_tr_b16 a[18:19], v5 offset:18432
ds_read_b64_tr_b16 a[20:21], v5 offset:20480
ds_read_b64_tr_b16 a[22:23], v5 offset:22528
ds_read_b64_tr_b16 a[24:25], v5 offset:24576
ds_read_b64_tr_b16 a[26:27], v5 offset:26624
s_waitcnt lgkmcnt(0)
ds_read_b64_tr_b16 a[56:57], v5 offset:32
ds_read_b64_tr_b16 a[58:59], v5 offset:2080
ds_read_b64_tr_b16 a[60:61], v5 offset:4128
ds_read_b64_tr_b16 a[62:63], v5 offset:6176
ds_read_b64_tr_b16 a[64:65], v5 offset:8224
ds_read_b64_tr_b16 a[66:67], v5 offset:10272
ds_read_b64_tr_b16 a[68:69], v5 offset:12320
ds_read_b64_tr_b16 a[70:71], v5 offset:14368
ds_read_b64_tr_b16 a[72:73], v5 offset:16416
ds_read_b64_tr_b16 a[74:75], v5 offset:18464
ds_read_b64_tr_b16 a[76:77], v5 offset:20512
ds_read_b64_tr_b16 a[78:79], v5 offset:22560
ds_read_b64_tr_b16 a[80:81], v5 offset:24608
ds_read_b64_tr_b16 a[82:83], v5 offset:26656
s_waitcnt lgkmcnt(0)
ds_read_b64_tr_b16 a[112:113], v5 offset:64
ds_read_b64_tr_b16 a[114:115], v5 offset:2112
ds_read_b64_tr_b16 a[116:117], v5 offset:4160
ds_read_b64_tr_b16 a[118:119], v5 offset:6208
ds_read_b64_tr_b16 a[120:121], v5 offset:8256
ds_read_b64_tr_b16 a[122:123], v5 offset:10304
ds_read_b64_tr_b16 a[124:125], v5 offset:12352
ds_read_b64_tr_b16 a[126:127], v5 offset:14400
ds_read_b64_tr_b16 a[128:129], v5 offset:16448
ds_read_b64_tr_b16 a[130:131], v5 offset:18496
ds_read_b64_tr_b16 a[132:133], v5 offset:20544
ds_read_b64_tr_b16 a[134:135], v5 offset:22592
ds_read_b64_tr_b16 a[136:137], v5 offset:24640
ds_read_b64_tr_b16 a[138:139], v5 offset:26688
s_waitcnt lgkmcnt(0)
ds_read_b64_tr_b16 a[168:169], v5 offset:96
ds_read_b64_tr_b16 a[170:171], v5 offset:2144
ds_read_b64_tr_b16 a[172:173], v5 offset:4192
ds_read_b64_tr_b16 a[174:175], v5 offset:6240
ds_read_b64_tr_b16 a[176:177], v5 offset:8288
ds_read_b64_tr_b16 a[178:179], v5 offset:10336
ds_read_b64_tr_b16 a[180:181], v5 offset:12384
ds_read_b64_tr_b16 a[182:183], v5 offset:14432
ds_read_b64_tr_b16 a[184:185], v5 offset:16480
ds_read_b64_tr_b16 a[186:187], v5 offset:18528
ds_read_b64_tr_b16 a[188:189], v5 offset:20576
ds_read_b64_tr_b16 a[190:191], v5 offset:22624
ds_read_b64_tr_b16 a[192:193], v5 offset:24672
ds_read_b64_tr_b16 a[194:195], v5 offset:26720
s_waitcnt lgkmcnt(0)
s_add_u32 s31, s30, 200704
buffer_load_dwordx4 v[8:11], v3, s[8:11], s31 offen
s_add_u32 s31, s30, 207872
buffer_load_dwordx4 v[12:15], v3, s[8:11], s31 offen
s_add_u32 s31, s30, 215040
buffer_load_dwordx4 v[16:19], v3, s[8:11], s31 offen
s_add_u32 s31, s30, 222208
buffer_load_dwordx4 v[20:23], v3, s[8:11], s31 offen
s_add_u32 s31, s30, 229376
buffer_load_dwordx4 v[24:27], v3, s[8:11], s31 offen
s_add_u32 s31, s30, 236544
buffer_load_dwordx4 v[28:31], v3, s[8:11], s31 offen
s_add_u32 s31, s30, 243712
buffer_load_dwordx4 v[32:35], v3, s[8:11], s31 offen
s_add_u32 s31, s30, 250880
buffer_load_dwordx4 v[36:39], v3, s[8:11], s31 offen
s_add_u32 s31, s30, 258048
buffer_load_dwordx4 v[40:43], v3, s[8:11], s31 offen
s_add_u32 s31, s30, 265216
buffer_load_dwordx4 v[44:47], v3, s[8:11], s31 offen
s_add_u32 s31, s30, 272384
buffer_load_dwordx4 v[48:51], v3, s[8:11], s31 offen
s_add_u32 s31, s30, 279552
buffer_load_dwordx4 v[52:55], v3, s[8:11], s31 offen
s_add_u32 s31, s30, 286720
buffer_load_dwordx4 v[56:59], v3, s[8:11], s31 offen
s_add_u32 s31, s30, 293888
buffer_load_dwordx4 v[60:63], v3, s[8:11], s31 offen
s_add_u32 s31, s30, 301056
buffer_load_dwordx4 v[64:67], v3, s[8:11], s31 offen
s_add_u32 s31, s30, 308224
buffer_load_dwordx4 v[68:71], v3, s[8:11], s31 offen
s_add_u32 s31, s30, 315392
buffer_load_dwordx4 v[72:75], v3, s[8:11], s31 offen
s_add_u32 s31, s30, 322560
buffer_load_dwordx4 v[76:79], v3, s[8:11], s31 offen
s_add_u32 s31, s30, 329728
buffer_load_dwordx4 v[80:83], v3, s[8:11], s31 offen
s_add_u32 s31, s30, 336896
buffer_load_dwordx4 v[84:87], v3, s[8:11], s31 offen
s_add_u32 s31, s30, 344064
buffer_load_dwordx4 v[88:91], v3, s[8:11], s31 offen
s_add_u32 s31, s30, 351232
buffer_load_dwordx4 v[92:95], v3, s[8:11], s31 offen
s_add_u32 s31, s30, 358400
buffer_load_dwordx4 v[96:99], v3, s[8:11], s31 offen
s_add_u32 s31, s30, 365568
buffer_load_dwordx4 v[100:103], v3, s[8:11], s31 offen
s_add_u32 s31, s30, 372736
buffer_load_dwordx4 v[104:107], v3, s[8:11], s31 offen
s_add_u32 s31, s30, 379904
buffer_load_dwordx4 v[108:111], v3, s[8:11], s31 offen
s_add_u32 s31, s30, 387072
buffer_load_dwordx4 v[112:115], v3, s[8:11], s31 offen
s_add_u32 s31, s30, 394240
buffer_load_dwordx4 v[116:119], v3, s[8:11], s31 offen
s_waitcnt vmcnt(0)
ds_write_b128 v4, v[8:11] offset:0
ds_write_b128 v4, v[12:15] offset:1024
ds_write_b128 v4, v[16:19] offset:2048
ds_write_b128 v4, v[20:23] offset:3072
ds_write_b128 v4, v[24:27] offset:4096
ds_write_b128 v4, v[28:31] offset:5120
ds_write_b128 v4, v[32:35] offset:6144
ds_write_b128 v4, v[36:39] offset:7168
ds_write_b128 v4, v[40:43] offset:8192
ds_write_b128 v4, v[44:47] offset:9216
ds_write_b128 v4, v[48:51] offset:10240
ds_write_b128 v4, v[52:55] offset:11264
ds_write_b128 v4, v[56:59] offset:12288
ds_write_b128 v4, v[60:63] offset:13312
ds_write_b128 v4, v[64:67] offset:14336
ds_write_b128 v4, v[68:71] offset:15360
ds_write_b128 v4, v[72:75] offset:16384
ds_write_b128 v4, v[76:79] offset:17408
ds_write_b128 v4, v[80:83] offset:18432
ds_write_b128 v4, v[84:87] offset:19456
ds_write_b128 v4, v[88:91] offset:20480
ds_write_b128 v4, v[92:95] offset:21504
ds_write_b128 v4, v[96:99] offset:22528
ds_write_b128 v4, v[100:103] offset:23552
ds_write_b128 v4, v[104:107] offset:24576
ds_write_b128 v4, v[108:111] offset:25600
ds_write_b128 v4, v[112:115] offset:26624
ds_write_b128 v4, v[116:119] offset:27648
s_waitcnt lgkmcnt(0)
ds_read_b64_tr_b16 a[28:29], v5 offset:0
ds_read_b64_tr_b16 a[30:31], v5 offset:2048
ds_read_b64_tr_b16 a[32:33], v5 offset:4096
ds_read_b64_tr_b16 a[34:35], v5 offset:6144
ds_read_b64_tr_b16 a[36:37], v5 offset:8192
ds_read_b64_tr_b16 a[38:39], v5 offset:10240
ds_read_b64_tr_b16 a[40:41], v5 offset:12288
ds_read_b64_tr_b16 a[42:43], v5 offset:14336
ds_read_b64_tr_b16 a[44:45], v5 offset:16384
ds_read_b64_tr_b16 a[46:47], v5 offset:18432
ds_read_b64_tr_b16 a[48:49], v5 offset:20480
ds_read_b64_tr_b16 a[50:51], v5 offset:22528
ds_read_b64_tr_b16 a[52:53], v5 offset:24576
ds_read_b64_tr_b16 a[54:55], v5 offset:26624
s_waitcnt lgkmcnt(0)
ds_read_b64_tr_b16 a[84:85], v5 offset:32
ds_read_b64_tr_b16 a[86:87], v5 offset:2080
ds_read_b64_tr_b16 a[88:89], v5 offset:4128
ds_read_b64_tr_b16 a[90:91], v5 offset:6176
ds_read_b64_tr_b16 a[92:93], v5 offset:8224
ds_read_b64_tr_b16 a[94:95], v5 offset:10272
ds_read_b64_tr_b16 a[96:97], v5 offset:12320
ds_read_b64_tr_b16 a[98:99], v5 offset:14368
ds_read_b64_tr_b16 a[100:101], v5 offset:16416
ds_read_b64_tr_b16 a[102:103], v5 offset:18464
ds_read_b64_tr_b16 a[104:105], v5 offset:20512
ds_read_b64_tr_b16 a[106:107], v5 offset:22560
ds_read_b64_tr_b16 a[108:109], v5 offset:24608
ds_read_b64_tr_b16 a[110:111], v5 offset:26656
s_waitcnt lgkmcnt(0)
ds_read_b64_tr_b16 a[140:141], v5 offset:64
ds_read_b64_tr_b16 a[142:143], v5 offset:2112
ds_read_b64_tr_b16 a[144:145], v5 offset:4160
ds_read_b64_tr_b16 a[146:147], v5 offset:6208
ds_read_b64_tr_b16 a[148:149], v5 offset:8256
ds_read_b64_tr_b16 a[150:151], v5 offset:10304
ds_read_b64_tr_b16 a[152:153], v5 offset:12352
ds_read_b64_tr_b16 a[154:155], v5 offset:14400
ds_read_b64_tr_b16 a[156:157], v5 offset:16448
ds_read_b64_tr_b16 a[158:159], v5 offset:18496
ds_read_b64_tr_b16 a[160:161], v5 offset:20544
ds_read_b64_tr_b16 a[162:163], v5 offset:22592
ds_read_b64_tr_b16 a[164:165], v5 offset:24640
ds_read_b64_tr_b16 a[166:167], v5 offset:26688
s_waitcnt lgkmcnt(0)
ds_read_b64_tr_b16 a[196:197], v5 offset:96
ds_read_b64_tr_b16 a[198:199], v5 offset:2144
ds_read_b64_tr_b16 a[200:201], v5 offset:4192
ds_read_b64_tr_b16 a[202:203], v5 offset:6240
ds_read_b64_tr_b16 a[204:205], v5 offset:8288
ds_read_b64_tr_b16 a[206:207], v5 offset:10336
ds_read_b64_tr_b16 a[208:209], v5 offset:12384
ds_read_b64_tr_b16 a[210:211], v5 offset:14432
ds_read_b64_tr_b16 a[212:213], v5 offset:16480
ds_read_b64_tr_b16 a[214:215], v5 offset:18528
ds_read_b64_tr_b16 a[216:217], v5 offset:20576
ds_read_b64_tr_b16 a[218:219], v5 offset:22624
ds_read_b64_tr_b16 a[220:221], v5 offset:24672
ds_read_b64_tr_b16 a[222:223], v5 offset:26720
s_waitcnt lgkmcnt(0)
s_barrier
s_lshl_b32 s29, s24, 13
v_add_u32 v68, s29, v2
s_lshl_b32 s29, s24, 11
v_add_u32 v69, s29, v2
v_and_b32 v72, 15, v1
v_lshrrev_b32 v73, 4, v1
v_lshrrev_b32 v74, 1, v73
v_lshlrev_b32 v70, 9, v74
v_lshl_add_u32 v70, v72, 4, v70
v_and_b32 v74, 1, v73
v_lshl_add_u32 v70, v74, 3, v70
s_lshl_b32 s29, s24, 5
s_add_u32 s29, s29, 65536
v_lshlrev_b32 v96, 7, v72
v_lshl_add_u32 v96, v73, 3, v96
v_add_u32 v96, s29, v96
v_lshlrev_b32 v97, 4, v0
v_add_u32 v97, 0x10000, v97
v_lshrrev_b32 v71, 3, v0
v_mul_u32_u24 v71, 896, v71
v_and_b32 v74, 7, v0
v_lshl_add_u32 v71, v74, 4, v71
s_lshl_b32 s29, s28, 2
s_add_u32 s29, s29, s24
RG_loop:
s_cmp_ge_u32 s25, 60
s_cbranch_scc1 RG_now
s_cmp_lg_u32 s24, 0
s_cbranch_scc1 RG_wa_w
s_lshl_b32 s46, s25, 7
s_add_u32 s46, s46, 74997888
v_mov_b32 v72, s46
s_mov_b32 s47, 0
RG_wa_p:
buffer_load_dword v73, v72, s[4:7], 0 offen sc1
s_waitcnt vmcnt(0)
v_readfirstlane_b32 s46, v73
s_add_u32 s47, s47, 1
s_nop 1
s_cmp_ge_u32 s46, 14
s_cbranch_scc1 RG_wa_w
s_cmp_gt_u32 s47, 20000
s_cbranch_scc1 RG_wa_w
s_sleep 1
s_branch RG_wa_p
RG_wa_w:
s_barrier
RG_now:
s_mul_i32 s30, s25, 114688
s_mul_i32 s31, s24, 14336
s_add_u32 s30, s30, s31
s_add_u32 s30, s30, 66650112
s_add_u32 s31, s30, 0
buffer_load_dwordx4 v[100:103], v2, s[4:7], s31 offen sc1
s_add_u32 s31, s30, 57344
buffer_load_dwordx4 v[104:107], v2, s[4:7], s31 offen sc1
s_add_u32 s31, s30, 1024
buffer_load_dwordx4 v[108:111], v2, s[4:7], s31 offen sc1
s_add_u32 s31, s30, 58368
buffer_load_dwordx4 v[112:115], v2, s[4:7], s31 offen sc1
s_add_u32 s31, s30, 2048
buffer_load_dwordx4 v[116:119], v2, s[4:7], s31 offen sc1
s_add_u32 s31, s30, 59392
buffer_load_dwordx4 v[120:123], v2, s[4:7], s31 offen sc1
s_add_u32 s31, s30, 3072
buffer_load_dwordx4 v[124:127], v2, s[4:7], s31 offen sc1
s_add_u32 s31, s30, 60416
buffer_load_dwordx4 v[128:131], v2, s[4:7], s31 offen sc1
s_add_u32 s31, s30, 4096
buffer_load_dwordx4 v[132:135], v2, s[4:7], s31 offen sc1
s_add_u32 s31, s30, 61440
buffer_load_dwordx4 v[136:139], v2, s[4:7], s31 offen sc1
s_add_u32 s31, s30, 5120
buffer_load_dwordx4 v[140:143], v2, s[4:7], s31 offen sc1
s_add_u32 s31, s30, 62464
buffer_load_dwordx4 v[144:147], v2, s[4:7], s31 offen sc1
s_add_u32 s31, s30, 6144
buffer_load_dwordx4 v[148:151], v2, s[4:7], s31 offen sc1
s_add_u32 s31, s30, 63488
buffer_load_dwordx4 v[152:155], v2, s[4:7], s31 offen sc1
s_add_u32 s31, s30, 7168
buffer_load_dwordx4 v[156:159], v2, s[4:7], s31 offen sc1
s_add_u32 s31, s30, 64512
buffer_load_dwordx4 v[160:163], v2, s[4:7], s31 offen sc1
s_add_u32 s31, s30, 8192
buffer_load_dwordx4 v[164:167], v2, s[4:7], s31 offen sc1
s_add_u32 s31, s30, 65536
buffer_load_dwordx4 v[168:171], v2, s[4:7], s31 offen sc1
s_add_u32 s31, s30, 9216
buffer_load_dwordx4 v[172:175], v2, s[4:7], s31 offen sc1
s_add_u32 s31, s30, 66560
buffer_load_dwordx4 v[176:179], v2, s[4:7], s31 offen sc1
s_add_u32 s31, s30, 10240
buffer_load_dwordx4 v[180:183], v2, s[4:7], s31 offen sc1
s_add_u32 s31, s30, 67584
buffer_load_dwordx4 v[184:187], v2, s[4:7], s31 offen sc1
s_add_u32 s31, s30, 11264
buffer_load_dwordx4 v[188:191], v2, s[4:7], s31 offen sc1
s_add_u32 s31, s30, 68608
buffer_load_dwordx4 v[192:195], v2, s[4:7], s31 offen sc1
s_add_u32 s31, s30, 12288
buffer_load_dwordx4 v[196:199], v2, s[4:7], s31 offen sc1
s_add_u32 s31, s30, 69632
buffer_load_dwordx4 v[200:203], v2, s[4:7], s31 offen sc1
s_add_u32 s31, s30, 13312
buffer_load_dwordx4 v[204:207], v2, s[4:7], s31 offen sc1
s_add_u32 s31, s30, 70656
buffer_load_dwordx4 v[208:211], v2, s[4:7], s31 offen sc1
s_mul_i32 s32, s25, 28672
s_lshl_b32 s33, s29, 10
s_add_u32 s32, s32, s33
s_add_u32 s32, s32, 64815104
buffer_load_dwordx2 v[76:77], v70, s[4:7], s32 offen offset:0 sc1
buffer_load_dwordx2 v[78:79], v70, s[4:7], s32 offen offset:256 sc1
s_cmp_lt_u32 s25, 60
s_cbranch_scc1 RG_go
s_mov_b32 s47, 0
RG_chk:
s_waitcnt vmcnt(0)
v_max_u32 v72, v100, v101
v_max3_u32 v72, v72, v102, v103
v_max3_u32 v72, v72, v104, v105
v_max3_u32 v72, v72, v106, v107
v_max3_u32 v72, v72, v108, v109
v_max3_u32 v72, v72, v110, v111
v_max3_u32 v72, v72, v112, v113
v_max3_u32 v72, v72, v114, v115
v_max3_u32 v72, v72, v116, v117
v_max3_u32 v72, v72, v118, v119
v_max3_u32 v72, v72, v120, v121
v_max3_u32 v72, v72, v122, v123
v_max3_u32 v72, v72, v124, v125
v_max3_u32 v72, v72, v126, v127
v_max3_u32 v72, v72, v128, v129
v_max3_u32 v72, v72, v130, v131
v_max3_u32 v72, v72, v132, v133
v_max3_u32 v72, v72, v134, v135
v_max3_u32 v72, v72, v136, v137
v_max3_u32 v72, v72, v138, v139
v_max3_u32 v72, v72, v140, v141
v_max3_u32 v72, v72, v142, v143
v_max3_u32 v72, v72, v144, v145
v_max3_u32 v72, v72, v146, v147
v_max3_u32 v72, v72, v148, v149
v_max3_u32 v72, v72, v150, v151
v_max3_u32 v72, v72, v152, v153
v_max3_u32 v72, v72, v154, v155
v_max3_u32 v72, v72, v156, v157
v_max3_u32 v72, v72, v158, v159
v_max3_u32 v72, v72, v160, v161
v_max3_u32 v72, v72, v162, v163
v_max3_u32 v72, v72, v164, v165
v_max3_u32 v72, v72, v166, v167
v_max3_u32 v72, v72, v168, v169
v_max3_u32 v72, v72, v170, v171
v_max3_u32 v72, v72, v172, v173
v_max3_u32 v72, v72, v174, v175
v_max3_u32 v72, v72, v176, v177
v_max3_u32 v72, v72, v178, v179
v_max3_u32 v72, v72, v180, v181
v_max3_u32 v72, v72, v182, v183
v_max3_u32 v72, v72, v184, v185
v_max3_u32 v72, v72, v186, v187
v_max3_u32 v72, v72, v188, v189
v_max3_u32 v72, v72, v190, v191
v_max3_u32 v72, v72, v192, v193
v_max3_u32 v72, v72, v194, v195
v_max3_u32 v72, v72, v196, v197
v_max3_u32 v72, v72, v198, v199
v_max3_u32 v72, v72, v200, v201
v_max3_u32 v72, v72, v202, v203
v_max3_u32 v72, v72, v204, v205
v_max3_u32 v72, v72, v206, v207
v_max3_u32 v72, v72, v208, v209
v_max3_u32 v72, v72, v210, v211
v_max3_u32 v72, v72, v76, v77
v_max3_u32 v72, v72, v78, v79
v_cmp_eq_u32 vcc, -1, v72
s_cbranch_vccz RG_go
s_add_u32 s47, s47, 1
s_cmp_gt_u32 s47, 20000
s_cbranch_scc1 RG_go
s_add_u32 s31, s30, 0
buffer_load_dwordx4 v[100:103], v2, s[4:7], s31 offen sc1
s_add_u32 s31, s30, 57344
buffer_load_dwordx4 v[104:107], v2, s[4:7], s31 offen sc1
s_add_u32 s31, s30, 1024
buffer_load_dwordx4 v[108:111], v2, s[4:7], s31 offen sc1
s_add_u32 s31, s30, 58368
buffer_load_dwordx4 v[112:115], v2, s[4:7], s31 offen sc1
s_add_u32 s31, s30, 2048
buffer_load_dwordx4 v[116:119], v2, s[4:7], s31 offen sc1
s_add_u32 s31, s30, 59392
buffer_load_dwordx4 v[120:123], v2, s[4:7], s31 offen sc1
s_add_u32 s31, s30, 3072
buffer_load_dwordx4 v[124:127], v2, s[4:7], s31 offen sc1
s_add_u32 s31, s30, 60416
buffer_load_dwordx4 v[128:131], v2, s[4:7], s31 offen sc1
s_add_u32 s31, s30, 4096
buffer_load_dwordx4 v[132:135], v2, s[4:7], s31 offen sc1
s_add_u32 s31, s30, 61440
buffer_load_dwordx4 v[136:139], v2, s[4:7], s31 offen sc1
s_add_u32 s31, s30, 5120
buffer_load_dwordx4 v[140:143], v2, s[4:7], s31 offen sc1
s_add_u32 s31, s30, 62464
buffer_load_dwordx4 v[144:147], v2, s[4:7], s31 offen sc1
s_add_u32 s31, s30, 6144
buffer_load_dwordx4 v[148:151], v2, s[4:7], s31 offen sc1
s_add_u32 s31, s30, 63488
buffer_load_dwordx4 v[152:155], v2, s[4:7], s31 offen sc1
s_add_u32 s31, s30, 7168
buffer_load_dwordx4 v[156:159], v2, s[4:7], s31 offen sc1
s_add_u32 s31, s30, 64512
buffer_load_dwordx4 v[160:163], v2, s[4:7], s31 offen sc1
s_add_u32 s31, s30, 8192
buffer_load_dwordx4 v[164:167], v2, s[4:7], s31 offen sc1
s_add_u32 s31, s30, 65536
buffer_load_dwordx4 v[168:171], v2, s[4:7], s31 offen sc1
s_add_u32 s31, s30, 9216
buffer_load_dwordx4 v[172:175], v2, s[4:7], s31 offen sc1
s_add_u32 s31, s30, 66560
buffer_load_dwordx4 v[176:179], v2, s[4:7], s31 offen sc1
s_add_u32 s31, s30, 10240
buffer_load_dwordx4 v[180:183], v2, s[4:7], s31 offen sc1
s_add_u32 s31, s30, 67584
buffer_load_dwordx4 v[184:187], v2, s[4:7], s31 offen sc1
s_add_u32 s31, s30, 11264
buffer_load_dwordx4 v[188:191], v2, s[4:7], s31 offen sc1
s_add_u32 s31, s30, 68608
buffer_load_dwordx4 v[192:195], v2, s[4:7], s31 offen sc1
s_add_u32 s31, s30, 12288
buffer_load_dwordx4 v[196:199], v2, s[4:7], s31 offen sc1
s_add_u32 s31, s30, 69632
buffer_load_dwordx4 v[200:203], v2, s[4:7], s31 offen sc1
s_add_u32 s31, s30, 13312
buffer_load_dwordx4 v[204:207], v2, s[4:7], s31 offen sc1
s_add_u32 s31, s30, 70656
buffer_load_dwordx4 v[208:211], v2, s[4:7], s31 offen sc1
buffer_load_dwordx2 v[76:77], v70, s[4:7], s32 offen offset:0 sc1
buffer_load_dwordx2 v[78:79], v70, s[4:7], s32 offen offset:256 sc1
s_branch RG_chk
RG_go:
s_waitcnt vmcnt(28)
v_mfma_f32_16x16x32_bf16 v[36:39], a[0:3], v[100:103], 0
v_mfma_f32_16x16x32_bf16 v[40:43], a[0:3], v[104:107], 0
v_mfma_f32_16x16x32_bf16 v[44:47], a[56:59], v[100:103], 0
v_mfma_f32_16x16x32_bf16 v[48:51], a[56:59], v[104:107], 0
v_mfma_f32_16x16x32_bf16 v[52:55], a[112:115], v[100:103], 0
v_mfma_f32_16x16x32_bf16 v[56:59], a[112:115], v[104:107], 0
v_mfma_f32_16x16x32_bf16 v[60:63], a[168:171], v[100:103], 0
v_mfma_f32_16x16x32_bf16 v[64:67], a[168:171], v[104:107], 0
s_waitcnt vmcnt(26)
v_mfma_f32_16x16x32_bf16 v[36:39], a[4:7], v[108:111], v[36:39]
v_mfma_f32_16x16x32_bf16 v[40:43], a[4:7], v[112:115], v[40:43]
v_mfma_f32_16x16x32_bf16 v[44:47], a[60:63], v[108:111], v[44:47]
v_mfma_f32_16x16x32_bf16 v[48:51], a[60:63], v[112:115], v[48:51]
v_mfma_f32_16x16x32_bf16 v[52:55], a[116:119], v[108:111], v[52:55]
v_mfma_f32_16x16x32_bf16 v[56:59], a[116:119], v[112:115], v[56:59]
v_mfma_f32_16x16x32_bf16 v[60:63], a[172:175], v[108:111], v[60:63]
v_mfma_f32_16x16x32_bf16 v[64:67], a[172:175], v[112:115], v[64:67]
s_waitcnt vmcnt(24)
v_mfma_f32_16x16x32_bf16 v[36:39], a[8:11], v[116:119], v[36:39]
v_mfma_f32_16x16x32_bf16 v[40:43], a[8:11], v[120:123], v[40:43]
v_mfma_f32_16x16x32_bf16 v[44:47], a[64:67], v[116:119], v[44:47]
v_mfma_f32_16x16x32_bf16 v[48:51], a[64:67], v[120:123], v[48:51]
v_mfma_f32_16x16x32_bf16 v[52:55], a[120:123], v[116:119], v[52:55]
v_mfma_f32_16x16x32_bf16 v[56:59], a[120:123], v[120:123], v[56:59]
v_mfma_f32_16x16x32_bf16 v[60:63], a[176:179], v[116:119], v[60:63]
v_mfma_f32_16x16x32_bf16 v[64:67], a[176:179], v[120:123], v[64:67]
s_waitcnt vmcnt(22)
v_mfma_f32_16x16x32_bf16 v[36:39], a[12:15], v[124:127], v[36:39]
v_mfma_f32_16x16x32_bf16 v[40:43], a[12:15], v[128:131], v[40:43]
v_mfma_f32_16x16x32_bf16 v[44:47], a[68:71], v[124:127], v[44:47]
v_mfma_f32_16x16x32_bf16 v[48:51], a[68:71], v[128:131], v[48:51]
v_mfma_f32_16x16x32_bf16 v[52:55], a[124:127], v[124:127], v[52:55]
v_mfma_f32_16x16x32_bf16 v[56:59], a[124:127], v[128:131], v[56:59]
v_mfma_f32_16x16x32_bf16 v[60:63], a[180:183], v[124:127], v[60:63]
v_mfma_f32_16x16x32_bf16 v[64:67], a[180:183], v[128:131], v[64:67]
s_waitcnt vmcnt(20)
v_mfma_f32_16x16x32_bf16 v[36:39], a[16:19], v[132:135], v[36:39]
v_mfma_f32_16x16x32_bf16 v[40:43], a[16:19], v[136:139], v[40:43]
v_mfma_f32_16x16x32_bf16 v[44:47], a[72:75], v[132:135], v[44:47]
v_mfma_f32_16x16x32_bf16 v[48:51], a[72:75], v[136:139], v[48:51]
v_mfma_f32_16x16x32_bf16 v[52:55], a[128:131], v[132:135], v[52:55]
v_mfma_f32_16x16x32_bf16 v[56:59], a[128:131], v[136:139], v[56:59]
v_mfma_f32_16x16x32_bf16 v[60:63], a[184:187], v[132:135], v[60:63]
v_mfma_f32_16x16x32_bf16 v[64:67], a[184:187], v[136:139], v[64:67]
s_waitcnt vmcnt(18)
v_mfma_f32_16x16x32_bf16 v[36:39], a[20:23], v[140:143], v[36:39]
v_mfma_f32_16x16x32_bf16 v[40:43], a[20:23], v[144:147], v[40:43]
v_mfma_f32_16x16x32_bf16 v[44:47], a[76:79], v[140:143], v[44:47]
v_mfma_f32_16x16x32_bf16 v[48:51], a[76:79], v[144:147], v[48:51]
v_mfma_f32_16x16x32_bf16 v[52:55], a[132:135], v[140:143], v[52:55]
v_mfma_f32_16x16x32_bf16 v[56:59], a[132:135], v[144:147], v[56:59]
v_mfma_f32_16x16x32_bf16 v[60:63], a[188:191], v[140:143], v[60:63]
v_mfma_f32_16x16x32_bf16 v[64:67], a[188:191], v[144:147], v[64:67]
s_waitcnt vmcnt(16)
v_mfma_f32_16x16x32_bf16 v[36:39], a[24:27], v[148:151], v[36:39]
v_mfma_f32_16x16x32_bf16 v[40:43], a[24:27], v[152:155], v[40:43]
v_mfma_f32_16x16x32_bf16 v[44:47], a[80:83], v[148:151], v[44:47]
v_mfma_f32_16x16x32_bf16 v[48:51], a[80:83], v[152:155], v[48:51]
v_mfma_f32_16x16x32_bf16 v[52:55], a[136:139], v[148:151], v[52:55]
v_mfma_f32_16x16x32_bf16 v[56:59], a[136:139], v[152:155], v[56:59]
v_mfma_f32_16x16x32_bf16 v[60:63], a[192:195], v[148:151], v[60:63]
v_mfma_f32_16x16x32_bf16 v[64:67], a[192:195], v[152:155], v[64:67]
s_waitcnt vmcnt(14)
v_mfma_f32_16x16x32_bf16 v[36:39], a[28:31], v[156:159], v[36:39]
v_mfma_f32_16x16x32_bf16 v[40:43], a[28:31], v[160:163], v[40:43]
v_mfma_f32_16x16x32_bf16 v[44:47], a[84:87], v[156:159], v[44:47]
v_mfma_f32_16x16x32_bf16 v[48:51], a[84:87], v[160:163], v[48:51]
v_mfma_f32_16x16x32_bf16 v[52:55], a[140:143], v[156:159], v[52:55]
v_mfma_f32_16x16x32_bf16 v[56:59], a[140:143], v[160:163], v[56:59]
v_mfma_f32_16x16x32_bf16 v[60:63], a[196:199], v[156:159], v[60:63]
v_mfma_f32_16x16x32_bf16 v[64:67], a[196:199], v[160:163], v[64:67]
s_waitcnt vmcnt(12)
v_mfma_f32_16x16x32_bf16 v[36:39], a[32:35], v[164:167], v[36:39]
v_mfma_f32_16x16x32_bf16 v[40:43], a[32:35], v[168:171], v[40:43]
v_mfma_f32_16x16x32_bf16 v[44:47], a[88:91], v[164:167], v[44:47]
v_mfma_f32_16x16x32_bf16 v[48:51], a[88:91], v[168:171], v[48:51]
v_mfma_f32_16x16x32_bf16 v[52:55], a[144:147], v[164:167], v[52:55]
v_mfma_f32_16x16x32_bf16 v[56:59], a[144:147], v[168:171], v[56:59]
v_mfma_f32_16x16x32_bf16 v[60:63], a[200:203], v[164:167], v[60:63]
v_mfma_f32_16x16x32_bf16 v[64:67], a[200:203], v[168:171], v[64:67]
s_waitcnt vmcnt(10)
v_mfma_f32_16x16x32_bf16 v[36:39], a[36:39], v[172:175], v[36:39]
v_mfma_f32_16x16x32_bf16 v[40:43], a[36:39], v[176:179], v[40:43]
v_mfma_f32_16x16x32_bf16 v[44:47], a[92:95], v[172:175], v[44:47]
v_mfma_f32_16x16x32_bf16 v[48:51], a[92:95], v[176:179], v[48:51]
v_mfma_f32_16x16x32_bf16 v[52:55], a[148:151], v[172:175], v[52:55]
v_mfma_f32_16x16x32_bf16 v[56:59], a[148:151], v[176:179], v[56:59]
v_mfma_f32_16x16x32_bf16 v[60:63], a[204:207], v[172:175], v[60:63]
v_mfma_f32_16x16x32_bf16 v[64:67], a[204:207], v[176:179], v[64:67]
s_waitcnt vmcnt(8)
v_mfma_f32_16x16x32_bf16 v[36:39], a[40:43], v[180:183], v[36:39]
v_mfma_f32_16x16x32_bf16 v[40:43], a[40:43], v[184:187], v[40:43]
v_mfma_f32_16x16x32_bf16 v[44:47], a[96:99], v[180:183], v[44:47]
v_mfma_f32_16x16x32_bf16 v[48:51], a[96:99], v[184:187], v[48:51]
v_mfma_f32_16x16x32_bf16 v[52:55], a[152:155], v[180:183], v[52:55]
v_mfma_f32_16x16x32_bf16 v[56:59], a[152:155], v[184:187], v[56:59]
v_mfma_f32_16x16x32_bf16 v[60:63], a[208:211], v[180:183], v[60:63]
v_mfma_f32_16x16x32_bf16 v[64:67], a[208:211], v[184:187], v[64:67]
s_waitcnt vmcnt(6)
v_mfma_f32_16x16x32_bf16 v[36:39], a[44:47], v[188:191], v[36:39]
v_mfma_f32_16x16x32_bf16 v[40:43], a[44:47], v[192:195], v[40:43]
v_mfma_f32_16x16x32_bf16 v[44:47], a[100:103], v[188:191], v[44:47]
v_mfma_f32_16x16x32_bf16 v[48:51], a[100:103], v[192:195], v[48:51]
v_mfma_f32_16x16x32_bf16 v[52:55], a[156:159], v[188:191], v[52:55]
v_mfma_f32_16x16x32_bf16 v[56:59], a[156:159], v[192:195], v[56:59]
v_mfma_f32_16x16x32_bf16 v[60:63], a[212:215], v[188:191], v[60:63]
v_mfma_f32_16x16x32_bf16 v[64:67], a[212:215], v[192:195], v[64:67]
s_waitcnt vmcnt(4)
v_mfma_f32_16x16x32_bf16 v[36:39], a[48:51], v[196:199], v[36:39]
v_mfma_f32_16x16x32_bf16 v[40:43], a[48:51], v[200:203], v[40:43]
v_mfma_f32_16x16x32_bf16 v[44:47], a[104:107], v[196:199], v[44:47]
v_mfma_f32_16x16x32_bf16 v[48:51], a[104:107], v[200:203], v[48:51]
v_mfma_f32_16x16x32_bf16 v[52:55], a[160:163], v[196:199], v[52:55]
v_mfma_f32_16x16x32_bf16 v[56:59], a[160:163], v[200:203], v[56:59]
v_mfma_f32_16x16x32_bf16 v[60:63], a[216:219], v[196:199], v[60:63]
v_mfma_f32_16x16x32_bf16 v[64:67], a[216:219], v[200:203], v[64:67]
s_waitcnt vmcnt(2)
v_mfma_f32_16x16x32_bf16 v[36:39], a[52:55], v[204:207], v[36:39]
v_mfma_f32_16x16x32_bf16 v[40:43], a[52:55], v[208:211], v[40:43]
v_mfma_f32_16x16x32_bf16 v[44:47], a[108:111], v[204:207], v[44:47]
v_mfma_f32_16x16x32_bf16 v[48:51], a[108:111], v[208:211], v[48:51]
v_mfma_f32_16x16x32_bf16 v[52:55], a[164:167], v[204:207], v[52:55]
v_mfma_f32_16x16x32_bf16 v[56:59], a[164:167], v[208:211], v[56:59]
v_mfma_f32_16x16x32_bf16 v[60:63], a[220:223], v[204:207], v[60:63]
v_mfma_f32_16x16x32_bf16 v[64:67], a[220:223], v[208:211], v[64:67]
s_nop 7
ds_write_b128 v68, v[36:39] offset:0
ds_write_b128 v68, v[40:43] offset:1024
ds_write_b128 v68, v[44:47] offset:2048
ds_write_b128 v68, v[48:51] offset:3072
ds_write_b128 v68, v[52:55] offset:4096
ds_write_b128 v68, v[56:59] offset:5120
ds_write_b128 v68, v[60:63] offset:6144
ds_write_b128 v68, v[64:67] offset:7168
v_xor_b32 v68, 0x8000, v68
s_waitcnt lgkmcnt(0)
s_barrier
ds_read_b128 v[36:39], v69 offset:0
ds_read_b128 v[40:43], v69 offset:8192
ds_read_b128 v[44:47], v69 offset:16384
ds_read_b128 v[48:51], v69 offset:24576
ds_read_b128 v[52:55], v69 offset:1024
ds_read_b128 v[56:59], v69 offset:9216
ds_read_b128 v[60:63], v69 offset:17408
ds_read_b128 v[64:67], v69 offset:25600
v_xor_b32 v69, 0x8000, v69
s_waitcnt lgkmcnt(0)
s_waitcnt vmcnt(0)
v_add_f32 v36, v36, v40
v_add_f32 v44, v44, v48
v_add_f32 v37, v37, v41
v_add_f32 v45, v45, v49
v_add_f32 v38, v38, v42
v_add_f32 v46, v46, v50
v_add_f32 v39, v39, v43
v_add_f32 v47, v47, v51
v_add_f32 v36, v36, v44
v_add_f32 v37, v37, v45
v_add_f32 v38, v38, v46
v_add_f32 v39, v39, v47
v_lshlrev_b32 v80, 16, v76
v_and_b32 v81, 0xffff0000, v76
v_lshlrev_b32 v82, 16, v77
v_and_b32 v83, 0xffff0000, v77
v_add_f32 v36, v36, v80
v_add_f32 v37, v37, v81
v_add_f32 v38, v38, v82
v_add_f32 v39, v39, v83
v_cvt_pk_bf16_f32 v84, v36, v37
v_cvt_pk_bf16_f32 v85, v38, v39
ds_write_b64 v96, v[84:85] offset:0
v_add_f32 v52, v52, v56
v_add_f32 v60, v60, v64
v_add_f32 v53, v53, v57
v_add_f32 v61, v61, v65
v_add_f32 v54, v54, v58
v_add_f32 v62, v62, v66
v_add_f32 v55, v55, v59
v_add_f32 v63, v63, v67
v_add_f32 v52, v52, v60
v_add_f32 v53, v53, v61
v_add_f32 v54, v54, v62
v_add_f32 v55, v55, v63
v_lshlrev_b32 v80, 16, v78
v_and_b32 v81, 0xffff0000, v78
v_lshlrev_b32 v82, 16, v79
v_and_b32 v83, 0xffff0000, v79
v_add_f32 v52, v52, v80
v_add_f32 v53, v53, v81
v_add_f32 v54, v54, v82
v_add_f32 v55, v55, v83
v_cvt_pk_bf16_f32 v86, v52, v53
v_cvt_pk_bf16_f32 v87, v54, v55
ds_write_b64 v96, v[86:87] offset:2048
s_waitcnt lgkmcnt(0)
s_barrier
ds_read_b128 v[80:83], v97
s_mul_i32 s32, s25, 28672
s_lshl_b32 s33, s28, 7
s_add_u32 s32, s32, s33
s_waitcnt lgkmcnt(0)
buffer_store_dwordx4 v[80:83], v71, s[12:15], s32 offen
s_add_u32 s25, s25, 4
s_cmp_lt_u32 s25, 60
s_cbranch_scc1 RG_loop
s_and_b32 s36, s25, 3
s_and_b32 s37, s36, 1
s_lshr_b32 s25, s36, 1
s_add_u32 s25, s25, 60
RG_tl:
s_mul_i32 s30, s25, 114688
s_mul_i32 s31, s24, 14336
s_add_u32 s30, s30, s31
s_mul_i32 s31, s37, 57344
s_add_u32 s30, s30, s31
s_add_u32 s30, s30, 66650112
s_mul_i32 s32, s25, 28672
s_lshl_b32 s33, s29, 10
s_add_u32 s32, s32, s33
s_lshl_b32 s33, s37, 8
s_add_u32 s32, s32, s33
s_add_u32 s32, s32, 64815104
s_mov_b32 s47, 0
RG_tld:
s_add_u32 s31, s30, 0
buffer_load_dwordx4 v[100:103], v2, s[4:7], s31 offen sc1
s_add_u32 s31, s30, 1024
buffer_load_dwordx4 v[104:107], v2, s[4:7], s31 offen sc1
s_add_u32 s31, s30, 2048
buffer_load_dwordx4 v[108:111], v2, s[4:7], s31 offen sc1
s_add_u32 s31, s30, 3072
buffer_load_dwordx4 v[112:115], v2, s[4:7], s31 offen sc1
s_add_u32 s31, s30, 4096
buffer_load_dwordx4 v[116:119], v2, s[4:7], s31 offen sc1
s_add_u32 s31, s30, 5120
buffer_load_dwordx4 v[120:123], v2, s[4:7], s31 offen sc1
s_add_u32 s31, s30, 6144
buffer_load_dwordx4 v[124:127], v2, s[4:7], s31 offen sc1
s_add_u32 s31, s30, 7168
buffer_load_dwordx4 v[128:131], v2, s[4:7], s31 offen sc1
s_add_u32 s31, s30, 8192
buffer_load_dwordx4 v[132:135], v2, s[4:7], s31 offen sc1
s_add_u32 s31, s30, 9216
buffer_load_dwordx4 v[136:139], v2, s[4:7], s31 offen sc1
s_add_u32 s31, s30, 10240
buffer_load_dwordx4 v[140:143], v2, s[4:7], s31 offen sc1
s_add_u32 s31, s30, 11264
buffer_load_dwordx4 v[144:147], v2, s[4:7], s31 offen sc1
s_add_u32 s31, s30, 12288
buffer_load_dwordx4 v[148:151], v2, s[4:7], s31 offen sc1
s_add_u32 s31, s30, 13312
buffer_load_dwordx4 v[152:155], v2, s[4:7], s31 offen sc1
buffer_load_dwordx2 v[76:77], v70, s[4:7], s32 offen sc1
s_waitcnt vmcnt(0)
v_max_u32 v72, v100, v101
v_max3_u32 v72, v72, v102, v103
v_max3_u32 v72, v72, v104, v105
v_max3_u32 v72, v72, v106, v107
v_max3_u32 v72, v72, v108, v109
v_max3_u32 v72, v72, v110, v111
v_max3_u32 v72, v72, v112, v113
v_max3_u32 v72, v72, v114, v115
v_max3_u32 v72, v72, v116, v117
v_max3_u32 v72, v72, v118, v119
v_max3_u32 v72, v72, v120, v121
v_max3_u32 v72, v72, v122, v123
v_max3_u32 v72, v72, v124, v125
v_max3_u32 v72, v72, v126, v127
v_max3_u32 v72, v72, v128, v129
v_max3_u32 v72, v72, v130, v131
v_max3_u32 v72, v72, v132, v133
v_max3_u32 v72, v72, v134, v135
v_max3_u32 v72, v72, v136, v137
v_max3_u32 v72, v72, v138, v139
v_max3_u32 v72, v72, v140, v141
v_max3_u32 v72, v72, v142, v143
v_max3_u32 v72, v72, v144, v145
v_max3_u32 v72, v72, v146, v147
v_max3_u32 v72, v72, v148, v149
v_max3_u32 v72, v72, v150, v151
v_max3_u32 v72, v72, v152, v153
v_max3_u32 v72, v72, v154, v155
v_max3_u32 v72, v72, v76, v77
v_cmp_eq_u32 vcc, -1, v72
s_cbranch_vccz RG_tgo
s_add_u32 s47, s47, 1
s_cmp_lt_u32 s47, 20000
s_cbranch_scc1 RG_tld
RG_tgo:
v_mfma_f32_16x16x32_bf16 v[36:39], a[0:3], v[100:103], 0
v_mfma_f32_16x16x32_bf16 v[40:43], a[56:59], v[100:103], 0
v_mfma_f32_16x16x32_bf16 v[44:47], a[112:115], v[100:103], 0
v_mfma_f32_16x16x32_bf16 v[48:51], a[168:171], v[100:103], 0
v_mfma_f32_16x16x32_bf16 v[36:39], a[4:7], v[104:107], v[36:39]
v_mfma_f32_16x16x32_bf16 v[40:43], a[60:63], v[104:107], v[40:43]
v_mfma_f32_16x16x32_bf16 v[44:47], a[116:119], v[104:107], v[44:47]
v_mfma_f32_16x16x32_bf16 v[48:51], a[172:175], v[104:107], v[48:51]
v_mfma_f32_16x16x32_bf16 v[36:39], a[8:11], v[108:111], v[36:39]
v_mfma_f32_16x16x32_bf16 v[40:43], a[64:67], v[108:111], v[40:43]
v_mfma_f32_16x16x32_bf16 v[44:47], a[120:123], v[108:111], v[44:47]
v_mfma_f32_16x16x32_bf16 v[48:51], a[176:179], v[108:111], v[48:51]
v_mfma_f32_16x16x32_bf16 v[36:39], a[12:15], v[112:115], v[36:39]
v_mfma_f32_16x16x32_bf16 v[40:43], a[68:71], v[112:115], v[40:43]
v_mfma_f32_16x16x32_bf16 v[44:47], a[124:127], v[112:115], v[44:47]
v_mfma_f32_16x16x32_bf16 v[48:51], a[180:183], v[112:115], v[48:51]
v_mfma_f32_16x16x32_bf16 v[36:39], a[16:19], v[116:119], v[36:39]
v_mfma_f32_16x16x32_bf16 v[40:43], a[72:75], v[116:119], v[40:43]
v_mfma_f32_16x16x32_bf16 v[44:47], a[128:131], v[116:119], v[44:47]
v_mfma_f32_16x16x32_bf16 v[48:51], a[184:187], v[116:119], v[48:51]
v_mfma_f32_16x16x32_bf16 v[36:39], a[20:23], v[120:123], v[36:39]
v_mfma_f32_16x16x32_bf16 v[40:43], a[76:79], v[120:123], v[40:43]
v_mfma_f32_16x16x32_bf16 v[44:47], a[132:135], v[120:123], v[44:47]
v_mfma_f32_16x16x32_bf16 v[48:51], a[188:191], v[120:123], v[48:51]
v_mfma_f32_16x16x32_bf16 v[36:39], a[24:27], v[124:127], v[36:39]
v_mfma_f32_16x16x32_bf16 v[40:43], a[80:83], v[124:127], v[40:43]
v_mfma_f32_16x16x32_bf16 v[44:47], a[136:139], v[124:127], v[44:47]
v_mfma_f32_16x16x32_bf16 v[48:51], a[192:195], v[124:127], v[48:51]
v_mfma_f32_16x16x32_bf16 v[36:39], a[28:31], v[128:131], v[36:39]
v_mfma_f32_16x16x32_bf16 v[40:43], a[84:87], v[128:131], v[40:43]
v_mfma_f32_16x16x32_bf16 v[44:47], a[140:143], v[128:131], v[44:47]
v_mfma_f32_16x16x32_bf16 v[48:51], a[196:199], v[128:131], v[48:51]
v_mfma_f32_16x16x32_bf16 v[36:39], a[32:35], v[132:135], v[36:39]
v_mfma_f32_16x16x32_bf16 v[40:43], a[88:91], v[132:135], v[40:43]
v_mfma_f32_16x16x32_bf16 v[44:47], a[144:147], v[132:135], v[44:47]
v_mfma_f32_16x16x32_bf16 v[48:51], a[200:203], v[132:135], v[48:51]
v_mfma_f32_16x16x32_bf16 v[36:39], a[36:39], v[136:139], v[36:39]
v_mfma_f32_16x16x32_bf16 v[40:43], a[92:95], v[136:139], v[40:43]
v_mfma_f32_16x16x32_bf16 v[44:47], a[148:151], v[136:139], v[44:47]
v_mfma_f32_16x16x32_bf16 v[48:51], a[204:207], v[136:139], v[48:51]
v_mfma_f32_16x16x32_bf16 v[36:39], a[40:43], v[140:143], v[36:39]
v_mfma_f32_16x16x32_bf16 v[40:43], a[96:99], v[140:143], v[40:43]
v_mfma_f32_16x16x32_bf16 v[44:47], a[152:155], v[140:143], v[44:47]
v_mfma_f32_16x16x32_bf16 v[48:51], a[208:211], v[140:143], v[48:51]
v_mfma_f32_16x16x32_bf16 v[36:39], a[44:47], v[144:147], v[36:39]
v_mfma_f32_16x16x32_bf16 v[40:43], a[100:103], v[144:147], v[40:43]
v_mfma_f32_16x16x32_bf16 v[44:47], a[156:159], v[144:147], v[44:47]
v_mfma_f32_16x16x32_bf16 v[48:51], a[212:215], v[144:147], v[48:51]
v_mfma_f32_16x16x32_bf16 v[36:39], a[48:51], v[148:151], v[36:39]
v_mfma_f32_16x16x32_bf16 v[40:43], a[104:107], v[148:151], v[40:43]
v_mfma_f32_16x16x32_bf16 v[44:47], a[160:163], v[148:151], v[44:47]
v_mfma_f32_16x16x32_bf16 v[48:51], a[216:219], v[148:151], v[48:51]
v_mfma_f32_16x16x32_bf16 v[36:39], a[52:55], v[152:155], v[36:39]
v_mfma_f32_16x16x32_bf16 v[40:43], a[108:111], v[152:155], v[40:43]
v_mfma_f32_16x16x32_bf16 v[44:47], a[164:167], v[152:155], v[44:47]
v_mfma_f32_16x16x32_bf16 v[48:51], a[220:223], v[152:155], v[48:51]
s_nop 7
ds_write_b128 v68, v[36:39] offset:0
ds_write_b128 v68, v[40:43] offset:2048
ds_write_b128 v68, v[44:47] offset:4096
ds_write_b128 v68, v[48:51] offset:6144
v_xor_b32 v68, 0x8000, v68
s_waitcnt lgkmcnt(0)
s_barrier
ds_read_b128 v[36:39], v69 offset:0
ds_read_b128 v[40:43], v69 offset:8192
ds_read_b128 v[44:47], v69 offset:16384
ds_read_b128 v[48:51], v69 offset:24576
v_xor_b32 v69, 0x8000, v69
s_waitcnt lgkmcnt(0)
v_add_f32 v36, v36, v40
v_add_f32 v44, v44, v48
v_add_f32 v37, v37, v41
v_add_f32 v45, v45, v49
v_add_f32 v38, v38, v42
v_add_f32 v46, v46, v50
v_add_f32 v39, v39, v43
v_add_f32 v47, v47, v51
v_add_f32 v36, v36, v44
v_add_f32 v37, v37, v45
v_add_f32 v38, v38, v46
v_add_f32 v39, v39, v47
v_lshlrev_b32 v80, 16, v76
v_and_b32 v81, 0xffff0000, v76
v_lshlrev_b32 v82, 16, v77
v_and_b32 v83, 0xffff0000, v77
v_add_f32 v36, v36, v80
v_add_f32 v37, v37, v81
v_add_f32 v38, v38, v82
v_add_f32 v39, v39, v83
v_cvt_pk_bf16_f32 v84, v36, v37
v_cvt_pk_bf16_f32 v85, v38, v39
ds_write_b64 v96, v[84:85]
s_waitcnt lgkmcnt(0)
s_barrier
s_cmp_ge_u32 s24, 2
s_cbranch_scc1 RG_tns
ds_read_b128 v[80:83], v97
s_mul_i32 s32, s25, 28672
s_mul_i32 s33, s37, 14336
s_add_u32 s32, s32, s33
s_lshl_b32 s33, s28, 7
s_add_u32 s32, s32, s33
s_waitcnt lgkmcnt(0)
buffer_store_dwordx4 v[80:83], v71, s[12:15], s32 offen
RG_tns:
s_add_u32 s25, s25, 2
s_cmp_lt_u32 s25, 64
s_cbranch_scc1 RG_tl
s_waitcnt vmcnt(0)
s_branch L_exit
L_exit:
s_waitcnt vmcnt(0)
L_exit0:
s_endpgm

.section .rodata,"a"
.p2align 6
.amdhsa_kernel sequential_preLN__memory_aug_recurrent_mem_tr__swiglu_ffn__prompt_kernel
  .amdhsa_next_free_vgpr 512
  .amdhsa_next_free_sgpr 102
  .amdhsa_accum_offset 256
  .amdhsa_group_segment_fixed_size 0
  .amdhsa_kernarg_size 112
  .amdhsa_user_sgpr_count 2
  .amdhsa_user_sgpr_kernarg_segment_ptr 1
  .amdhsa_system_sgpr_workgroup_id_x 1
.end_amdhsa_kernel
```
